```python
import torch

def _softmax(x, axis=-1):
    return torch.softmax(x, dim=axis)
def _gelu(x):
    return torch.nn.functional.gelu(x, approximate="tanh")
def _silu(x):
    return torch.nn.functional.silu(x)
def _sigmoid(x):
    return torch.sigmoid(x)
def _layernorm(x, axis=-1, eps=1e-5):
    m = x.mean(dim=axis, keepdim=True)
    v = x.var(dim=axis, keepdim=True, unbiased=False)
    return (x - m) / torch.sqrt(v + eps)
def _scatter_add(tgt, idx, src, axis=0):
    return tgt.clone().index_add_(axis, idx, src)
def _segment_sum(src, seg, n):
    out = torch.zeros((n,) + src.shape[1:], dtype=src.dtype)
    return out.index_add_(0, seg, src)
def _pad(x, pw):
    flat = tuple(v for pair in reversed(pw) for v in pair)
    return torch.nn.functional.pad(x, flat)

kernel_name = 'sequential_preLN__ssm_conv_h3__mixer_s_mlp__prompt'

def setup_inputs():

    _w = (lambda a: (lambda t: t.to(torch.bfloat16) if t.is_floating_point() else t)(torch.as_tensor(a)))
    def _A_setup():
        B, S, D = 1, 2048, 576
        ks = 4
        return {
            "q": _w((lambda *s: torch.randn(*s, dtype=torch.bfloat16) * 0.05)(B, S, D)),
            "k": _w((lambda *s: torch.randn(*s, dtype=torch.bfloat16) * 0.4)(B, S, D)),
            "v": _w((lambda *s: torch.randn(*s, dtype=torch.bfloat16) * 0.4)(B, S, D)),
            "shift_k": _w((lambda *s: torch.randn(*s, dtype=torch.bfloat16) * 0.4)(D, ks) * 0.5),
            "ssm_k": _w((lambda *s: torch.randn(*s, dtype=torch.bfloat16) * 0.4)(D, S) * (1.0 / S ** 0.5)),
            "ssm_D": _w((lambda *s: torch.randn(*s, dtype=torch.bfloat16) * 0.4)(D)),
        }
    _A_in = _A_setup()

    def _B_setup():
        B, S, D, F = 1, 2048, 576, 4608
        return {
            "x":  _w((lambda *s: torch.randn(*s, dtype=torch.bfloat16) * 0.05)(B, S, D)),
            "w1": _w((lambda *s: torch.randn(*s, dtype=torch.bfloat16) * 3.2)(D, D) * (D ** -0.5)),
            "w2": _w((lambda *s: torch.randn(*s, dtype=torch.bfloat16) * 3.2)(D, D) * (D ** -0.5)),
            "w3": _w((lambda *s: torch.randn(*s, dtype=torch.bfloat16) * 3.2)(D, F) * (D ** -0.5)),
            "w4": _w((lambda *s: torch.randn(*s, dtype=torch.bfloat16) * 1.6)(F, D) * (F ** -0.5)),
        }
    _B_in = _B_setup()

    return {
        "A_q": _A_in["q"],
        "A_k": _A_in["k"],
        "A_v": _A_in["v"],
        "A_shift_k": _A_in["shift_k"],
        "A_ssm_k": _A_in["ssm_k"],
        "A_ssm_D": _A_in["ssm_D"],
        "B_x": _B_in["x"],
        "B_w1": _B_in["w1"],
        "B_w2": _B_in["w2"],
        "B_w3": _B_in["w3"],
        "B_w4": _B_in["w4"],
    }

def reference(A_q, A_k, A_v, A_shift_k, A_ssm_k, A_ssm_D, B_x, B_w1, B_w2, B_w3, B_w4):
    def _A_ref(q, k, v, shift_k, ssm_k, ssm_D):
        B, S, D = q.shape
        ks = shift_k.shape[-1]
        k_pad = _pad(k, ((0, 0), (ks - 1, 0), (0, 0)))
        k_shift = torch.zeros_like(k)
        for t in range(ks):
            k_shift = k_shift + k_pad[:, t:t + S, :] * shift_k[:, ks - 1 - t][None, None, :]
        kv = k_shift * v
        L = 2 * S
        kv_pad = _pad(kv, ((0, 0), (0, S), (0, 0)))
        kf_pad = _pad(ssm_k, ((0, 0), (0, S)))
        kv_f = (lambda x, axes=(-2,-1): torch.fft.rfft2(x.float(), dim=axes))(kv_pad[:, None, :, :], axes=(1, 2))
        kf_f = (lambda x, axes=(-2,-1): torch.fft.rfft2(x.float(), dim=axes))(kf_pad[:, None, :], axes=(1, 2))
        kf_f = (lambda x, *d: x.permute(*d))(kf_f, 1, 2, 0)
        y_f = kv_f * kf_f[None, :, :, :]
        y = (lambda x, s, axes=(-2,-1): torch.fft.irfft2(x, s=s, dim=axes).to(torch.bfloat16))(y_f, (1, L), axes=(1, 2))[:, 0, :S, :]
        y = y + kv * ssm_D[None, None, :]
        return q * y

    def _B_ref(x, w1, w2, w3, w4):
        B, S, D = x.shape
        h = _gelu(_layernorm(x, axis=-1) @ w1)
        c = D // 4
        g0 = _pad(h[:, :, 0*c:1*c], ((0, 0), (1, 0), (0, 0)))[:, :S, :]
        g1 = _pad(h[:, :, 1*c:2*c], ((0, 0), (0, 1), (0, 0)))[:, 1:, :]
        g2 = _pad(h[:, :, 2*c:3*c], ((0, 0), (2, 0), (0, 0)))[:, :S, :]
        g3 = _pad(h[:, :, 3*c:   ], ((0, 0), (0, 2), (0, 0)))[:, 2:, :]
        hs = torch.concatenate([g0, g1, g2, g3], axis=-1) @ w2
        x1 = x + hs
        h2 = _gelu(_layernorm(x1, axis=-1) @ w3) @ w4
        return x1 + h2

    x = A_q
    h = x + _A_ref(_layernorm(x, axis=-1), A_k, A_v, A_shift_k, A_ssm_k, A_ssm_D)
    h2 = h + _B_ref(_layernorm(h, axis=-1), B_w1, B_w2, B_w3, B_w4)
    return h2
```

```asm
; @launch grid=(256,1,1) block=(512,1,1) lds=151552
.amdgcn_target "amdgcn-amd-amdhsa--gfx950"
.text
.globl sequential_preLN__ssm_conv_h3__mixer_s_mlp__prompt_kernel
.p2align 8
.type sequential_preLN__ssm_conv_h3__mixer_s_mlp__prompt_kernel,@function
sequential_preLN__ssm_conv_h3__mixer_s_mlp__prompt_kernel:
    s_cmp_ge_u32 s2, 256
    s_cbranch_scc1 sequential_preLN__ssm_conv_h3__mixer_s_mlp__prompt_kernel_end
    s_load_dwordx16 s[16:31], s[0:1], 0
    s_load_dwordx8 s[32:39], s[0:1], 64
    s_load_dwordx4 s[40:43], s[0:1], 96
    v_lshrrev_b32 v1, 6, v0
    v_and_b32 v11, 63, v0
    v_readfirstlane_b32 s3, v1
    s_lshr_b32 s4, s2, 3
    s_and_b32 s5, s2, 7
    s_lshl_b32 s74, s5, 3
    s_lshr_b32 s75, s4, 2
    s_add_u32 s74, s74, s75
    s_and_b32 s75, s4, 3
    s_lshr_b32 s72, s75, 1
    s_add_u32 s72, s72, 1
    s_sub_u32 s73, 0, s72
    s_bitcmp1_b32 s75, 0
    s_cselect_b32 s72, s72, s73
    s_lshl_b32 s73, s74, 5
    s_add_u32 s72, s72, s73
    s_mul_i32 s73, s75, 9
    s_getpc_b64 s[6:7]
text_pc0:
    v_and_b32 v12, 127, v0
    s_lshl_b32 s8, s4, 7
    v_add_u32 v12, s8, v12
    v_lshrrev_b32 v14, 1, v12
    v_and_b32 v12, 1, v12
    v_add_u32 v12, s5, v12
    v_lshlrev_b32 v12, 7, v12
    s_movk_i32 s8, 1152
    v_mad_u32_u24 v12, v14, s8, v12
    v_lshlrev_b32 v13, 7, v11
    s_waitcnt lgkmcnt(0)
    s_mov_b32 s44, s42
    s_and_b32 s45, s43, 0xffff
    s_mov_b32 s46, 268435456
    s_mov_b32 s47, 0x20000
    s_cmp_ge_u32 s3, 4
    s_cbranch_scc1 sequential_preLN__ssm_conv_h3__mixer_s_mlp__prompt_kernel_nopf
    s_cmp_lt_u32 s3, 2
    s_cselect_b64 s[8:9], s[18:19], s[20:21]
    global_load_dword v166, v12, s[8:9]
    global_load_dword v167, v13, s[6:7]
sequential_preLN__ssm_conv_h3__mixer_s_mlp__prompt_kernel_nopf:
    v_mov_b32 v111, 0
    s_cmp_ge_u32 s4, 18
    s_cbranch_scc1 sequential_preLN__ssm_conv_h3__mixer_s_mlp__prompt_kernel_nonconv
    s_mul_i32 s10, s5, 18
    s_add_u32 s10, s10, s4
    s_cmp_ge_u32 s3, 4
    s_cbranch_scc1 sequential_preLN__ssm_conv_h3__mixer_s_mlp__prompt_kernel_loader
    s_lshl_b32 s11, s10, 2
    s_add_u32 s11, s11, s3
    s_lshr_b32 s13, s11, 1
    s_lshl_b32 s13, s13, 2
    s_load_dword s56, s[26:27], s13
    s_lshl_b32 s12, s11, 12
    s_add_u32 s60, s24, s12
    s_addc_u32 s61, s25, 0
    s_and_b32 s61, s61, 0xffff
    s_movk_i32 s62, 4096
    s_mov_b32 s63, 0x20000
    v_lshlrev_b32 v5, 4, v11
    buffer_load_dwordx4 v[16:19], v5, s[60:63], 0 offen offset:0
    buffer_load_dwordx4 v[20:23], v5, s[60:63], 0 offen offset:4
    buffer_load_dwordx4 v[24:27], v5, s[60:63], 0 offen offset:8
    buffer_load_dwordx4 v[28:31], v5, s[60:63], 0 offen offset:1024
    buffer_load_dwordx4 v[32:35], v5, s[60:63], 0 offen offset:1028
    buffer_load_dwordx4 v[36:39], v5, s[60:63], 0 offen offset:1032
    buffer_load_dwordx4 v[40:43], v5, s[60:63], 0 offen offset:2048
    buffer_load_dwordx4 v[44:47], v5, s[60:63], 0 offen offset:2052
    buffer_load_dwordx4 v[48:51], v5, s[60:63], 0 offen offset:2056
    buffer_load_dwordx4 v[52:55], v5, s[60:63], 0 offen offset:3072
    buffer_load_dwordx4 v[56:59], v5, s[60:63], 0 offen offset:3076
    buffer_load_dwordx4 v[60:63], v5, s[60:63], 0 offen offset:3080
    s_mul_i32 s14, s3, 16640
    s_mul_i32 s15, s3, 4608
    s_add_u32 s15, s15, 66560
    v_add_u32 v6, s14, v5
    v_and_b32 v12, 15, v11
    v_lshrrev_b32 v15, 4, v11
    v_add_u32 v8, 1, v12
    v_and_b32 v9, 3, v8
    v_mul_u32_u24 v9, 4160, v9
    v_and_b32 v8, 0xfffffffc, v8
    v_add_u32 v8, 24, v8
    v_lshlrev_b32 v10, 3, v15
    v_sub_u32 v8, v8, v10
    v_lshlrev_b32 v8, 1, v8
    v_add3_u32 v8, v8, v9, s14
    v_lshlrev_b32 v9, 5, v12
    v_lshl_add_u32 v10, v15, 3, v9
    v_lshl_add_u32 v9, v15, 4, v9
    s_add_u32 s57, s15, 528
    v_sub_u32 v9, s57, v9
    v_lshrrev_b32 v7, 1, v12
    v_lshlrev_b32 v7, 6, v7
    v_and_b32 v4, 1, v12
    v_lshl_add_u32 v7, v4, 4, v7
    v_lshl_add_u32 v7, v15, 2, v7
    s_add_u32 s57, s15, 504
    v_sub_u32 v10, s57, v10
    v_mov_b32 v84, 0
    v_mov_b32 v85, 0
    v_mov_b32 v86, 0
    v_mov_b32 v87, 0
    v_add_u32 v13, s15, v5
    s_mov_b64 exec, 0x3fffffff
    ds_write_b128 v13, v[84:87] offset:4096
    s_mov_b64 exec, -1
    v_lshrrev_b32 v13, 1, v11
    v_mul_u32_u24 v13, 4160, v13
    v_and_b32 v4, 1, v11
    v_lshl_add_u32 v13, v4, 4, v13
    v_add_u32 v13, s14, v13
    s_mov_b64 exec, 0xff
    ds_write_b128 v13, v[84:87]
    s_mov_b64 exec, -1
    v_mov_b32 v88, 0
    v_mov_b32 v89, 0
    v_mov_b32 v90, 0
    v_mov_b32 v91, 0
    v_mov_b32 v92, 0
    v_mov_b32 v93, 0
    v_mov_b32 v94, 0
    v_mov_b32 v95, 0
    v_mov_b32 v96, 0
    v_mov_b32 v97, 0
    v_mov_b32 v98, 0
    v_mov_b32 v99, 0
    v_mov_b32 v100, 0
    v_mov_b32 v101, 0
    v_mov_b32 v102, 0
    v_mov_b32 v103, 0
    v_mov_b32 v104, 0
    v_mov_b32 v105, 0
    v_mov_b32 v106, 0
    v_mov_b32 v107, 0
    v_mov_b32 v108, 0
    v_mov_b32 v109, 0
    v_mov_b32 v110, 0
    v_mov_b32 v111, 0
    v_mov_b32 v112, 0
    v_mov_b32 v113, 0
    v_mov_b32 v114, 0
    v_mov_b32 v115, 0
    v_mov_b32 v116, 0
    v_mov_b32 v117, 0
    v_mov_b32 v118, 0
    v_mov_b32 v119, 0
    s_waitcnt lgkmcnt(0)
    s_lshl_b32 s57, s56, 16
    s_and_b32 s58, s56, 0xffff0000
    s_bitcmp1_b32 s3, 0
    s_cselect_b32 s56, s58, s57
    s_waitcnt vmcnt(10)
    v_alignbit_b32 v64, v20, v16, 16
    v_alignbit_b32 v65, v21, v17, 16
    v_alignbit_b32 v66, v22, v18, 16
    v_alignbit_b32 v67, v23, v19, 16
    s_waitcnt vmcnt(9)
    v_alignbit_b32 v68, v24, v20, 16
    v_alignbit_b32 v69, v25, v21, 16
    v_alignbit_b32 v70, v26, v22, 16
    v_alignbit_b32 v71, v27, v23, 16
    ds_write_b128 v6, v[16:19] offset:32
    ds_write_b128 v6, v[20:23] offset:8352
    ds_write_b128 v6, v[64:67] offset:4192
    ds_write_b128 v6, v[68:71] offset:12512
    v_lshlrev_b32 v72, 16, v16
    v_alignbit_b32 v73, v17, v16, 16
    s_mov_b64 exec, 1
    ds_write_b32 v6, v72 offset:4188
    ds_write_b32 v6, v16 offset:8348
    ds_write_b64 v6, v[72:73] offset:12504
    s_mov_b64 exec, -1
    s_waitcnt vmcnt(7)
    v_alignbit_b32 v74, v32, v28, 16
    v_alignbit_b32 v75, v33, v29, 16
    v_alignbit_b32 v76, v34, v30, 16
    v_alignbit_b32 v77, v35, v31, 16
    s_waitcnt vmcnt(6)
    v_alignbit_b32 v78, v36, v32, 16
    v_alignbit_b32 v79, v37, v33, 16
    v_alignbit_b32 v80, v38, v34, 16
    v_alignbit_b32 v81, v39, v35, 16
    ds_write_b128 v6, v[28:31] offset:1056
    ds_write_b128 v6, v[32:35] offset:9376
    ds_write_b128 v6, v[74:77] offset:5216
    ds_write_b128 v6, v[78:81] offset:13536
    s_waitcnt vmcnt(4)
    v_alignbit_b32 v64, v44, v40, 16
    v_alignbit_b32 v65, v45, v41, 16
    v_alignbit_b32 v66, v46, v42, 16
    v_alignbit_b32 v67, v47, v43, 16
    s_waitcnt vmcnt(3)
    v_alignbit_b32 v68, v48, v44, 16
    v_alignbit_b32 v69, v49, v45, 16
    v_alignbit_b32 v70, v50, v46, 16
    v_alignbit_b32 v71, v51, v47, 16
    ds_write_b128 v6, v[40:43] offset:2080
    ds_write_b128 v6, v[44:47] offset:10400
    ds_write_b128 v6, v[64:67] offset:6240
    ds_write_b128 v6, v[68:71] offset:14560
    s_waitcnt vmcnt(1)
    v_alignbit_b32 v74, v56, v52, 16
    v_alignbit_b32 v75, v57, v53, 16
    v_alignbit_b32 v76, v58, v54, 16
    v_alignbit_b32 v77, v59, v55, 16
    s_waitcnt vmcnt(0)
    v_alignbit_b32 v78, v60, v56, 16
    v_alignbit_b32 v79, v61, v57, 16
    v_alignbit_b32 v80, v62, v58, 16
    v_alignbit_b32 v81, v63, v59, 16
    s_waitcnt lgkmcnt(14)
    ds_write_b128 v6, v[52:55] offset:3104
    s_waitcnt lgkmcnt(14)
    ds_write_b128 v6, v[56:59] offset:11424
    s_waitcnt lgkmcnt(14)
    ds_write_b128 v6, v[74:77] offset:7264
    s_waitcnt lgkmcnt(14)
    ds_write_b128 v6, v[78:81] offset:15584
    s_mov_b32 s64, s16
    s_and_b32 s65, s17, 0xffff
    s_mov_b32 s66, 2359296
    s_mov_b32 s67, 0x20000
    s_mul_i32 s68, s72, 1152
    s_lshl_b32 s69, s3, 10
    s_add_u32 s68, s68, s69
    v_add_u32 v2, s68, v5
    s_add_u32 m0, s69, 94208
    s_waitcnt lgkmcnt(0)
    ds_read_b64 v[120:121], v8 offset:0
    ds_read_b64 v[122:123], v8 offset:8
    ds_read_b64 v[124:125], v8 offset:512
    ds_read_b64 v[126:127], v8 offset:520
    ds_read_b64 v[128:129], v8 offset:1024
    ds_read_b64 v[130:131], v8 offset:1032
    ds_read_b64 v[132:133], v8 offset:1536
    ds_read_b64 v[134:135], v8 offset:1544
    ds_read_b64 v[136:137], v8 offset:2048
    ds_read_b64 v[138:139], v8 offset:2056
    ds_read_b64 v[140:141], v8 offset:2560
    ds_read_b64 v[142:143], v8 offset:2568
    ds_read_b64 v[144:145], v8 offset:3072
    ds_read_b64 v[146:147], v8 offset:3080
    ds_read_b64 v[148:149], v8 offset:3584
    s_waitcnt lgkmcnt(14)
    ds_read_b64 v[150:151], v8 offset:3592
    s_barrier
    s_waitcnt lgkmcnt(14)
    ds_read_b128 v[152:155], v9 offset:3584
    s_waitcnt lgkmcnt(14)
    ds_read_b128 v[156:159], v9 offset:3072
    s_waitcnt lgkmcnt(1)
    v_mfma_f32_16x16x32_bf16 v[88:91], v[120:123], v[152:155], v[88:91]
    ds_read_b128 v[160:163], v9 offset:3648
    s_waitcnt lgkmcnt(1)
    v_mfma_f32_16x16x32_bf16 v[92:95], v[120:123], v[156:159], v[92:95]
    ds_read_b128 v[164:167], v9 offset:3136
    ds_read_b64 v[120:121], v8 offset:64
    ds_read_b64 v[122:123], v8 offset:72
    v_mfma_f32_16x16x32_bf16 v[92:95], v[124:127], v[152:155], v[92:95]
    v_mfma_f32_16x16x32_bf16 v[96:99], v[124:127], v[156:159], v[96:99]
    ds_read_b64 v[124:125], v8 offset:576
    ds_read_b64 v[126:127], v8 offset:584
    v_mfma_f32_16x16x32_bf16 v[96:99], v[128:131], v[152:155], v[96:99]
    v_mfma_f32_16x16x32_bf16 v[100:103], v[128:131], v[156:159], v[100:103]
    ds_read_b64 v[128:129], v8 offset:1088
    ds_read_b64 v[130:131], v8 offset:1096
    v_mfma_f32_16x16x32_bf16 v[100:103], v[132:135], v[152:155], v[100:103]
    v_mfma_f32_16x16x32_bf16 v[104:107], v[132:135], v[156:159], v[104:107]
    ds_read_b64 v[132:133], v8 offset:1600
    ds_read_b64 v[134:135], v8 offset:1608
    v_mfma_f32_16x16x32_bf16 v[104:107], v[136:139], v[152:155], v[104:107]
    v_mfma_f32_16x16x32_bf16 v[108:111], v[136:139], v[156:159], v[108:111]
    ds_read_b64 v[136:137], v8 offset:2112
    ds_read_b64 v[138:139], v8 offset:2120
    v_mfma_f32_16x16x32_bf16 v[108:111], v[140:143], v[152:155], v[108:111]
    v_mfma_f32_16x16x32_bf16 v[112:115], v[140:143], v[156:159], v[112:115]
    ds_read_b64 v[140:141], v8 offset:2624
    ds_read_b64 v[142:143], v8 offset:2632
    v_mfma_f32_16x16x32_bf16 v[112:115], v[144:147], v[152:155], v[112:115]
    v_mfma_f32_16x16x32_bf16 v[116:119], v[144:147], v[156:159], v[116:119]
    ds_read_b64 v[144:145], v8 offset:3136
    s_waitcnt lgkmcnt(14)
    ds_read_b64 v[146:147], v8 offset:3144
    v_mfma_f32_16x16x32_bf16 v[116:119], v[148:151], v[152:155], v[116:119]
    s_waitcnt lgkmcnt(14)
    ds_read_b64 v[148:149], v8 offset:3648
    s_waitcnt lgkmcnt(14)
    ds_read_b64 v[150:151], v8 offset:3656
    s_waitcnt lgkmcnt(14)
    v_mfma_f32_16x16x32_bf16 v[88:91], v[120:123], v[160:163], v[88:91]
    ds_read_b128 v[152:155], v9 offset:3712
    v_mfma_f32_16x16x32_bf16 v[92:95], v[120:123], v[164:167], v[92:95]
    s_waitcnt lgkmcnt(14)
    ds_read_b128 v[156:159], v9 offset:3200
    s_waitcnt lgkmcnt(14)
    ds_read_b64 v[120:121], v8 offset:128
    s_waitcnt lgkmcnt(14)
    ds_read_b64 v[122:123], v8 offset:136
    v_mfma_f32_16x16x32_bf16 v[92:95], v[124:127], v[160:163], v[92:95]
    v_mfma_f32_16x16x32_bf16 v[96:99], v[124:127], v[164:167], v[96:99]
    s_waitcnt lgkmcnt(14)
    ds_read_b64 v[124:125], v8 offset:640
    s_waitcnt lgkmcnt(14)
    ds_read_b64 v[126:127], v8 offset:648
    v_mfma_f32_16x16x32_bf16 v[96:99], v[128:131], v[160:163], v[96:99]
    v_mfma_f32_16x16x32_bf16 v[100:103], v[128:131], v[164:167], v[100:103]
    s_waitcnt lgkmcnt(14)
    ds_read_b64 v[128:129], v8 offset:1152
    s_waitcnt lgkmcnt(14)
    ds_read_b64 v[130:131], v8 offset:1160
    v_mfma_f32_16x16x32_bf16 v[100:103], v[132:135], v[160:163], v[100:103]
    v_mfma_f32_16x16x32_bf16 v[104:107], v[132:135], v[164:167], v[104:107]
    s_waitcnt lgkmcnt(14)
    ds_read_b64 v[132:133], v8 offset:1664
    s_waitcnt lgkmcnt(14)
    ds_read_b64 v[134:135], v8 offset:1672
    v_mfma_f32_16x16x32_bf16 v[104:107], v[136:139], v[160:163], v[104:107]
    v_mfma_f32_16x16x32_bf16 v[108:111], v[136:139], v[164:167], v[108:111]
    s_waitcnt lgkmcnt(14)
    ds_read_b64 v[136:137], v8 offset:2176
    s_waitcnt lgkmcnt(14)
    ds_read_b64 v[138:139], v8 offset:2184
    v_mfma_f32_16x16x32_bf16 v[108:111], v[140:143], v[160:163], v[108:111]
    v_mfma_f32_16x16x32_bf16 v[112:115], v[140:143], v[164:167], v[112:115]
    s_waitcnt lgkmcnt(14)
    ds_read_b64 v[140:141], v8 offset:2688
    s_waitcnt lgkmcnt(14)
    ds_read_b64 v[142:143], v8 offset:2696
    v_mfma_f32_16x16x32_bf16 v[112:115], v[144:147], v[160:163], v[112:115]
    v_mfma_f32_16x16x32_bf16 v[116:119], v[144:147], v[164:167], v[116:119]
    s_waitcnt lgkmcnt(14)
    ds_read_b64 v[144:145], v8 offset:3200
    s_waitcnt lgkmcnt(14)
    ds_read_b64 v[146:147], v8 offset:3208
    v_mfma_f32_16x16x32_bf16 v[116:119], v[148:151], v[160:163], v[116:119]
    s_waitcnt lgkmcnt(14)
    ds_read_b64 v[148:149], v8 offset:3712
    s_waitcnt lgkmcnt(14)
    ds_read_b64 v[150:151], v8 offset:3720
    s_waitcnt lgkmcnt(14)
    v_mfma_f32_16x16x32_bf16 v[88:91], v[120:123], v[152:155], v[88:91]
    ds_read_b128 v[160:163], v9 offset:3776
    v_mfma_f32_16x16x32_bf16 v[92:95], v[120:123], v[156:159], v[92:95]
    s_waitcnt lgkmcnt(14)
    ds_read_b128 v[164:167], v9 offset:3264
    s_waitcnt lgkmcnt(14)
    ds_read_b64 v[120:121], v8 offset:192
    s_waitcnt lgkmcnt(14)
    ds_read_b64 v[122:123], v8 offset:200
    v_mfma_f32_16x16x32_bf16 v[92:95], v[124:127], v[152:155], v[92:95]
    v_mfma_f32_16x16x32_bf16 v[96:99], v[124:127], v[156:159], v[96:99]
    s_waitcnt lgkmcnt(14)
    ds_read_b64 v[124:125], v8 offset:704
    s_waitcnt lgkmcnt(14)
    ds_read_b64 v[126:127], v8 offset:712
    v_mfma_f32_16x16x32_bf16 v[96:99], v[128:131], v[152:155], v[96:99]
    v_mfma_f32_16x16x32_bf16 v[100:103], v[128:131], v[156:159], v[100:103]
    s_waitcnt lgkmcnt(14)
    ds_read_b64 v[128:129], v8 offset:1216
    s_waitcnt lgkmcnt(14)
    ds_read_b64 v[130:131], v8 offset:1224
    v_mfma_f32_16x16x32_bf16 v[100:103], v[132:135], v[152:155], v[100:103]
    v_mfma_f32_16x16x32_bf16 v[104:107], v[132:135], v[156:159], v[104:107]
    s_waitcnt lgkmcnt(14)
    ds_read_b64 v[132:133], v8 offset:1728
    s_waitcnt lgkmcnt(14)
    ds_read_b64 v[134:135], v8 offset:1736
    v_mfma_f32_16x16x32_bf16 v[104:107], v[136:139], v[152:155], v[104:107]
    v_mfma_f32_16x16x32_bf16 v[108:111], v[136:139], v[156:159], v[108:111]
    s_waitcnt lgkmcnt(14)
    ds_read_b64 v[136:137], v8 offset:2240
    s_waitcnt lgkmcnt(14)
    ds_read_b64 v[138:139], v8 offset:2248
    v_mfma_f32_16x16x32_bf16 v[108:111], v[140:143], v[152:155], v[108:111]
    v_mfma_f32_16x16x32_bf16 v[112:115], v[140:143], v[156:159], v[112:115]
    s_waitcnt lgkmcnt(14)
    ds_read_b64 v[140:141], v8 offset:2752
    s_waitcnt lgkmcnt(14)
    ds_read_b64 v[142:143], v8 offset:2760
    v_mfma_f32_16x16x32_bf16 v[112:115], v[144:147], v[152:155], v[112:115]
    v_mfma_f32_16x16x32_bf16 v[116:119], v[144:147], v[156:159], v[116:119]
    s_waitcnt lgkmcnt(14)
    ds_read_b64 v[144:145], v8 offset:3264
    s_waitcnt lgkmcnt(14)
    ds_read_b64 v[146:147], v8 offset:3272
    v_mfma_f32_16x16x32_bf16 v[116:119], v[148:151], v[152:155], v[116:119]
    s_waitcnt lgkmcnt(14)
    ds_read_b64 v[148:149], v8 offset:3776
    s_waitcnt lgkmcnt(14)
    ds_read_b64 v[150:151], v8 offset:3784
    s_waitcnt lgkmcnt(14)
    v_mfma_f32_16x16x32_bf16 v[88:91], v[120:123], v[160:163], v[88:91]
    ds_read_b128 v[152:155], v9 offset:3840
    v_mfma_f32_16x16x32_bf16 v[92:95], v[120:123], v[164:167], v[92:95]
    s_waitcnt lgkmcnt(14)
    ds_read_b128 v[156:159], v9 offset:3328
    s_waitcnt lgkmcnt(14)
    ds_read_b64 v[120:121], v8 offset:256
    s_waitcnt lgkmcnt(14)
    ds_read_b64 v[122:123], v8 offset:264
    v_mfma_f32_16x16x32_bf16 v[92:95], v[124:127], v[160:163], v[92:95]
    v_mfma_f32_16x16x32_bf16 v[96:99], v[124:127], v[164:167], v[96:99]
    s_waitcnt lgkmcnt(14)
    ds_read_b64 v[124:125], v8 offset:768
    s_waitcnt lgkmcnt(14)
    ds_read_b64 v[126:127], v8 offset:776
    v_mfma_f32_16x16x32_bf16 v[96:99], v[128:131], v[160:163], v[96:99]
    v_mfma_f32_16x16x32_bf16 v[100:103], v[128:131], v[164:167], v[100:103]
    s_waitcnt lgkmcnt(14)
    ds_read_b64 v[128:129], v8 offset:1280
    s_waitcnt lgkmcnt(14)
    ds_read_b64 v[130:131], v8 offset:1288
    v_mfma_f32_16x16x32_bf16 v[100:103], v[132:135], v[160:163], v[100:103]
    v_mfma_f32_16x16x32_bf16 v[104:107], v[132:135], v[164:167], v[104:107]
    s_waitcnt lgkmcnt(14)
    ds_read_b64 v[132:133], v8 offset:1792
    s_waitcnt lgkmcnt(14)
    ds_read_b64 v[134:135], v8 offset:1800
    v_mfma_f32_16x16x32_bf16 v[104:107], v[136:139], v[160:163], v[104:107]
    v_mfma_f32_16x16x32_bf16 v[108:111], v[136:139], v[164:167], v[108:111]
    s_waitcnt lgkmcnt(14)
    ds_read_b64 v[136:137], v8 offset:2304
    s_waitcnt lgkmcnt(14)
    ds_read_b64 v[138:139], v8 offset:2312
    v_mfma_f32_16x16x32_bf16 v[108:111], v[140:143], v[160:163], v[108:111]
    v_mfma_f32_16x16x32_bf16 v[112:115], v[140:143], v[164:167], v[112:115]
    s_waitcnt lgkmcnt(14)
    ds_read_b64 v[140:141], v8 offset:2816
    s_waitcnt lgkmcnt(14)
    ds_read_b64 v[142:143], v8 offset:2824
    v_mfma_f32_16x16x32_bf16 v[112:115], v[144:147], v[160:163], v[112:115]
    v_mfma_f32_16x16x32_bf16 v[116:119], v[144:147], v[164:167], v[116:119]
    s_waitcnt lgkmcnt(14)
    ds_read_b64 v[144:145], v8 offset:3328
    s_waitcnt lgkmcnt(14)
    ds_read_b64 v[146:147], v8 offset:3336
    v_mfma_f32_16x16x32_bf16 v[116:119], v[148:151], v[160:163], v[116:119]
    s_waitcnt lgkmcnt(14)
    ds_read_b64 v[148:149], v8 offset:3840
    s_waitcnt lgkmcnt(14)
    ds_read_b64 v[150:151], v8 offset:3848
    s_waitcnt lgkmcnt(14)
    v_mfma_f32_16x16x32_bf16 v[88:91], v[120:123], v[152:155], v[88:91]
    ds_read_b128 v[160:163], v9 offset:3904
    v_mfma_f32_16x16x32_bf16 v[92:95], v[120:123], v[156:159], v[92:95]
    s_waitcnt lgkmcnt(14)
    ds_read_b128 v[164:167], v9 offset:3392
    s_waitcnt lgkmcnt(14)
    ds_read_b64 v[120:121], v8 offset:320
    s_waitcnt lgkmcnt(14)
    ds_read_b64 v[122:123], v8 offset:328
    v_mfma_f32_16x16x32_bf16 v[92:95], v[124:127], v[152:155], v[92:95]
    v_mfma_f32_16x16x32_bf16 v[96:99], v[124:127], v[156:159], v[96:99]
    s_waitcnt lgkmcnt(14)
    ds_read_b64 v[124:125], v8 offset:832
    s_waitcnt lgkmcnt(14)
    ds_read_b64 v[126:127], v8 offset:840
    v_mfma_f32_16x16x32_bf16 v[96:99], v[128:131], v[152:155], v[96:99]
    v_mfma_f32_16x16x32_bf16 v[100:103], v[128:131], v[156:159], v[100:103]
    s_waitcnt lgkmcnt(14)
    ds_read_b64 v[128:129], v8 offset:1344
    s_waitcnt lgkmcnt(14)
    ds_read_b64 v[130:131], v8 offset:1352
    v_mfma_f32_16x16x32_bf16 v[100:103], v[132:135], v[152:155], v[100:103]
    v_mfma_f32_16x16x32_bf16 v[104:107], v[132:135], v[156:159], v[104:107]
    s_waitcnt lgkmcnt(14)
    ds_read_b64 v[132:133], v8 offset:1856
    s_waitcnt lgkmcnt(14)
    ds_read_b64 v[134:135], v8 offset:1864
    v_mfma_f32_16x16x32_bf16 v[104:107], v[136:139], v[152:155], v[104:107]
    v_mfma_f32_16x16x32_bf16 v[108:111], v[136:139], v[156:159], v[108:111]
    s_waitcnt lgkmcnt(14)
    ds_read_b64 v[136:137], v8 offset:2368
    s_waitcnt lgkmcnt(14)
    ds_read_b64 v[138:139], v8 offset:2376
    v_mfma_f32_16x16x32_bf16 v[108:111], v[140:143], v[152:155], v[108:111]
    v_mfma_f32_16x16x32_bf16 v[112:115], v[140:143], v[156:159], v[112:115]
    s_waitcnt lgkmcnt(14)
    ds_read_b64 v[140:141], v8 offset:2880
    s_waitcnt lgkmcnt(14)
    ds_read_b64 v[142:143], v8 offset:2888
    v_mfma_f32_16x16x32_bf16 v[112:115], v[144:147], v[152:155], v[112:115]
    v_mfma_f32_16x16x32_bf16 v[116:119], v[144:147], v[156:159], v[116:119]
    s_waitcnt lgkmcnt(14)
    ds_read_b64 v[144:145], v8 offset:3392
    s_waitcnt lgkmcnt(14)
    ds_read_b64 v[146:147], v8 offset:3400
    v_mfma_f32_16x16x32_bf16 v[116:119], v[148:151], v[152:155], v[116:119]
    s_waitcnt lgkmcnt(14)
    ds_read_b64 v[148:149], v8 offset:3904
    s_waitcnt lgkmcnt(14)
    ds_read_b64 v[150:151], v8 offset:3912
    s_waitcnt lgkmcnt(14)
    v_mfma_f32_16x16x32_bf16 v[88:91], v[120:123], v[160:163], v[88:91]
    ds_read_b128 v[152:155], v9 offset:3968
    v_mfma_f32_16x16x32_bf16 v[92:95], v[120:123], v[164:167], v[92:95]
    s_waitcnt lgkmcnt(14)
    ds_read_b128 v[156:159], v9 offset:3456
    s_waitcnt lgkmcnt(14)
    ds_read_b64 v[120:121], v8 offset:384
    s_waitcnt lgkmcnt(14)
    ds_read_b64 v[122:123], v8 offset:392
    v_mfma_f32_16x16x32_bf16 v[92:95], v[124:127], v[160:163], v[92:95]
    v_mfma_f32_16x16x32_bf16 v[96:99], v[124:127], v[164:167], v[96:99]
    s_waitcnt lgkmcnt(14)
    ds_read_b64 v[124:125], v8 offset:896
    s_waitcnt lgkmcnt(14)
    ds_read_b64 v[126:127], v8 offset:904
    v_mfma_f32_16x16x32_bf16 v[96:99], v[128:131], v[160:163], v[96:99]
    v_mfma_f32_16x16x32_bf16 v[100:103], v[128:131], v[164:167], v[100:103]
    s_waitcnt lgkmcnt(14)
    ds_read_b64 v[128:129], v8 offset:1408
    s_waitcnt lgkmcnt(14)
    ds_read_b64 v[130:131], v8 offset:1416
    v_mfma_f32_16x16x32_bf16 v[100:103], v[132:135], v[160:163], v[100:103]
    v_mfma_f32_16x16x32_bf16 v[104:107], v[132:135], v[164:167], v[104:107]
    s_waitcnt lgkmcnt(14)
    ds_read_b64 v[132:133], v8 offset:1920
    s_waitcnt lgkmcnt(14)
    ds_read_b64 v[134:135], v8 offset:1928
    v_mfma_f32_16x16x32_bf16 v[104:107], v[136:139], v[160:163], v[104:107]
    v_mfma_f32_16x16x32_bf16 v[108:111], v[136:139], v[164:167], v[108:111]
    s_waitcnt lgkmcnt(14)
    ds_read_b64 v[136:137], v8 offset:2432
    s_waitcnt lgkmcnt(14)
    ds_read_b64 v[138:139], v8 offset:2440
    v_mfma_f32_16x16x32_bf16 v[108:111], v[140:143], v[160:163], v[108:111]
    v_mfma_f32_16x16x32_bf16 v[112:115], v[140:143], v[164:167], v[112:115]
    s_waitcnt lgkmcnt(14)
    ds_read_b64 v[140:141], v8 offset:2944
    s_waitcnt lgkmcnt(14)
    ds_read_b64 v[142:143], v8 offset:2952
    v_mfma_f32_16x16x32_bf16 v[112:115], v[144:147], v[160:163], v[112:115]
    v_mfma_f32_16x16x32_bf16 v[116:119], v[144:147], v[164:167], v[116:119]
    s_waitcnt lgkmcnt(14)
    ds_read_b64 v[144:145], v8 offset:3456
    s_waitcnt lgkmcnt(14)
    ds_read_b64 v[146:147], v8 offset:3464
    v_mfma_f32_16x16x32_bf16 v[116:119], v[148:151], v[160:163], v[116:119]
    s_waitcnt lgkmcnt(14)
    ds_read_b64 v[148:149], v8 offset:3968
    s_waitcnt lgkmcnt(14)
    ds_read_b64 v[150:151], v8 offset:3976
    s_waitcnt lgkmcnt(14)
    v_mfma_f32_16x16x32_bf16 v[88:91], v[120:123], v[152:155], v[88:91]
    ds_read_b128 v[160:163], v9 offset:4032
    v_mfma_f32_16x16x32_bf16 v[92:95], v[120:123], v[156:159], v[92:95]
    s_waitcnt lgkmcnt(14)
    ds_read_b128 v[164:167], v9 offset:3520
    s_waitcnt lgkmcnt(14)
    ds_read_b64 v[120:121], v8 offset:448
    s_waitcnt lgkmcnt(14)
    ds_read_b64 v[122:123], v8 offset:456
    v_mfma_f32_16x16x32_bf16 v[92:95], v[124:127], v[152:155], v[92:95]
    v_mfma_f32_16x16x32_bf16 v[96:99], v[124:127], v[156:159], v[96:99]
    s_waitcnt lgkmcnt(14)
    ds_read_b64 v[124:125], v8 offset:960
    s_waitcnt lgkmcnt(14)
    ds_read_b64 v[126:127], v8 offset:968
    v_mfma_f32_16x16x32_bf16 v[96:99], v[128:131], v[152:155], v[96:99]
    v_mfma_f32_16x16x32_bf16 v[100:103], v[128:131], v[156:159], v[100:103]
    s_waitcnt lgkmcnt(14)
    ds_read_b64 v[128:129], v8 offset:1472
    s_waitcnt lgkmcnt(14)
    ds_read_b64 v[130:131], v8 offset:1480
    v_mfma_f32_16x16x32_bf16 v[100:103], v[132:135], v[152:155], v[100:103]
    v_mfma_f32_16x16x32_bf16 v[104:107], v[132:135], v[156:159], v[104:107]
    s_waitcnt lgkmcnt(14)
    ds_read_b64 v[132:133], v8 offset:1984
    s_waitcnt lgkmcnt(14)
    ds_read_b64 v[134:135], v8 offset:1992
    v_mfma_f32_16x16x32_bf16 v[104:107], v[136:139], v[152:155], v[104:107]
    v_mfma_f32_16x16x32_bf16 v[108:111], v[136:139], v[156:159], v[108:111]
    s_waitcnt lgkmcnt(14)
    ds_read_b64 v[136:137], v8 offset:2496
    s_waitcnt lgkmcnt(14)
    ds_read_b64 v[138:139], v8 offset:2504
    v_mfma_f32_16x16x32_bf16 v[108:111], v[140:143], v[152:155], v[108:111]
    v_mfma_f32_16x16x32_bf16 v[112:115], v[140:143], v[156:159], v[112:115]
    s_waitcnt lgkmcnt(14)
    ds_read_b64 v[140:141], v8 offset:3008
    s_waitcnt lgkmcnt(14)
    ds_read_b64 v[142:143], v8 offset:3016
    v_mfma_f32_16x16x32_bf16 v[112:115], v[144:147], v[152:155], v[112:115]
    v_mfma_f32_16x16x32_bf16 v[116:119], v[144:147], v[156:159], v[116:119]
    s_waitcnt lgkmcnt(14)
    ds_read_b64 v[144:145], v8 offset:3520
    s_waitcnt lgkmcnt(14)
    ds_read_b64 v[146:147], v8 offset:3528
    v_mfma_f32_16x16x32_bf16 v[116:119], v[148:151], v[152:155], v[116:119]
    s_waitcnt lgkmcnt(14)
    ds_read_b64 v[148:149], v8 offset:4032
    s_waitcnt lgkmcnt(14)
    ds_read_b64 v[150:151], v8 offset:4040
    s_waitcnt lgkmcnt(14)
    v_mfma_f32_16x16x32_bf16 v[88:91], v[120:123], v[160:163], v[88:91]
    v_mfma_f32_16x16x32_bf16 v[92:95], v[120:123], v[164:167], v[92:95]
    s_waitcnt lgkmcnt(12)
    v_mfma_f32_16x16x32_bf16 v[92:95], v[124:127], v[160:163], v[92:95]
    v_mfma_f32_16x16x32_bf16 v[96:99], v[124:127], v[164:167], v[96:99]
    s_waitcnt lgkmcnt(10)
    v_mfma_f32_16x16x32_bf16 v[96:99], v[128:131], v[160:163], v[96:99]
    v_mfma_f32_16x16x32_bf16 v[100:103], v[128:131], v[164:167], v[100:103]
    s_waitcnt lgkmcnt(8)
    v_mfma_f32_16x16x32_bf16 v[100:103], v[132:135], v[160:163], v[100:103]
    v_mfma_f32_16x16x32_bf16 v[104:107], v[132:135], v[164:167], v[104:107]
    s_waitcnt lgkmcnt(6)
    v_mfma_f32_16x16x32_bf16 v[104:107], v[136:139], v[160:163], v[104:107]
    v_mfma_f32_16x16x32_bf16 v[108:111], v[136:139], v[164:167], v[108:111]
    s_waitcnt lgkmcnt(4)
    v_mfma_f32_16x16x32_bf16 v[108:111], v[140:143], v[160:163], v[108:111]
    v_mfma_f32_16x16x32_bf16 v[112:115], v[140:143], v[164:167], v[112:115]
    s_waitcnt lgkmcnt(2)
    v_mfma_f32_16x16x32_bf16 v[112:115], v[144:147], v[160:163], v[112:115]
    v_mfma_f32_16x16x32_bf16 v[116:119], v[144:147], v[164:167], v[116:119]
    s_waitcnt lgkmcnt(0)
    v_mfma_f32_16x16x32_bf16 v[116:119], v[148:151], v[160:163], v[116:119]
    s_waitcnt lgkmcnt(0)
    ds_read_b64 v[120:121], v8 offset:0
    ds_read_b64 v[122:123], v8 offset:8
    ds_read_b64 v[124:125], v8 offset:512
    ds_read_b64 v[126:127], v8 offset:520
    ds_read_b64 v[128:129], v8 offset:1024
    ds_read_b64 v[130:131], v8 offset:1032
    ds_read_b64 v[132:133], v8 offset:1536
    ds_read_b64 v[134:135], v8 offset:1544
    ds_read_b64 v[136:137], v8 offset:2048
    ds_read_b64 v[138:139], v8 offset:2056
    ds_read_b64 v[140:141], v8 offset:2560
    ds_read_b64 v[142:143], v8 offset:2568
    s_barrier
    ds_read_b128 v[152:155], v9 offset:2560
    ds_read_b128 v[156:159], v9 offset:2048
    s_waitcnt lgkmcnt(1)
    v_mfma_f32_16x16x32_bf16 v[96:99], v[120:123], v[152:155], v[96:99]
    ds_read_b128 v[160:163], v9 offset:2624
    s_waitcnt lgkmcnt(1)
    v_mfma_f32_16x16x32_bf16 v[100:103], v[120:123], v[156:159], v[100:103]
    ds_read_b128 v[164:167], v9 offset:2112
    ds_read_b64 v[120:121], v8 offset:64
    ds_read_b64 v[122:123], v8 offset:72
    v_mfma_f32_16x16x32_bf16 v[100:103], v[124:127], v[152:155], v[100:103]
    v_mfma_f32_16x16x32_bf16 v[104:107], v[124:127], v[156:159], v[104:107]
    ds_read_b64 v[124:125], v8 offset:576
    ds_read_b64 v[126:127], v8 offset:584
    v_mfma_f32_16x16x32_bf16 v[104:107], v[128:131], v[152:155], v[104:107]
    v_mfma_f32_16x16x32_bf16 v[108:111], v[128:131], v[156:159], v[108:111]
    ds_read_b64 v[128:129], v8 offset:1088
    ds_read_b64 v[130:131], v8 offset:1096
    v_mfma_f32_16x16x32_bf16 v[108:111], v[132:135], v[152:155], v[108:111]
    v_mfma_f32_16x16x32_bf16 v[112:115], v[132:135], v[156:159], v[112:115]
    ds_read_b64 v[132:133], v8 offset:1600
    ds_read_b64 v[134:135], v8 offset:1608
    v_mfma_f32_16x16x32_bf16 v[112:115], v[136:139], v[152:155], v[112:115]
    v_mfma_f32_16x16x32_bf16 v[116:119], v[136:139], v[156:159], v[116:119]
    ds_read_b64 v[136:137], v8 offset:2112
    ds_read_b64 v[138:139], v8 offset:2120
    v_mfma_f32_16x16x32_bf16 v[116:119], v[140:143], v[152:155], v[116:119]
    ds_read_b64 v[140:141], v8 offset:2624
    ds_read_b64 v[142:143], v8 offset:2632
    s_waitcnt lgkmcnt(10)
    v_mfma_f32_16x16x32_bf16 v[96:99], v[120:123], v[160:163], v[96:99]
    ds_read_b128 v[152:155], v9 offset:2688
    v_mfma_f32_16x16x32_bf16 v[100:103], v[120:123], v[164:167], v[100:103]
    ds_read_b128 v[156:159], v9 offset:2176
    ds_read_b64 v[120:121], v8 offset:128
    ds_read_b64 v[122:123], v8 offset:136
    s_waitcnt lgkmcnt(12)
    v_mfma_f32_16x16x32_bf16 v[100:103], v[124:127], v[160:163], v[100:103]
    v_mfma_f32_16x16x32_bf16 v[104:107], v[124:127], v[164:167], v[104:107]
    ds_read_b64 v[124:125], v8 offset:640
    ds_read_b64 v[126:127], v8 offset:648
    s_waitcnt lgkmcnt(12)
    v_mfma_f32_16x16x32_bf16 v[104:107], v[128:131], v[160:163], v[104:107]
    v_mfma_f32_16x16x32_bf16 v[108:111], v[128:131], v[164:167], v[108:111]
    ds_read_b64 v[128:129], v8 offset:1152
    ds_read_b64 v[130:131], v8 offset:1160
    s_waitcnt lgkmcnt(12)
    v_mfma_f32_16x16x32_bf16 v[108:111], v[132:135], v[160:163], v[108:111]
    v_mfma_f32_16x16x32_bf16 v[112:115], v[132:135], v[164:167], v[112:115]
    ds_read_b64 v[132:133], v8 offset:1664
    ds_read_b64 v[134:135], v8 offset:1672
    s_waitcnt lgkmcnt(12)
    v_mfma_f32_16x16x32_bf16 v[112:115], v[136:139], v[160:163], v[112:115]
    v_mfma_f32_16x16x32_bf16 v[116:119], v[136:139], v[164:167], v[116:119]
    ds_read_b64 v[136:137], v8 offset:2176
    ds_read_b64 v[138:139], v8 offset:2184
    s_waitcnt lgkmcnt(12)
    v_mfma_f32_16x16x32_bf16 v[116:119], v[140:143], v[160:163], v[116:119]
    ds_read_b64 v[140:141], v8 offset:2688
    ds_read_b64 v[142:143], v8 offset:2696
    s_waitcnt lgkmcnt(10)
    v_mfma_f32_16x16x32_bf16 v[96:99], v[120:123], v[152:155], v[96:99]
    ds_read_b128 v[160:163], v9 offset:2752
    v_mfma_f32_16x16x32_bf16 v[100:103], v[120:123], v[156:159], v[100:103]
    ds_read_b128 v[164:167], v9 offset:2240
    ds_read_b64 v[120:121], v8 offset:192
    ds_read_b64 v[122:123], v8 offset:200
    s_waitcnt lgkmcnt(12)
    v_mfma_f32_16x16x32_bf16 v[100:103], v[124:127], v[152:155], v[100:103]
    v_mfma_f32_16x16x32_bf16 v[104:107], v[124:127], v[156:159], v[104:107]
    ds_read_b64 v[124:125], v8 offset:704
    ds_read_b64 v[126:127], v8 offset:712
    s_waitcnt lgkmcnt(12)
    v_mfma_f32_16x16x32_bf16 v[104:107], v[128:131], v[152:155], v[104:107]
    v_mfma_f32_16x16x32_bf16 v[108:111], v[128:131], v[156:159], v[108:111]
    ds_read_b64 v[128:129], v8 offset:1216
    ds_read_b64 v[130:131], v8 offset:1224
    s_waitcnt lgkmcnt(12)
    v_mfma_f32_16x16x32_bf16 v[108:111], v[132:135], v[152:155], v[108:111]
    v_mfma_f32_16x16x32_bf16 v[112:115], v[132:135], v[156:159], v[112:115]
    ds_read_b64 v[132:133], v8 offset:1728
    ds_read_b64 v[134:135], v8 offset:1736
    s_waitcnt lgkmcnt(12)
    v_mfma_f32_16x16x32_bf16 v[112:115], v[136:139], v[152:155], v[112:115]
    v_mfma_f32_16x16x32_bf16 v[116:119], v[136:139], v[156:159], v[116:119]
    ds_read_b64 v[136:137], v8 offset:2240
    ds_read_b64 v[138:139], v8 offset:2248
    s_waitcnt lgkmcnt(12)
    v_mfma_f32_16x16x32_bf16 v[116:119], v[140:143], v[152:155], v[116:119]
    ds_read_b64 v[140:141], v8 offset:2752
    ds_read_b64 v[142:143], v8 offset:2760
    s_waitcnt lgkmcnt(10)
    v_mfma_f32_16x16x32_bf16 v[96:99], v[120:123], v[160:163], v[96:99]
    ds_read_b128 v[152:155], v9 offset:2816
    v_mfma_f32_16x16x32_bf16 v[100:103], v[120:123], v[164:167], v[100:103]
    ds_read_b128 v[156:159], v9 offset:2304
    ds_read_b64 v[120:121], v8 offset:256
    ds_read_b64 v[122:123], v8 offset:264
    s_waitcnt lgkmcnt(12)
    v_mfma_f32_16x16x32_bf16 v[100:103], v[124:127], v[160:163], v[100:103]
    v_mfma_f32_16x16x32_bf16 v[104:107], v[124:127], v[164:167], v[104:107]
    ds_read_b64 v[124:125], v8 offset:768
    ds_read_b64 v[126:127], v8 offset:776
    s_waitcnt lgkmcnt(12)
    v_mfma_f32_16x16x32_bf16 v[104:107], v[128:131], v[160:163], v[104:107]
    v_mfma_f32_16x16x32_bf16 v[108:111], v[128:131], v[164:167], v[108:111]
    ds_read_b64 v[128:129], v8 offset:1280
    ds_read_b64 v[130:131], v8 offset:1288
    s_waitcnt lgkmcnt(12)
    v_mfma_f32_16x16x32_bf16 v[108:111], v[132:135], v[160:163], v[108:111]
    v_mfma_f32_16x16x32_bf16 v[112:115], v[132:135], v[164:167], v[112:115]
    ds_read_b64 v[132:133], v8 offset:1792
    ds_read_b64 v[134:135], v8 offset:1800
    s_waitcnt lgkmcnt(12)
    v_mfma_f32_16x16x32_bf16 v[112:115], v[136:139], v[160:163], v[112:115]
    v_mfma_f32_16x16x32_bf16 v[116:119], v[136:139], v[164:167], v[116:119]
    ds_read_b64 v[136:137], v8 offset:2304
    ds_read_b64 v[138:139], v8 offset:2312
    s_waitcnt lgkmcnt(12)
    v_mfma_f32_16x16x32_bf16 v[116:119], v[140:143], v[160:163], v[116:119]
    ds_read_b64 v[140:141], v8 offset:2816
    ds_read_b64 v[142:143], v8 offset:2824
    s_waitcnt lgkmcnt(10)
    v_mfma_f32_16x16x32_bf16 v[96:99], v[120:123], v[152:155], v[96:99]
    ds_read_b128 v[160:163], v9 offset:2880
    v_mfma_f32_16x16x32_bf16 v[100:103], v[120:123], v[156:159], v[100:103]
    ds_read_b128 v[164:167], v9 offset:2368
    ds_read_b64 v[120:121], v8 offset:320
    ds_read_b64 v[122:123], v8 offset:328
    s_waitcnt lgkmcnt(12)
    v_mfma_f32_16x16x32_bf16 v[100:103], v[124:127], v[152:155], v[100:103]
    v_mfma_f32_16x16x32_bf16 v[104:107], v[124:127], v[156:159], v[104:107]
    ds_read_b64 v[124:125], v8 offset:832
    ds_read_b64 v[126:127], v8 offset:840
    s_waitcnt lgkmcnt(12)
    v_mfma_f32_16x16x32_bf16 v[104:107], v[128:131], v[152:155], v[104:107]
    v_mfma_f32_16x16x32_bf16 v[108:111], v[128:131], v[156:159], v[108:111]
    ds_read_b64 v[128:129], v8 offset:1344
    ds_read_b64 v[130:131], v8 offset:1352
    s_waitcnt lgkmcnt(12)
    v_mfma_f32_16x16x32_bf16 v[108:111], v[132:135], v[152:155], v[108:111]
    v_mfma_f32_16x16x32_bf16 v[112:115], v[132:135], v[156:159], v[112:115]
    ds_read_b64 v[132:133], v8 offset:1856
    ds_read_b64 v[134:135], v8 offset:1864
    s_waitcnt lgkmcnt(12)
    v_mfma_f32_16x16x32_bf16 v[112:115], v[136:139], v[152:155], v[112:115]
    v_mfma_f32_16x16x32_bf16 v[116:119], v[136:139], v[156:159], v[116:119]
    ds_read_b64 v[136:137], v8 offset:2368
    ds_read_b64 v[138:139], v8 offset:2376
    s_waitcnt lgkmcnt(12)
    v_mfma_f32_16x16x32_bf16 v[116:119], v[140:143], v[152:155], v[116:119]
    ds_read_b64 v[140:141], v8 offset:2880
    ds_read_b64 v[142:143], v8 offset:2888
    s_waitcnt lgkmcnt(10)
    v_mfma_f32_16x16x32_bf16 v[96:99], v[120:123], v[160:163], v[96:99]
    ds_read_b128 v[152:155], v9 offset:2944
    v_mfma_f32_16x16x32_bf16 v[100:103], v[120:123], v[164:167], v[100:103]
    ds_read_b128 v[156:159], v9 offset:2432
    ds_read_b64 v[120:121], v8 offset:384
    ds_read_b64 v[122:123], v8 offset:392
    s_waitcnt lgkmcnt(12)
    v_mfma_f32_16x16x32_bf16 v[100:103], v[124:127], v[160:163], v[100:103]
    v_mfma_f32_16x16x32_bf16 v[104:107], v[124:127], v[164:167], v[104:107]
    ds_read_b64 v[124:125], v8 offset:896
    ds_read_b64 v[126:127], v8 offset:904
    s_waitcnt lgkmcnt(12)
    v_mfma_f32_16x16x32_bf16 v[104:107], v[128:131], v[160:163], v[104:107]
    v_mfma_f32_16x16x32_bf16 v[108:111], v[128:131], v[164:167], v[108:111]
    ds_read_b64 v[128:129], v8 offset:1408
    ds_read_b64 v[130:131], v8 offset:1416
    s_waitcnt lgkmcnt(12)
    v_mfma_f32_16x16x32_bf16 v[108:111], v[132:135], v[160:163], v[108:111]
    v_mfma_f32_16x16x32_bf16 v[112:115], v[132:135], v[164:167], v[112:115]
    ds_read_b64 v[132:133], v8 offset:1920
    ds_read_b64 v[134:135], v8 offset:1928
    s_waitcnt lgkmcnt(12)
    v_mfma_f32_16x16x32_bf16 v[112:115], v[136:139], v[160:163], v[112:115]
    v_mfma_f32_16x16x32_bf16 v[116:119], v[136:139], v[164:167], v[116:119]
    ds_read_b64 v[136:137], v8 offset:2432
    ds_read_b64 v[138:139], v8 offset:2440
    s_waitcnt lgkmcnt(12)
    v_mfma_f32_16x16x32_bf16 v[116:119], v[140:143], v[160:163], v[116:119]
    ds_read_b64 v[140:141], v8 offset:2944
    ds_read_b64 v[142:143], v8 offset:2952
    s_waitcnt lgkmcnt(10)
    v_mfma_f32_16x16x32_bf16 v[96:99], v[120:123], v[152:155], v[96:99]
    ds_read_b128 v[160:163], v9 offset:3008
    v_mfma_f32_16x16x32_bf16 v[100:103], v[120:123], v[156:159], v[100:103]
    ds_read_b128 v[164:167], v9 offset:2496
    ds_read_b64 v[120:121], v8 offset:448
    ds_read_b64 v[122:123], v8 offset:456
    s_waitcnt lgkmcnt(12)
    v_mfma_f32_16x16x32_bf16 v[100:103], v[124:127], v[152:155], v[100:103]
    v_mfma_f32_16x16x32_bf16 v[104:107], v[124:127], v[156:159], v[104:107]
    ds_read_b64 v[124:125], v8 offset:960
    ds_read_b64 v[126:127], v8 offset:968
    s_waitcnt lgkmcnt(12)
    v_mfma_f32_16x16x32_bf16 v[104:107], v[128:131], v[152:155], v[104:107]
    v_mfma_f32_16x16x32_bf16 v[108:111], v[128:131], v[156:159], v[108:111]
    ds_read_b64 v[128:129], v8 offset:1472
    ds_read_b64 v[130:131], v8 offset:1480
    s_waitcnt lgkmcnt(12)
    v_mfma_f32_16x16x32_bf16 v[108:111], v[132:135], v[152:155], v[108:111]
    v_mfma_f32_16x16x32_bf16 v[112:115], v[132:135], v[156:159], v[112:115]
    ds_read_b64 v[132:133], v8 offset:1984
    ds_read_b64 v[134:135], v8 offset:1992
    s_waitcnt lgkmcnt(12)
    v_mfma_f32_16x16x32_bf16 v[112:115], v[136:139], v[152:155], v[112:115]
    v_mfma_f32_16x16x32_bf16 v[116:119], v[136:139], v[156:159], v[116:119]
    ds_read_b64 v[136:137], v8 offset:2496
    ds_read_b64 v[138:139], v8 offset:2504
    s_waitcnt lgkmcnt(12)
    v_mfma_f32_16x16x32_bf16 v[116:119], v[140:143], v[152:155], v[116:119]
    ds_read_b64 v[140:141], v8 offset:3008
    ds_read_b64 v[142:143], v8 offset:3016
    s_waitcnt lgkmcnt(10)
    v_mfma_f32_16x16x32_bf16 v[96:99], v[120:123], v[160:163], v[96:99]
    v_mfma_f32_16x16x32_bf16 v[100:103], v[120:123], v[164:167], v[100:103]
    s_waitcnt lgkmcnt(8)
    v_mfma_f32_16x16x32_bf16 v[100:103], v[124:127], v[160:163], v[100:103]
    v_mfma_f32_16x16x32_bf16 v[104:107], v[124:127], v[164:167], v[104:107]
    s_waitcnt lgkmcnt(6)
    v_mfma_f32_16x16x32_bf16 v[104:107], v[128:131], v[160:163], v[104:107]
    v_mfma_f32_16x16x32_bf16 v[108:111], v[128:131], v[164:167], v[108:111]
    s_waitcnt lgkmcnt(4)
    v_mfma_f32_16x16x32_bf16 v[108:111], v[132:135], v[160:163], v[108:111]
    v_mfma_f32_16x16x32_bf16 v[112:115], v[132:135], v[164:167], v[112:115]
    s_waitcnt lgkmcnt(2)
    v_mfma_f32_16x16x32_bf16 v[112:115], v[136:139], v[160:163], v[112:115]
    v_mfma_f32_16x16x32_bf16 v[116:119], v[136:139], v[164:167], v[116:119]
    s_waitcnt lgkmcnt(0)
    v_mfma_f32_16x16x32_bf16 v[116:119], v[140:143], v[160:163], v[116:119]
    s_waitcnt lgkmcnt(0)
    ds_read_b64 v[120:121], v8 offset:0
    ds_read_b64 v[122:123], v8 offset:8
    ds_read_b64 v[124:125], v8 offset:512
    ds_read_b64 v[126:127], v8 offset:520
    ds_read_b64 v[128:129], v8 offset:1024
    ds_read_b64 v[130:131], v8 offset:1032
    ds_read_b64 v[132:133], v8 offset:1536
    ds_read_b64 v[134:135], v8 offset:1544
    s_barrier
    ds_read_b128 v[152:155], v9 offset:1536
    ds_read_b128 v[156:159], v9 offset:1024
    s_waitcnt lgkmcnt(1)
    v_mfma_f32_16x16x32_bf16 v[104:107], v[120:123], v[152:155], v[104:107]
    ds_read_b128 v[160:163], v9 offset:1600
    buffer_load_dwordx4 v2, s[64:67], 0 offen lds
    s_waitcnt lgkmcnt(1)
    v_mfma_f32_16x16x32_bf16 v[108:111], v[120:123], v[156:159], v[108:111]
    ds_read_b128 v[164:167], v9 offset:1088
    ds_read_b64 v[120:121], v8 offset:64
    ds_read_b64 v[122:123], v8 offset:72
    v_mfma_f32_16x16x32_bf16 v[108:111], v[124:127], v[152:155], v[108:111]
    v_mfma_f32_16x16x32_bf16 v[112:115], v[124:127], v[156:159], v[112:115]
    ds_read_b64 v[124:125], v8 offset:576
    ds_read_b64 v[126:127], v8 offset:584
    v_mfma_f32_16x16x32_bf16 v[112:115], v[128:131], v[152:155], v[112:115]
    v_mfma_f32_16x16x32_bf16 v[116:119], v[128:131], v[156:159], v[116:119]
    v_add_u32 v2, 0x1000, v2
    s_add_u32 m0, m0, 4096
    s_nop 0
    buffer_load_dwordx4 v2, s[64:67], 0 offen lds
    ds_read_b64 v[128:129], v8 offset:1088
    ds_read_b64 v[130:131], v8 offset:1096
    v_mfma_f32_16x16x32_bf16 v[116:119], v[132:135], v[152:155], v[116:119]
    ds_read_b64 v[132:133], v8 offset:1600
    ds_read_b64 v[134:135], v8 offset:1608
    s_waitcnt lgkmcnt(6)
    v_mfma_f32_16x16x32_bf16 v[104:107], v[120:123], v[160:163], v[104:107]
    ds_read_b128 v[152:155], v9 offset:1664
    v_mfma_f32_16x16x32_bf16 v[108:111], v[120:123], v[164:167], v[108:111]
    ds_read_b128 v[156:159], v9 offset:1152
    ds_read_b64 v[120:121], v8 offset:128
    ds_read_b64 v[122:123], v8 offset:136
    s_waitcnt lgkmcnt(8)
    v_mfma_f32_16x16x32_bf16 v[108:111], v[124:127], v[160:163], v[108:111]
    v_mfma_f32_16x16x32_bf16 v[112:115], v[124:127], v[164:167], v[112:115]
    v_add_u32 v2, 0x1000, v2
    s_add_u32 m0, m0, 4096
    s_nop 0
    buffer_load_dwordx4 v2, s[64:67], 0 offen lds
    ds_read_b64 v[124:125], v8 offset:640
    ds_read_b64 v[126:127], v8 offset:648
    s_waitcnt lgkmcnt(8)
    v_mfma_f32_16x16x32_bf16 v[112:115], v[128:131], v[160:163], v[112:115]
    v_mfma_f32_16x16x32_bf16 v[116:119], v[128:131], v[164:167], v[116:119]
    ds_read_b64 v[128:129], v8 offset:1152
    ds_read_b64 v[130:131], v8 offset:1160
    s_waitcnt lgkmcnt(8)
    v_mfma_f32_16x16x32_bf16 v[116:119], v[132:135], v[160:163], v[116:119]
    ds_read_b64 v[132:133], v8 offset:1664
    ds_read_b64 v[134:135], v8 offset:1672
    s_waitcnt lgkmcnt(6)
    v_mfma_f32_16x16x32_bf16 v[104:107], v[120:123], v[152:155], v[104:107]
    ds_read_b128 v[160:163], v9 offset:1728
    v_mfma_f32_16x16x32_bf16 v[108:111], v[120:123], v[156:159], v[108:111]
    ds_read_b128 v[164:167], v9 offset:1216
    v_add_u32 v2, 0x1000, v2
    s_add_u32 m0, m0, 4096
    s_nop 0
    buffer_load_dwordx4 v2, s[64:67], 0 offen lds
    ds_read_b64 v[120:121], v8 offset:192
    ds_read_b64 v[122:123], v8 offset:200
    s_waitcnt lgkmcnt(8)
    v_mfma_f32_16x16x32_bf16 v[108:111], v[124:127], v[152:155], v[108:111]
    v_mfma_f32_16x16x32_bf16 v[112:115], v[124:127], v[156:159], v[112:115]
    ds_read_b64 v[124:125], v8 offset:704
    ds_read_b64 v[126:127], v8 offset:712
    s_waitcnt lgkmcnt(8)
    v_mfma_f32_16x16x32_bf16 v[112:115], v[128:131], v[152:155], v[112:115]
    v_mfma_f32_16x16x32_bf16 v[116:119], v[128:131], v[156:159], v[116:119]
    ds_read_b64 v[128:129], v8 offset:1216
    ds_read_b64 v[130:131], v8 offset:1224
    s_waitcnt lgkmcnt(8)
    v_mfma_f32_16x16x32_bf16 v[116:119], v[132:135], v[152:155], v[116:119]
    v_add_u32 v2, 0x1000, v2
    s_add_u32 m0, m0, 4096
    s_nop 0
    buffer_load_dwordx4 v2, s[64:67], 0 offen lds
    ds_read_b64 v[132:133], v8 offset:1728
    ds_read_b64 v[134:135], v8 offset:1736
    s_waitcnt lgkmcnt(6)
    v_mfma_f32_16x16x32_bf16 v[104:107], v[120:123], v[160:163], v[104:107]
    ds_read_b128 v[152:155], v9 offset:1792
    v_mfma_f32_16x16x32_bf16 v[108:111], v[120:123], v[164:167], v[108:111]
    ds_read_b128 v[156:159], v9 offset:1280
    ds_read_b64 v[120:121], v8 offset:256
    ds_read_b64 v[122:123], v8 offset:264
    s_waitcnt lgkmcnt(8)
    v_mfma_f32_16x16x32_bf16 v[108:111], v[124:127], v[160:163], v[108:111]
    v_mfma_f32_16x16x32_bf16 v[112:115], v[124:127], v[164:167], v[112:115]
    ds_read_b64 v[124:125], v8 offset:768
    ds_read_b64 v[126:127], v8 offset:776
    s_waitcnt lgkmcnt(8)
    v_mfma_f32_16x16x32_bf16 v[112:115], v[128:131], v[160:163], v[112:115]
    v_add_u32 v2, 0x1000, v2
    s_add_u32 m0, m0, 4096
    s_nop 0
    buffer_load_dwordx4 v2, s[64:67], 0 offen lds
    v_mfma_f32_16x16x32_bf16 v[116:119], v[128:131], v[164:167], v[116:119]
    ds_read_b64 v[128:129], v8 offset:1280
    ds_read_b64 v[130:131], v8 offset:1288
    s_waitcnt lgkmcnt(8)
    v_mfma_f32_16x16x32_bf16 v[116:119], v[132:135], v[160:163], v[116:119]
    ds_read_b64 v[132:133], v8 offset:1792
    ds_read_b64 v[134:135], v8 offset:1800
    s_waitcnt lgkmcnt(6)
    v_mfma_f32_16x16x32_bf16 v[104:107], v[120:123], v[152:155], v[104:107]
    ds_read_b128 v[160:163], v9 offset:1856
    v_mfma_f32_16x16x32_bf16 v[108:111], v[120:123], v[156:159], v[108:111]
    ds_read_b128 v[164:167], v9 offset:1344
    ds_read_b64 v[120:121], v8 offset:320
    ds_read_b64 v[122:123], v8 offset:328
    s_waitcnt lgkmcnt(8)
    v_mfma_f32_16x16x32_bf16 v[108:111], v[124:127], v[152:155], v[108:111]
    v_add_u32 v2, 0x1000, v2
    s_add_u32 m0, m0, 4096
    s_nop 0
    buffer_load_dwordx4 v2, s[64:67], 0 offen lds
    v_mfma_f32_16x16x32_bf16 v[112:115], v[124:127], v[156:159], v[112:115]
    ds_read_b64 v[124:125], v8 offset:832
    ds_read_b64 v[126:127], v8 offset:840
    s_waitcnt lgkmcnt(8)
    v_mfma_f32_16x16x32_bf16 v[112:115], v[128:131], v[152:155], v[112:115]
    v_mfma_f32_16x16x32_bf16 v[116:119], v[128:131], v[156:159], v[116:119]
    ds_read_b64 v[128:129], v8 offset:1344
    ds_read_b64 v[130:131], v8 offset:1352
    s_waitcnt lgkmcnt(8)
    v_mfma_f32_16x16x32_bf16 v[116:119], v[132:135], v[152:155], v[116:119]
    ds_read_b64 v[132:133], v8 offset:1856
    ds_read_b64 v[134:135], v8 offset:1864
    s_waitcnt lgkmcnt(6)
    v_mfma_f32_16x16x32_bf16 v[104:107], v[120:123], v[160:163], v[104:107]
    ds_read_b128 v[152:155], v9 offset:1920
    v_add_u32 v2, 0x1000, v2
    s_add_u32 m0, m0, 4096
    s_nop 0
    buffer_load_dwordx4 v2, s[64:67], 0 offen lds
    v_mfma_f32_16x16x32_bf16 v[108:111], v[120:123], v[164:167], v[108:111]
    ds_read_b128 v[156:159], v9 offset:1408
    ds_read_b64 v[120:121], v8 offset:384
    ds_read_b64 v[122:123], v8 offset:392
    s_waitcnt lgkmcnt(8)
    v_mfma_f32_16x16x32_bf16 v[108:111], v[124:127], v[160:163], v[108:111]
    v_mfma_f32_16x16x32_bf16 v[112:115], v[124:127], v[164:167], v[112:115]
    ds_read_b64 v[124:125], v8 offset:896
    ds_read_b64 v[126:127], v8 offset:904
    s_waitcnt lgkmcnt(8)
    v_mfma_f32_16x16x32_bf16 v[112:115], v[128:131], v[160:163], v[112:115]
    v_mfma_f32_16x16x32_bf16 v[116:119], v[128:131], v[164:167], v[116:119]
    v_add_u32 v2, 0x1000, v2
    s_add_u32 m0, m0, 4096
    s_nop 0
    buffer_load_dwordx4 v2, s[64:67], 0 offen lds
    ds_read_b64 v[128:129], v8 offset:1408
    ds_read_b64 v[130:131], v8 offset:1416
    s_waitcnt lgkmcnt(8)
    v_mfma_f32_16x16x32_bf16 v[116:119], v[132:135], v[160:163], v[116:119]
    ds_read_b64 v[132:133], v8 offset:1920
    ds_read_b64 v[134:135], v8 offset:1928
    s_waitcnt lgkmcnt(6)
    v_mfma_f32_16x16x32_bf16 v[104:107], v[120:123], v[152:155], v[104:107]
    ds_read_b128 v[160:163], v9 offset:1984
    v_mfma_f32_16x16x32_bf16 v[108:111], v[120:123], v[156:159], v[108:111]
    ds_read_b128 v[164:167], v9 offset:1472
    ds_read_b64 v[120:121], v8 offset:448
    ds_read_b64 v[122:123], v8 offset:456
    s_waitcnt lgkmcnt(8)
    v_mfma_f32_16x16x32_bf16 v[108:111], v[124:127], v[152:155], v[108:111]
    v_mfma_f32_16x16x32_bf16 v[112:115], v[124:127], v[156:159], v[112:115]
    ds_read_b64 v[124:125], v8 offset:960
    ds_read_b64 v[126:127], v8 offset:968
    s_waitcnt lgkmcnt(8)
    v_mfma_f32_16x16x32_bf16 v[112:115], v[128:131], v[152:155], v[112:115]
    v_mfma_f32_16x16x32_bf16 v[116:119], v[128:131], v[156:159], v[116:119]
    ds_read_b64 v[128:129], v8 offset:1472
    ds_read_b64 v[130:131], v8 offset:1480
    s_waitcnt lgkmcnt(8)
    v_mfma_f32_16x16x32_bf16 v[116:119], v[132:135], v[152:155], v[116:119]
    ds_read_b64 v[132:133], v8 offset:1984
    ds_read_b64 v[134:135], v8 offset:1992
    s_waitcnt lgkmcnt(6)
    v_mfma_f32_16x16x32_bf16 v[104:107], v[120:123], v[160:163], v[104:107]
    v_mfma_f32_16x16x32_bf16 v[108:111], v[120:123], v[164:167], v[108:111]
    s_waitcnt lgkmcnt(4)
    v_mfma_f32_16x16x32_bf16 v[108:111], v[124:127], v[160:163], v[108:111]
    v_mfma_f32_16x16x32_bf16 v[112:115], v[124:127], v[164:167], v[112:115]
    s_waitcnt lgkmcnt(2)
    v_mfma_f32_16x16x32_bf16 v[112:115], v[128:131], v[160:163], v[112:115]
    v_mfma_f32_16x16x32_bf16 v[116:119], v[128:131], v[164:167], v[116:119]
    s_waitcnt lgkmcnt(0)
    v_mfma_f32_16x16x32_bf16 v[116:119], v[132:135], v[160:163], v[116:119]
    s_waitcnt lgkmcnt(0)
    ds_read_b64 v[120:121], v8 offset:0
    ds_read_b64 v[122:123], v8 offset:8
    ds_read_b64 v[124:125], v8 offset:512
    ds_read_b64 v[126:127], v8 offset:520
    s_barrier
    ds_read_b128 v[152:155], v9 offset:512
    ds_read_b128 v[156:159], v9 offset:0
    s_waitcnt lgkmcnt(1)
    v_mfma_f32_16x16x32_bf16 v[112:115], v[120:123], v[152:155], v[112:115]
    ds_read_b128 v[160:163], v9 offset:576
    s_waitcnt lgkmcnt(1)
    v_mfma_f32_16x16x32_bf16 v[116:119], v[120:123], v[156:159], v[116:119]
    ds_read_b128 v[164:167], v9 offset:64
    ds_read_b64 v[120:121], v8 offset:64
    ds_read_b64 v[122:123], v8 offset:72
    v_mfma_f32_16x16x32_bf16 v[116:119], v[124:127], v[152:155], v[116:119]
    ds_read_b64 v[124:125], v8 offset:576
    ds_read_b64 v[126:127], v8 offset:584
    s_waitcnt lgkmcnt(2)
    v_mfma_f32_16x16x32_bf16 v[112:115], v[120:123], v[160:163], v[112:115]
    ds_read_b128 v[152:155], v9 offset:640
    v_mfma_f32_16x16x32_bf16 v[116:119], v[120:123], v[164:167], v[116:119]
    ds_read_b128 v[156:159], v9 offset:128
    ds_read_b64 v[120:121], v8 offset:128
    ds_read_b64 v[122:123], v8 offset:136
    s_waitcnt lgkmcnt(4)
    v_mfma_f32_16x16x32_bf16 v[116:119], v[124:127], v[160:163], v[116:119]
    ds_read_b64 v[124:125], v8 offset:640
    ds_read_b64 v[126:127], v8 offset:648
    s_waitcnt lgkmcnt(2)
    v_mfma_f32_16x16x32_bf16 v[112:115], v[120:123], v[152:155], v[112:115]
    ds_read_b128 v[160:163], v9 offset:704
    v_mfma_f32_16x16x32_bf16 v[116:119], v[120:123], v[156:159], v[116:119]
    ds_read_b128 v[164:167], v9 offset:192
    ds_read_b64 v[120:121], v8 offset:192
    ds_read_b64 v[122:123], v8 offset:200
    s_waitcnt lgkmcnt(4)
    v_mfma_f32_16x16x32_bf16 v[116:119], v[124:127], v[152:155], v[116:119]
    ds_read_b64 v[124:125], v8 offset:704
    ds_read_b64 v[126:127], v8 offset:712
    s_waitcnt lgkmcnt(2)
    v_mfma_f32_16x16x32_bf16 v[112:115], v[120:123], v[160:163], v[112:115]
    ds_read_b128 v[152:155], v9 offset:768
    v_mfma_f32_16x16x32_bf16 v[116:119], v[120:123], v[164:167], v[116:119]
    ds_read_b128 v[156:159], v9 offset:256
    ds_read_b64 v[120:121], v8 offset:256
    ds_read_b64 v[122:123], v8 offset:264
    s_waitcnt lgkmcnt(4)
    v_mfma_f32_16x16x32_bf16 v[116:119], v[124:127], v[160:163], v[116:119]
    ds_read_b64 v[124:125], v8 offset:768
    ds_read_b64 v[126:127], v8 offset:776
    s_waitcnt lgkmcnt(2)
    v_mfma_f32_16x16x32_bf16 v[112:115], v[120:123], v[152:155], v[112:115]
    ds_read_b128 v[160:163], v9 offset:832
    v_mfma_f32_16x16x32_bf16 v[116:119], v[120:123], v[156:159], v[116:119]
    ds_read_b128 v[164:167], v9 offset:320
    ds_read_b64 v[120:121], v8 offset:320
    ds_read_b64 v[122:123], v8 offset:328
    s_waitcnt lgkmcnt(4)
    v_mfma_f32_16x16x32_bf16 v[116:119], v[124:127], v[152:155], v[116:119]
    ds_read_b64 v[124:125], v8 offset:832
    ds_read_b64 v[126:127], v8 offset:840
    s_waitcnt lgkmcnt(2)
    v_mfma_f32_16x16x32_bf16 v[112:115], v[120:123], v[160:163], v[112:115]
    ds_read_b128 v[152:155], v9 offset:896
    v_mfma_f32_16x16x32_bf16 v[116:119], v[120:123], v[164:167], v[116:119]
    ds_read_b128 v[156:159], v9 offset:384
    ds_read_b64 v[120:121], v8 offset:384
    ds_read_b64 v[122:123], v8 offset:392
    s_waitcnt lgkmcnt(4)
    v_mfma_f32_16x16x32_bf16 v[116:119], v[124:127], v[160:163], v[116:119]
    ds_read_b64 v[124:125], v8 offset:896
    ds_read_b64 v[126:127], v8 offset:904
    s_waitcnt lgkmcnt(2)
    v_mfma_f32_16x16x32_bf16 v[112:115], v[120:123], v[152:155], v[112:115]
    ds_read_b128 v[160:163], v9 offset:960
    v_mfma_f32_16x16x32_bf16 v[116:119], v[120:123], v[156:159], v[116:119]
    ds_read_b128 v[164:167], v9 offset:448
    ds_read_b64 v[120:121], v8 offset:448
    ds_read_b64 v[122:123], v8 offset:456
    s_waitcnt lgkmcnt(4)
    v_mfma_f32_16x16x32_bf16 v[116:119], v[124:127], v[152:155], v[116:119]
    ds_read_b64 v[124:125], v8 offset:960
    ds_read_b64 v[126:127], v8 offset:968
    s_waitcnt lgkmcnt(2)
    v_mfma_f32_16x16x32_bf16 v[112:115], v[120:123], v[160:163], v[112:115]
    v_mfma_f32_16x16x32_bf16 v[116:119], v[120:123], v[164:167], v[116:119]
    s_waitcnt lgkmcnt(0)
    v_mfma_f32_16x16x32_bf16 v[116:119], v[124:127], v[160:163], v[116:119]
    ds_read_b64 v[16:17], v10 offset:3584
    ds_read_b64 v[18:19], v10 offset:3072
    ds_read_b64 v[20:21], v10 offset:2560
    ds_read_b64 v[22:23], v10 offset:2048
    ds_read_b64 v[24:25], v10 offset:1536
    ds_read_b64 v[26:27], v10 offset:1024
    ds_read_b64 v[28:29], v10 offset:512
    ds_read_b64 v[30:31], v10 offset:0
    s_mul_i32 s57, s3, 16704
    v_add_u32 v7, s57, v7
    s_waitcnt lgkmcnt(7)
    v_lshlrev_b32 v43, 16, v16
    v_and_b32 v42, 0xffff0000, v16
    v_lshlrev_b32 v41, 16, v17
    v_and_b32 v40, 0xffff0000, v17
    v_fma_f32 v40, v40, s56, v88
    v_fma_f32 v41, v41, s56, v89
    v_fma_f32 v42, v42, s56, v90
    v_fma_f32 v43, v43, s56, v91
    v_cvt_pk_bf16_f32 v44, v40, v42
    v_cvt_pk_bf16_f32 v45, v41, v43
    ds_write2_b32 v7, v44, v45 offset0:0 offset1:8
    s_waitcnt lgkmcnt(7)
    v_lshlrev_b32 v51, 16, v18
    v_and_b32 v50, 0xffff0000, v18
    v_lshlrev_b32 v49, 16, v19
    v_and_b32 v48, 0xffff0000, v19
    v_fma_f32 v48, v48, s56, v92
    v_fma_f32 v49, v49, s56, v93
    v_fma_f32 v50, v50, s56, v94
    v_fma_f32 v51, v51, s56, v95
    v_cvt_pk_bf16_f32 v52, v48, v50
    v_cvt_pk_bf16_f32 v53, v49, v51
    ds_write2_b32 v7, v52, v53 offset0:128 offset1:136
    v_add_u32 v7, 0x400, v7
    s_waitcnt lgkmcnt(7)
    v_lshlrev_b32 v43, 16, v20
    v_and_b32 v42, 0xffff0000, v20
    v_lshlrev_b32 v41, 16, v21
    v_and_b32 v40, 0xffff0000, v21
    v_fma_f32 v40, v40, s56, v96
    v_fma_f32 v41, v41, s56, v97
    v_fma_f32 v42, v42, s56, v98
    v_fma_f32 v43, v43, s56, v99
    v_cvt_pk_bf16_f32 v44, v40, v42
    v_cvt_pk_bf16_f32 v45, v41, v43
    ds_write2_b32 v7, v44, v45 offset0:0 offset1:8
    s_waitcnt lgkmcnt(7)
    v_lshlrev_b32 v51, 16, v22
    v_and_b32 v50, 0xffff0000, v22
    v_lshlrev_b32 v49, 16, v23
    v_and_b32 v48, 0xffff0000, v23
    v_fma_f32 v48, v48, s56, v100
    v_fma_f32 v49, v49, s56, v101
    v_fma_f32 v50, v50, s56, v102
    v_fma_f32 v51, v51, s56, v103
    v_cvt_pk_bf16_f32 v52, v48, v50
    v_cvt_pk_bf16_f32 v53, v49, v51
    ds_write2_b32 v7, v52, v53 offset0:128 offset1:136
    v_add_u32 v7, 0x400, v7
    s_waitcnt lgkmcnt(7)
    v_lshlrev_b32 v43, 16, v24
    v_and_b32 v42, 0xffff0000, v24
    v_lshlrev_b32 v41, 16, v25
    v_and_b32 v40, 0xffff0000, v25
    v_fma_f32 v40, v40, s56, v104
    v_fma_f32 v41, v41, s56, v105
    v_fma_f32 v42, v42, s56, v106
    v_fma_f32 v43, v43, s56, v107
    v_cvt_pk_bf16_f32 v44, v40, v42
    v_cvt_pk_bf16_f32 v45, v41, v43
    ds_write2_b32 v7, v44, v45 offset0:0 offset1:8
    s_waitcnt lgkmcnt(7)
    v_lshlrev_b32 v51, 16, v26
    v_and_b32 v50, 0xffff0000, v26
    v_lshlrev_b32 v49, 16, v27
    v_and_b32 v48, 0xffff0000, v27
    v_fma_f32 v48, v48, s56, v108
    v_fma_f32 v49, v49, s56, v109
    v_fma_f32 v50, v50, s56, v110
    v_fma_f32 v51, v51, s56, v111
    v_cvt_pk_bf16_f32 v52, v48, v50
    v_cvt_pk_bf16_f32 v53, v49, v51
    ds_write2_b32 v7, v52, v53 offset0:128 offset1:136
    v_add_u32 v7, 0x400, v7
    s_waitcnt lgkmcnt(7)
    v_lshlrev_b32 v43, 16, v28
    v_and_b32 v42, 0xffff0000, v28
    v_lshlrev_b32 v41, 16, v29
    v_and_b32 v40, 0xffff0000, v29
    v_fma_f32 v40, v40, s56, v112
    v_fma_f32 v41, v41, s56, v113
    v_fma_f32 v42, v42, s56, v114
    v_fma_f32 v43, v43, s56, v115
    v_cvt_pk_bf16_f32 v44, v40, v42
    v_cvt_pk_bf16_f32 v45, v41, v43
    ds_write2_b32 v7, v44, v45 offset0:0 offset1:8
    s_waitcnt lgkmcnt(7)
    v_lshlrev_b32 v51, 16, v30
    v_and_b32 v50, 0xffff0000, v30
    v_lshlrev_b32 v49, 16, v31
    v_and_b32 v48, 0xffff0000, v31
    v_fma_f32 v48, v48, s56, v116
    v_fma_f32 v49, v49, s56, v117
    v_fma_f32 v50, v50, s56, v118
    v_fma_f32 v51, v51, s56, v119
    v_cvt_pk_bf16_f32 v52, v48, v50
    v_cvt_pk_bf16_f32 v53, v49, v51
    ds_write2_b32 v7, v52, v53 offset0:128 offset1:136
    v_add_u32 v7, 0x400, v7
    s_waitcnt lgkmcnt(0)
    s_branch sequential_preLN__ssm_conv_h3__mixer_s_mlp__prompt_kernel_ctail
sequential_preLN__ssm_conv_h3__mixer_s_mlp__prompt_kernel_loader:
    s_sub_u32 s11, s3, 4
    s_lshl_b32 s12, s10, 5
    s_load_dwordx8 s[48:55], s[22:23], s12
    v_and_b32 v4, 31, v11
    v_mul_u32_u24 v5, 4608, v4
    s_mul_i32 s12, s11, 147456
    s_lshl_b32 s13, s10, 3
    s_add_u32 s12, s12, s13
    v_add_u32 v5, s12, v5
    v_cmp_gt_u32 vcc, 32, v11
    v_mov_b32 v2, s20
    v_mov_b32 v3, s21
    v_mov_b32 v6, s18
    v_mov_b32 v7, s19
    v_cndmask_b32 v2, v2, v6, vcc
    v_cndmask_b32 v3, v3, v7, vcc
    v_add_co_u32 v2, vcc, v2, v5
    s_nop 1
    v_addc_co_u32 v3, vcc, 0, v3, vcc
    v_mov_b32 v24, 0
    v_mov_b32 v25, 0
    v_mov_b32 v26, 0
    v_mov_b32 v27, 0
    v_mov_b32 v28, 0
    v_mov_b32 v29, 0
    global_load_dwordx2 v[16:17], v[2:3], off offset:0
    global_load_dwordx2 v[18:19], v[2:3], off offset:1152
    global_load_dwordx2 v[20:21], v[2:3], off offset:2304
    global_load_dwordx2 v[22:23], v[2:3], off offset:3456
    s_cmp_lg_u32 s11, 0
    s_cselect_b64 exec, 1, 0
    s_cbranch_execz Lld_nohalo
    global_load_dwordx2 v[24:25], v[2:3], off offset:-3456
    global_load_dwordx2 v[26:27], v[2:3], off offset:-2304
    global_load_dwordx2 v[28:29], v[2:3], off offset:-1152
Lld_nohalo:
    s_mov_b64 exec, -1
    v_add_co_u32 v2, vcc, 589824, v2
    s_nop 1
    v_addc_co_u32 v3, vcc, 0, v3, vcc
    global_load_dwordx2 v[30:31], v[2:3], off offset:0
    global_load_dwordx2 v[32:33], v[2:3], off offset:1152
    global_load_dwordx2 v[34:35], v[2:3], off offset:2304
    global_load_dwordx2 v[36:37], v[2:3], off offset:3456
    s_mov_b64 exec, 1
    global_load_dwordx2 v[38:39], v[2:3], off offset:-3456
    global_load_dwordx2 v[40:41], v[2:3], off offset:-2304
    global_load_dwordx2 v[42:43], v[2:3], off offset:-1152
    s_mov_b64 exec, -1
    v_add_co_u32 v2, vcc, 589824, v2
    s_nop 1
    v_addc_co_u32 v3, vcc, 0, v3, vcc
    v_lshlrev_b32 v7, 3, v4
    s_lshl_b32 s12, s11, 8
    s_sub_u32 s12, 67576, s12
    v_sub_u32 v7, s12, v7
    s_waitcnt lgkmcnt(0)
    s_lshl_b32 s56, s48, 16
    s_and_b32 s57, s48, 0xffff0000
    s_lshl_b32 s58, s49, 16
    s_and_b32 s59, s49, 0xffff0000
    s_lshl_b32 s60, s50, 16
    s_and_b32 s61, s50, 0xffff0000
    s_lshl_b32 s62, s51, 16
    s_and_b32 s63, s51, 0xffff0000
    s_lshl_b32 s64, s52, 16
    s_and_b32 s65, s52, 0xffff0000
    s_lshl_b32 s66, s53, 16
    s_and_b32 s67, s53, 0xffff0000
    s_lshl_b32 s68, s54, 16
    s_and_b32 s69, s54, 0xffff0000
    s_lshl_b32 s70, s55, 16
    s_and_b32 s71, s55, 0xffff0000
    s_waitcnt vmcnt(7)
    v_mov_b32_dpp v24, v18 wave_shr:1 row_mask:0xf bank_mask:0xf
    v_mov_b32_dpp v25, v19 wave_shr:1 row_mask:0xf bank_mask:0xf
    v_mov_b32_dpp v26, v20 wave_shr:1 row_mask:0xf bank_mask:0xf
    v_mov_b32_dpp v27, v21 wave_shr:1 row_mask:0xf bank_mask:0xf
    v_mov_b32_dpp v28, v22 wave_shr:1 row_mask:0xf bank_mask:0xf
    v_mov_b32_dpp v29, v23 wave_shr:1 row_mask:0xf bank_mask:0xf
    v_permlane32_swap_b32 v16, v116
    v_permlane32_swap_b32 v17, v117
    v_permlane32_swap_b32 v18, v118
    v_permlane32_swap_b32 v19, v119
    v_permlane32_swap_b32 v20, v120
    v_permlane32_swap_b32 v21, v121
    v_permlane32_swap_b32 v22, v122
    v_permlane32_swap_b32 v23, v123
    v_lshlrev_b32 v72, 16, v24
    v_and_b32 v73, 0xffff0000, v24
    v_lshlrev_b32 v74, 16, v25
    v_and_b32 v75, 0xffff0000, v25
    v_lshlrev_b32 v76, 16, v26
    v_and_b32 v77, 0xffff0000, v26
    v_lshlrev_b32 v78, 16, v27
    v_and_b32 v79, 0xffff0000, v27
    v_lshlrev_b32 v80, 16, v28
    v_and_b32 v81, 0xffff0000, v28
    v_lshlrev_b32 v82, 16, v29
    v_and_b32 v83, 0xffff0000, v29
    v_lshlrev_b32 v84, 16, v16
    v_and_b32 v85, 0xffff0000, v16
    v_lshlrev_b32 v86, 16, v17
    v_and_b32 v87, 0xffff0000, v17
    v_lshlrev_b32 v88, 16, v18
    v_and_b32 v89, 0xffff0000, v18
    v_lshlrev_b32 v90, 16, v19
    v_and_b32 v91, 0xffff0000, v19
    v_lshlrev_b32 v92, 16, v20
    v_and_b32 v93, 0xffff0000, v20
    v_lshlrev_b32 v94, 16, v21
    v_and_b32 v95, 0xffff0000, v21
    v_lshlrev_b32 v96, 16, v22
    v_and_b32 v97, 0xffff0000, v22
    v_lshlrev_b32 v98, 16, v23
    v_and_b32 v99, 0xffff0000, v23
    v_lshlrev_b32 v100, 16, v116
    v_and_b32 v101, 0xffff0000, v116
    v_lshlrev_b32 v102, 16, v117
    v_and_b32 v103, 0xffff0000, v117
    v_lshlrev_b32 v104, 16, v118
    v_and_b32 v105, 0xffff0000, v118
    v_lshlrev_b32 v106, 16, v119
    v_and_b32 v107, 0xffff0000, v119
    v_lshlrev_b32 v108, 16, v120
    v_and_b32 v109, 0xffff0000, v120
    v_lshlrev_b32 v110, 16, v121
    v_and_b32 v111, 0xffff0000, v121
    v_lshlrev_b32 v112, 16, v122
    v_and_b32 v113, 0xffff0000, v122
    v_lshlrev_b32 v114, 16, v123
    v_and_b32 v115, 0xffff0000, v123
    v_mul_f32 v132, s59, v72
    v_mul_f32 v133, s59, v76
    v_mul_f32 v134, s59, v80
    v_mul_f32 v135, s59, v84
    v_fmac_f32 v132, s58, v76
    v_fmac_f32 v133, s58, v80
    v_fmac_f32 v134, s58, v84
    v_fmac_f32 v135, s58, v88
    v_fmac_f32 v132, s57, v80
    v_fmac_f32 v133, s57, v84
    v_fmac_f32 v134, s57, v88
    v_fmac_f32 v135, s57, v92
    v_fmac_f32 v132, s56, v84
    v_fmac_f32 v133, s56, v88
    v_fmac_f32 v134, s56, v92
    v_fmac_f32 v135, s56, v96
    v_mul_f32 v132, v132, v100
    v_mul_f32 v133, v133, v104
    v_mul_f32 v134, v134, v108
    v_mul_f32 v135, v135, v112
    v_cvt_pk_bf16_f32 v124, v135, v134
    v_cvt_pk_bf16_f32 v125, v133, v132
    v_mul_f32 v136, s63, v73
    v_mul_f32 v137, s63, v77
    v_mul_f32 v138, s63, v81
    v_mul_f32 v139, s63, v85
    v_fmac_f32 v136, s62, v77
    v_fmac_f32 v137, s62, v81
    v_fmac_f32 v138, s62, v85
    v_fmac_f32 v139, s62, v89
    v_fmac_f32 v136, s61, v81
    v_fmac_f32 v137, s61, v85
    v_fmac_f32 v138, s61, v89
    v_fmac_f32 v139, s61, v93
    v_fmac_f32 v136, s60, v85
    v_fmac_f32 v137, s60, v89
    v_fmac_f32 v138, s60, v93
    v_fmac_f32 v139, s60, v97
    v_mul_f32 v136, v136, v101
    v_mul_f32 v137, v137, v105
    v_mul_f32 v138, v138, v109
    v_mul_f32 v139, v139, v113
    v_cvt_pk_bf16_f32 v126, v139, v138
    v_cvt_pk_bf16_f32 v127, v137, v136
    v_mul_f32 v132, s67, v74
    v_mul_f32 v133, s67, v78
    v_mul_f32 v134, s67, v82
    v_mul_f32 v135, s67, v86
    v_fmac_f32 v132, s66, v78
    v_fmac_f32 v133, s66, v82
    v_fmac_f32 v134, s66, v86
    v_fmac_f32 v135, s66, v90
    v_fmac_f32 v132, s65, v82
    v_fmac_f32 v133, s65, v86
    v_fmac_f32 v134, s65, v90
    v_fmac_f32 v135, s65, v94
    v_fmac_f32 v132, s64, v86
    v_fmac_f32 v133, s64, v90
    v_fmac_f32 v134, s64, v94
    v_fmac_f32 v135, s64, v98
    v_mul_f32 v132, v132, v102
    v_mul_f32 v133, v133, v106
    v_mul_f32 v134, v134, v110
    v_mul_f32 v135, v135, v114
    v_cvt_pk_bf16_f32 v128, v135, v134
    v_cvt_pk_bf16_f32 v129, v133, v132
    v_mul_f32 v136, s71, v75
    v_mul_f32 v137, s71, v79
    v_mul_f32 v138, s71, v83
    v_mul_f32 v139, s71, v87
    v_fmac_f32 v136, s70, v79
    v_fmac_f32 v137, s70, v83
    v_fmac_f32 v138, s70, v87
    v_fmac_f32 v139, s70, v91
    v_fmac_f32 v136, s69, v83
    v_fmac_f32 v137, s69, v87
    v_fmac_f32 v138, s69, v91
    v_fmac_f32 v139, s69, v95
    v_fmac_f32 v136, s68, v87
    v_fmac_f32 v137, s68, v91
    v_fmac_f32 v138, s68, v95
    v_fmac_f32 v139, s68, v99
    v_mul_f32 v136, v136, v103
    v_mul_f32 v137, v137, v107
    v_mul_f32 v138, v138, v111
    v_mul_f32 v139, v139, v115
    v_cvt_pk_bf16_f32 v130, v139, v138
    v_cvt_pk_bf16_f32 v131, v137, v136
    s_mov_b32 exec_hi, 0
    ds_write_b64 v7, v[124:125] offset:3072
    ds_write_b64 v7, v[126:127] offset:7680
    ds_write_b64 v7, v[128:129] offset:12288
    ds_write_b64 v7, v[130:131] offset:16896
    s_mov_b32 exec_hi, -1
    s_waitcnt lgkmcnt(0)
    s_barrier
    global_load_dwordx2 v[44:45], v[2:3], off offset:0
    global_load_dwordx2 v[46:47], v[2:3], off offset:1152
    global_load_dwordx2 v[48:49], v[2:3], off offset:2304
    global_load_dwordx2 v[50:51], v[2:3], off offset:3456
    s_mov_b64 exec, 1
    global_load_dwordx2 v[52:53], v[2:3], off offset:-3456
    global_load_dwordx2 v[54:55], v[2:3], off offset:-2304
    global_load_dwordx2 v[56:57], v[2:3], off offset:-1152
    s_mov_b64 exec, -1
    v_add_co_u32 v2, vcc, 589824, v2
    s_nop 1
    v_addc_co_u32 v3, vcc, 0, v3, vcc
    s_waitcnt vmcnt(9)
    v_mov_b32_dpp v38, v32 wave_shr:1 row_mask:0xf bank_mask:0xf
    v_mov_b32_dpp v39, v33 wave_shr:1 row_mask:0xf bank_mask:0xf
    s_waitcnt vmcnt(8)
    v_mov_b32_dpp v40, v34 wave_shr:1 row_mask:0xf bank_mask:0xf
    v_mov_b32_dpp v41, v35 wave_shr:1 row_mask:0xf bank_mask:0xf
    s_waitcnt vmcnt(7)
    v_mov_b32_dpp v42, v36 wave_shr:1 row_mask:0xf bank_mask:0xf
    v_mov_b32_dpp v43, v37 wave_shr:1 row_mask:0xf bank_mask:0xf
    v_permlane32_swap_b32 v30, v116
    v_permlane32_swap_b32 v31, v117
    v_permlane32_swap_b32 v32, v118
    v_permlane32_swap_b32 v33, v119
    v_permlane32_swap_b32 v34, v120
    v_permlane32_swap_b32 v35, v121
    v_permlane32_swap_b32 v36, v122
    v_permlane32_swap_b32 v37, v123
    v_lshlrev_b32 v72, 16, v38
    v_and_b32 v73, 0xffff0000, v38
    v_lshlrev_b32 v74, 16, v39
    v_and_b32 v75, 0xffff0000, v39
    v_lshlrev_b32 v76, 16, v40
    v_and_b32 v77, 0xffff0000, v40
    v_lshlrev_b32 v78, 16, v41
    v_and_b32 v79, 0xffff0000, v41
    v_lshlrev_b32 v80, 16, v42
    v_and_b32 v81, 0xffff0000, v42
    v_lshlrev_b32 v82, 16, v43
    v_and_b32 v83, 0xffff0000, v43
    v_lshlrev_b32 v84, 16, v30
    v_and_b32 v85, 0xffff0000, v30
    v_lshlrev_b32 v86, 16, v31
    v_and_b32 v87, 0xffff0000, v31
    v_lshlrev_b32 v88, 16, v32
    v_and_b32 v89, 0xffff0000, v32
    v_lshlrev_b32 v90, 16, v33
    v_and_b32 v91, 0xffff0000, v33
    v_lshlrev_b32 v92, 16, v34
    v_and_b32 v93, 0xffff0000, v34
    v_lshlrev_b32 v94, 16, v35
    v_and_b32 v95, 0xffff0000, v35
    v_lshlrev_b32 v96, 16, v36
    v_and_b32 v97, 0xffff0000, v36
    v_lshlrev_b32 v98, 16, v37
    v_and_b32 v99, 0xffff0000, v37
    v_lshlrev_b32 v100, 16, v116
    v_and_b32 v101, 0xffff0000, v116
    v_lshlrev_b32 v102, 16, v117
    v_and_b32 v103, 0xffff0000, v117
    v_lshlrev_b32 v104, 16, v118
    v_and_b32 v105, 0xffff0000, v118
    v_lshlrev_b32 v106, 16, v119
    v_and_b32 v107, 0xffff0000, v119
    v_lshlrev_b32 v108, 16, v120
    v_and_b32 v109, 0xffff0000, v120
    v_lshlrev_b32 v110, 16, v121
    v_and_b32 v111, 0xffff0000, v121
    v_lshlrev_b32 v112, 16, v122
    v_and_b32 v113, 0xffff0000, v122
    v_lshlrev_b32 v114, 16, v123
    v_and_b32 v115, 0xffff0000, v123
    v_mul_f32 v132, s59, v72
    v_mul_f32 v133, s59, v76
    v_mul_f32 v134, s59, v80
    v_mul_f32 v135, s59, v84
    v_fmac_f32 v132, s58, v76
    v_fmac_f32 v133, s58, v80
    v_fmac_f32 v134, s58, v84
    v_fmac_f32 v135, s58, v88
    v_fmac_f32 v132, s57, v80
    v_fmac_f32 v133, s57, v84
    v_fmac_f32 v134, s57, v88
    v_fmac_f32 v135, s57, v92
    v_fmac_f32 v132, s56, v84
    v_fmac_f32 v133, s56, v88
    v_fmac_f32 v134, s56, v92
    v_fmac_f32 v135, s56, v96
    v_mul_f32 v132, v132, v100
    v_mul_f32 v133, v133, v104
    v_mul_f32 v134, v134, v108
    v_mul_f32 v135, v135, v112
    v_cvt_pk_bf16_f32 v124, v135, v134
    v_cvt_pk_bf16_f32 v125, v133, v132
    v_mul_f32 v136, s63, v73
    v_mul_f32 v137, s63, v77
    v_mul_f32 v138, s63, v81
    v_mul_f32 v139, s63, v85
    v_fmac_f32 v136, s62, v77
    v_fmac_f32 v137, s62, v81
    v_fmac_f32 v138, s62, v85
    v_fmac_f32 v139, s62, v89
    v_fmac_f32 v136, s61, v81
    v_fmac_f32 v137, s61, v85
    v_fmac_f32 v138, s61, v89
    v_fmac_f32 v139, s61, v93
    v_fmac_f32 v136, s60, v85
    v_fmac_f32 v137, s60, v89
    v_fmac_f32 v138, s60, v93
    v_fmac_f32 v139, s60, v97
    v_mul_f32 v136, v136, v101
    v_mul_f32 v137, v137, v105
    v_mul_f32 v138, v138, v109
    v_mul_f32 v139, v139, v113
    v_cvt_pk_bf16_f32 v126, v139, v138
    v_cvt_pk_bf16_f32 v127, v137, v136
    v_mul_f32 v132, s67, v74
    v_mul_f32 v133, s67, v78
    v_mul_f32 v134, s67, v82
    v_mul_f32 v135, s67, v86
    v_fmac_f32 v132, s66, v78
    v_fmac_f32 v133, s66, v82
    v_fmac_f32 v134, s66, v86
    v_fmac_f32 v135, s66, v90
    v_fmac_f32 v132, s65, v82
    v_fmac_f32 v133, s65, v86
    v_fmac_f32 v134, s65, v90
    v_fmac_f32 v135, s65, v94
    v_fmac_f32 v132, s64, v86
    v_fmac_f32 v133, s64, v90
    v_fmac_f32 v134, s64, v94
    v_fmac_f32 v135, s64, v98
    v_mul_f32 v132, v132, v102
    v_mul_f32 v133, v133, v106
    v_mul_f32 v134, v134, v110
    v_mul_f32 v135, v135, v114
    v_cvt_pk_bf16_f32 v128, v135, v134
    v_cvt_pk_bf16_f32 v129, v133, v132
    v_mul_f32 v136, s71, v75
    v_mul_f32 v137, s71, v79
    v_mul_f32 v138, s71, v83
    v_mul_f32 v139, s71, v87
    v_fmac_f32 v136, s70, v79
    v_fmac_f32 v137, s70, v83
    v_fmac_f32 v138, s70, v87
    v_fmac_f32 v139, s70, v91
    v_fmac_f32 v136, s69, v83
    v_fmac_f32 v137, s69, v87
    v_fmac_f32 v138, s69, v91
    v_fmac_f32 v139, s69, v95
    v_fmac_f32 v136, s68, v87
    v_fmac_f32 v137, s68, v91
    v_fmac_f32 v138, s68, v95
    v_fmac_f32 v139, s68, v99
    v_mul_f32 v136, v136, v103
    v_mul_f32 v137, v137, v107
    v_mul_f32 v138, v138, v111
    v_mul_f32 v139, v139, v115
    v_cvt_pk_bf16_f32 v130, v139, v138
    v_cvt_pk_bf16_f32 v131, v137, v136
    s_mov_b32 exec_hi, 0
    ds_write_b64 v7, v[124:125] offset:2048
    ds_write_b64 v7, v[126:127] offset:6656
    ds_write_b64 v7, v[128:129] offset:11264
    ds_write_b64 v7, v[130:131] offset:15872
    s_mov_b32 exec_hi, -1
    s_waitcnt lgkmcnt(0)
    s_barrier
    global_load_dwordx2 v[58:59], v[2:3], off offset:0
    global_load_dwordx2 v[60:61], v[2:3], off offset:1152
    global_load_dwordx2 v[62:63], v[2:3], off offset:2304
    global_load_dwordx2 v[64:65], v[2:3], off offset:3456
    s_mov_b64 exec, 1
    global_load_dwordx2 v[66:67], v[2:3], off offset:-3456
    global_load_dwordx2 v[68:69], v[2:3], off offset:-2304
    global_load_dwordx2 v[70:71], v[2:3], off offset:-1152
    s_mov_b64 exec, -1
    s_waitcnt vmcnt(9)
    v_mov_b32_dpp v52, v46 wave_shr:1 row_mask:0xf bank_mask:0xf
    v_mov_b32_dpp v53, v47 wave_shr:1 row_mask:0xf bank_mask:0xf
    s_waitcnt vmcnt(8)
    v_mov_b32_dpp v54, v48 wave_shr:1 row_mask:0xf bank_mask:0xf
    v_mov_b32_dpp v55, v49 wave_shr:1 row_mask:0xf bank_mask:0xf
    s_waitcnt vmcnt(7)
    v_mov_b32_dpp v56, v50 wave_shr:1 row_mask:0xf bank_mask:0xf
    v_mov_b32_dpp v57, v51 wave_shr:1 row_mask:0xf bank_mask:0xf
    v_permlane32_swap_b32 v44, v116
    v_permlane32_swap_b32 v45, v117
    v_permlane32_swap_b32 v46, v118
    v_permlane32_swap_b32 v47, v119
    v_permlane32_swap_b32 v48, v120
    v_permlane32_swap_b32 v49, v121
    v_permlane32_swap_b32 v50, v122
    v_permlane32_swap_b32 v51, v123
    v_lshlrev_b32 v72, 16, v52
    v_and_b32 v73, 0xffff0000, v52
    v_lshlrev_b32 v74, 16, v53
    v_and_b32 v75, 0xffff0000, v53
    v_lshlrev_b32 v76, 16, v54
    v_and_b32 v77, 0xffff0000, v54
    v_lshlrev_b32 v78, 16, v55
    v_and_b32 v79, 0xffff0000, v55
    v_lshlrev_b32 v80, 16, v56
    v_and_b32 v81, 0xffff0000, v56
    v_lshlrev_b32 v82, 16, v57
    v_and_b32 v83, 0xffff0000, v57
    v_lshlrev_b32 v84, 16, v44
    v_and_b32 v85, 0xffff0000, v44
    v_lshlrev_b32 v86, 16, v45
    v_and_b32 v87, 0xffff0000, v45
    v_lshlrev_b32 v88, 16, v46
    v_and_b32 v89, 0xffff0000, v46
    v_lshlrev_b32 v90, 16, v47
    v_and_b32 v91, 0xffff0000, v47
    v_lshlrev_b32 v92, 16, v48
    v_and_b32 v93, 0xffff0000, v48
    v_lshlrev_b32 v94, 16, v49
    v_and_b32 v95, 0xffff0000, v49
    v_lshlrev_b32 v96, 16, v50
    v_and_b32 v97, 0xffff0000, v50
    v_lshlrev_b32 v98, 16, v51
    v_and_b32 v99, 0xffff0000, v51
    v_lshlrev_b32 v100, 16, v116
    v_and_b32 v101, 0xffff0000, v116
    v_lshlrev_b32 v102, 16, v117
    v_and_b32 v103, 0xffff0000, v117
    v_lshlrev_b32 v104, 16, v118
    v_and_b32 v105, 0xffff0000, v118
    v_lshlrev_b32 v106, 16, v119
    v_and_b32 v107, 0xffff0000, v119
    v_lshlrev_b32 v108, 16, v120
    v_and_b32 v109, 0xffff0000, v120
    v_lshlrev_b32 v110, 16, v121
    v_and_b32 v111, 0xffff0000, v121
    v_lshlrev_b32 v112, 16, v122
    v_and_b32 v113, 0xffff0000, v122
    v_lshlrev_b32 v114, 16, v123
    v_and_b32 v115, 0xffff0000, v123
    v_mul_f32 v132, s59, v72
    v_mul_f32 v133, s59, v76
    v_mul_f32 v134, s59, v80
    v_mul_f32 v135, s59, v84
    v_fmac_f32 v132, s58, v76
    v_fmac_f32 v133, s58, v80
    v_fmac_f32 v134, s58, v84
    v_fmac_f32 v135, s58, v88
    v_fmac_f32 v132, s57, v80
    v_fmac_f32 v133, s57, v84
    v_fmac_f32 v134, s57, v88
    v_fmac_f32 v135, s57, v92
    v_fmac_f32 v132, s56, v84
    v_fmac_f32 v133, s56, v88
    v_fmac_f32 v134, s56, v92
    v_fmac_f32 v135, s56, v96
    v_mul_f32 v132, v132, v100
    v_mul_f32 v133, v133, v104
    v_mul_f32 v134, v134, v108
    v_mul_f32 v135, v135, v112
    v_cvt_pk_bf16_f32 v124, v135, v134
    v_cvt_pk_bf16_f32 v125, v133, v132
    v_mul_f32 v136, s63, v73
    v_mul_f32 v137, s63, v77
    v_mul_f32 v138, s63, v81
    v_mul_f32 v139, s63, v85
    v_fmac_f32 v136, s62, v77
    v_fmac_f32 v137, s62, v81
    v_fmac_f32 v138, s62, v85
    v_fmac_f32 v139, s62, v89
    v_fmac_f32 v136, s61, v81
    v_fmac_f32 v137, s61, v85
    v_fmac_f32 v138, s61, v89
    v_fmac_f32 v139, s61, v93
    v_fmac_f32 v136, s60, v85
    v_fmac_f32 v137, s60, v89
    v_fmac_f32 v138, s60, v93
    v_fmac_f32 v139, s60, v97
    v_mul_f32 v136, v136, v101
    v_mul_f32 v137, v137, v105
    v_mul_f32 v138, v138, v109
    v_mul_f32 v139, v139, v113
    v_cvt_pk_bf16_f32 v126, v139, v138
    v_cvt_pk_bf16_f32 v127, v137, v136
    v_mul_f32 v132, s67, v74
    v_mul_f32 v133, s67, v78
    v_mul_f32 v134, s67, v82
    v_mul_f32 v135, s67, v86
    v_fmac_f32 v132, s66, v78
    v_fmac_f32 v133, s66, v82
    v_fmac_f32 v134, s66, v86
    v_fmac_f32 v135, s66, v90
    v_fmac_f32 v132, s65, v82
    v_fmac_f32 v133, s65, v86
    v_fmac_f32 v134, s65, v90
    v_fmac_f32 v135, s65, v94
    v_fmac_f32 v132, s64, v86
    v_fmac_f32 v133, s64, v90
    v_fmac_f32 v134, s64, v94
    v_fmac_f32 v135, s64, v98
    v_mul_f32 v132, v132, v102
    v_mul_f32 v133, v133, v106
    v_mul_f32 v134, v134, v110
    v_mul_f32 v135, v135, v114
    v_cvt_pk_bf16_f32 v128, v135, v134
    v_cvt_pk_bf16_f32 v129, v133, v132
    v_mul_f32 v136, s71, v75
    v_mul_f32 v137, s71, v79
    v_mul_f32 v138, s71, v83
    v_mul_f32 v139, s71, v87
    v_fmac_f32 v136, s70, v79
    v_fmac_f32 v137, s70, v83
    v_fmac_f32 v138, s70, v87
    v_fmac_f32 v139, s70, v91
    v_fmac_f32 v136, s69, v83
    v_fmac_f32 v137, s69, v87
    v_fmac_f32 v138, s69, v91
    v_fmac_f32 v139, s69, v95
    v_fmac_f32 v136, s68, v87
    v_fmac_f32 v137, s68, v91
    v_fmac_f32 v138, s68, v95
    v_fmac_f32 v139, s68, v99
    v_mul_f32 v136, v136, v103
    v_mul_f32 v137, v137, v107
    v_mul_f32 v138, v138, v111
    v_mul_f32 v139, v139, v115
    v_cvt_pk_bf16_f32 v130, v139, v138
    v_cvt_pk_bf16_f32 v131, v137, v136
    s_mov_b32 exec_hi, 0
    ds_write_b64 v7, v[124:125] offset:1024
    ds_write_b64 v7, v[126:127] offset:5632
    ds_write_b64 v7, v[128:129] offset:10240
    ds_write_b64 v7, v[130:131] offset:14848
    s_mov_b32 exec_hi, -1
    s_waitcnt lgkmcnt(0)
    s_barrier
    s_waitcnt vmcnt(2)
    v_mov_b32_dpp v66, v60 wave_shr:1 row_mask:0xf bank_mask:0xf
    v_mov_b32_dpp v67, v61 wave_shr:1 row_mask:0xf bank_mask:0xf
    s_waitcnt vmcnt(1)
    v_mov_b32_dpp v68, v62 wave_shr:1 row_mask:0xf bank_mask:0xf
    v_mov_b32_dpp v69, v63 wave_shr:1 row_mask:0xf bank_mask:0xf
    s_waitcnt vmcnt(0)
    v_mov_b32_dpp v70, v64 wave_shr:1 row_mask:0xf bank_mask:0xf
    v_mov_b32_dpp v71, v65 wave_shr:1 row_mask:0xf bank_mask:0xf
    v_permlane32_swap_b32 v58, v116
    v_permlane32_swap_b32 v59, v117
    v_permlane32_swap_b32 v60, v118
    v_permlane32_swap_b32 v61, v119
    v_permlane32_swap_b32 v62, v120
    v_permlane32_swap_b32 v63, v121
    v_permlane32_swap_b32 v64, v122
    v_permlane32_swap_b32 v65, v123
    v_lshlrev_b32 v72, 16, v66
    v_and_b32 v73, 0xffff0000, v66
    v_lshlrev_b32 v74, 16, v67
    v_and_b32 v75, 0xffff0000, v67
    v_lshlrev_b32 v76, 16, v68
    v_and_b32 v77, 0xffff0000, v68
    v_lshlrev_b32 v78, 16, v69
    v_and_b32 v79, 0xffff0000, v69
    v_lshlrev_b32 v80, 16, v70
    v_and_b32 v81, 0xffff0000, v70
    v_lshlrev_b32 v82, 16, v71
    v_and_b32 v83, 0xffff0000, v71
    v_lshlrev_b32 v84, 16, v58
    v_and_b32 v85, 0xffff0000, v58
    v_lshlrev_b32 v86, 16, v59
    v_and_b32 v87, 0xffff0000, v59
    v_lshlrev_b32 v88, 16, v60
    v_and_b32 v89, 0xffff0000, v60
    v_lshlrev_b32 v90, 16, v61
    v_and_b32 v91, 0xffff0000, v61
    v_lshlrev_b32 v92, 16, v62
    v_and_b32 v93, 0xffff0000, v62
    v_lshlrev_b32 v94, 16, v63
    v_and_b32 v95, 0xffff0000, v63
    v_lshlrev_b32 v96, 16, v64
    v_and_b32 v97, 0xffff0000, v64
    v_lshlrev_b32 v98, 16, v65
    v_and_b32 v99, 0xffff0000, v65
    v_lshlrev_b32 v100, 16, v116
    v_and_b32 v101, 0xffff0000, v116
    v_lshlrev_b32 v102, 16, v117
    v_and_b32 v103, 0xffff0000, v117
    v_lshlrev_b32 v104, 16, v118
    v_and_b32 v105, 0xffff0000, v118
    v_lshlrev_b32 v106, 16, v119
    v_and_b32 v107, 0xffff0000, v119
    v_lshlrev_b32 v108, 16, v120
    v_and_b32 v109, 0xffff0000, v120
    v_lshlrev_b32 v110, 16, v121
    v_and_b32 v111, 0xffff0000, v121
    v_lshlrev_b32 v112, 16, v122
    v_and_b32 v113, 0xffff0000, v122
    v_lshlrev_b32 v114, 16, v123
    v_and_b32 v115, 0xffff0000, v123
    v_mul_f32 v132, s59, v72
    v_mul_f32 v133, s59, v76
    v_mul_f32 v134, s59, v80
    v_mul_f32 v135, s59, v84
    v_fmac_f32 v132, s58, v76
    v_fmac_f32 v133, s58, v80
    v_fmac_f32 v134, s58, v84
    v_fmac_f32 v135, s58, v88
    v_fmac_f32 v132, s57, v80
    v_fmac_f32 v133, s57, v84
    v_fmac_f32 v134, s57, v88
    v_fmac_f32 v135, s57, v92
    v_fmac_f32 v132, s56, v84
    v_fmac_f32 v133, s56, v88
    v_fmac_f32 v134, s56, v92
    v_fmac_f32 v135, s56, v96
    v_mul_f32 v132, v132, v100
    v_mul_f32 v133, v133, v104
    v_mul_f32 v134, v134, v108
    v_mul_f32 v135, v135, v112
    v_cvt_pk_bf16_f32 v124, v135, v134
    v_cvt_pk_bf16_f32 v125, v133, v132
    v_mul_f32 v136, s63, v73
    v_mul_f32 v137, s63, v77
    v_mul_f32 v138, s63, v81
    v_mul_f32 v139, s63, v85
    v_fmac_f32 v136, s62, v77
    v_fmac_f32 v137, s62, v81
    v_fmac_f32 v138, s62, v85
    v_fmac_f32 v139, s62, v89
    v_fmac_f32 v136, s61, v81
    v_fmac_f32 v137, s61, v85
    v_fmac_f32 v138, s61, v89
    v_fmac_f32 v139, s61, v93
    v_fmac_f32 v136, s60, v85
    v_fmac_f32 v137, s60, v89
    v_fmac_f32 v138, s60, v93
    v_fmac_f32 v139, s60, v97
    v_mul_f32 v136, v136, v101
    v_mul_f32 v137, v137, v105
    v_mul_f32 v138, v138, v109
    v_mul_f32 v139, v139, v113
    v_cvt_pk_bf16_f32 v126, v139, v138
    v_cvt_pk_bf16_f32 v127, v137, v136
    v_mul_f32 v132, s67, v74
    v_mul_f32 v133, s67, v78
    v_mul_f32 v134, s67, v82
    v_mul_f32 v135, s67, v86
    v_fmac_f32 v132, s66, v78
    v_fmac_f32 v133, s66, v82
    v_fmac_f32 v134, s66, v86
    v_fmac_f32 v135, s66, v90
    v_fmac_f32 v132, s65, v82
    v_fmac_f32 v133, s65, v86
    v_fmac_f32 v134, s65, v90
    v_fmac_f32 v135, s65, v94
    v_fmac_f32 v132, s64, v86
    v_fmac_f32 v133, s64, v90
    v_fmac_f32 v134, s64, v94
    v_fmac_f32 v135, s64, v98
    v_mul_f32 v132, v132, v102
    v_mul_f32 v133, v133, v106
    v_mul_f32 v134, v134, v110
    v_mul_f32 v135, v135, v114
    v_cvt_pk_bf16_f32 v128, v135, v134
    v_cvt_pk_bf16_f32 v129, v133, v132
    v_mul_f32 v136, s71, v75
    v_mul_f32 v137, s71, v79
    v_mul_f32 v138, s71, v83
    v_mul_f32 v139, s71, v87
    v_fmac_f32 v136, s70, v79
    v_fmac_f32 v137, s70, v83
    v_fmac_f32 v138, s70, v87
    v_fmac_f32 v139, s70, v91
    v_fmac_f32 v136, s69, v83
    v_fmac_f32 v137, s69, v87
    v_fmac_f32 v138, s69, v91
    v_fmac_f32 v139, s69, v95
    v_fmac_f32 v136, s68, v87
    v_fmac_f32 v137, s68, v91
    v_fmac_f32 v138, s68, v95
    v_fmac_f32 v139, s68, v99
    v_mul_f32 v136, v136, v103
    v_mul_f32 v137, v137, v107
    v_mul_f32 v138, v138, v111
    v_mul_f32 v139, v139, v115
    v_cvt_pk_bf16_f32 v130, v139, v138
    v_cvt_pk_bf16_f32 v131, v137, v136
    s_mov_b32 exec_hi, 0
    ds_write_b64 v7, v[124:125] offset:0
    ds_write_b64 v7, v[126:127] offset:4608
    ds_write_b64 v7, v[128:129] offset:9216
    ds_write_b64 v7, v[130:131] offset:13824
    s_mov_b32 exec_hi, -1
    s_waitcnt lgkmcnt(0)
    s_barrier
sequential_preLN__ssm_conv_h3__mixer_s_mlp__prompt_kernel_ctail:
    s_nop 7
    v_bfe_u32 v2, v11, 2, 2
    v_mul_u32_u24 v2, 16704, v2
    v_and_b32 v3, 3, v11
    v_lshl_add_u32 v2, v3, 3, v2
    v_lshrrev_b32 v3, 4, v11
    v_lshl_add_u32 v2, v3, 6, v2
    s_lshl_b32 s57, s3, 9
    v_add_u32 v2, s57, v2
    v_lshrrev_b32 v3, 3, v11
    v_mul_u32_u24 v3, 18432, v3
    v_and_b32 v4, 7, v11
    v_lshl_add_u32 v3, v4, 4, v3
    s_mul_i32 s57, s3, 294912
    s_lshl_b32 s58, s10, 7
    s_add_u32 s57, s57, s58
    s_add_u32 s57, s57, 11943936
    s_cmp_lg_u32 s3, 4
    s_cbranch_scc1 Lcv_nopk
    v_mov_b32 v10, 0
    global_load_dword v111, v10, s[40:41] offset:0 sc1
Lcv_nopk:
    s_barrier
    ds_read_b64_tr_b16 v[16:17], v2 offset:0
    ds_read_b64_tr_b16 v[18:19], v2 offset:32
    ds_read_b64_tr_b16 v[20:21], v2 offset:256
    ds_read_b64_tr_b16 v[22:23], v2 offset:288
    s_waitcnt lgkmcnt(2)
    buffer_store_dwordx4 v[16:19], v3, s[44:47], s57 offen sc1
    s_nop 1
    s_add_u32 s57, s57, 147456
    s_waitcnt lgkmcnt(0)
    buffer_store_dwordx4 v[20:23], v3, s[44:47], s57 offen sc1
    s_waitcnt vmcnt(0) lgkmcnt(0)
    s_barrier
    s_cmp_lg_u32 s3, 0
    s_cbranch_scc1 Lcv_sig
    s_mov_b64 exec, 1
    v_mov_b32 v1, 1
    v_mov_b32 v10, 0
    global_atomic_add v1, v10, v1, s[40:41] offset:128 sc0 sc1
    s_mov_b64 exec, -1
    s_waitcnt vmcnt(0)
    v_readfirstlane_b32 s12, v1
    s_add_u32 s12, s12, 1
    s_mul_hi_u32 s13, s12, 29620465
    s_mul_i32 s13, s13, 145
    s_cmp_lg_u32 s12, s13
    s_cbranch_scc1 Lya1
    v_lshlrev_b32 v10, 7, v11
    v_mov_b32 v1, 1
    s_mov_b32 s12, 40337408
    s_mov_b32 exec_hi, 0
    buffer_store_dword v1, v10, s[44:47], s12 offen sc1
    s_mov_b32 exec_hi, -1
Lya1:
Lcv_sig:
    s_branch sequential_preLN__ssm_conv_h3__mixer_s_mlp__prompt_kernel_common
sequential_preLN__ssm_conv_h3__mixer_s_mlp__prompt_kernel_nonconv:
    s_sub_u32 s11, s4, 18
    s_cmp_ge_u32 s11, 9
    s_cbranch_scc1 sequential_preLN__ssm_conv_h3__mixer_s_mlp__prompt_kernel_rl12
    s_lshl_b32 s10, s11, 2
    s_and_b32 s12, s3, 3
    s_add_u32 s10, s10, s12
    s_mul_i32 s12, s5, 18
    s_add_u32 s12, s12, s10
    s_cmp_lt_u32 s10, 18
    s_cselect_b32 s10, 36, 162
    s_add_u32 s10, s10, s12
    s_mul_i32 s12, s10, 36864
    s_mov_b64 s[48:49], s[30:31]
    s_mov_b32 s50, 663552
    s_movk_i32 s13, 1152
    s_mov_b32 s14, 0
    s_sub_u32 s15, s10, 36
    s_mul_hi_u32 s56, s15, 0x0e38e38f
    s_mul_i32 s57, s56, 18
    s_sub_u32 s57, s15, s57
    s_mul_i32 s57, s57, 294912
    s_mul_i32 s56, s56, 1152
    s_add_u32 s12, s57, s56
    s_mov_b64 s[48:49], s[34:35]
    s_movk_i32 s13, 9216
    s_mov_b32 s50, 5308416
    s_sub_u32 s15, s10, 180
    s_mul_i32 s15, s15, 36864
    s_cmp_ge_u32 s10, 180
    s_cselect_b64 s[48:49], s[36:37], s[48:49]
    s_cselect_b32 s14, 1, s14
    s_cselect_b32 s12, s15, s12
    s_cselect_b32 s13, 1152, s13
    s_and_b32 s15, s3, 3
    s_mul_i32 s15, s15, 37888
    s_lshr_b32 s11, s3, 2
    s_and_b32 s49, s49, 0xffff
    s_mov_b32 s51, 0x20000
    v_lshlrev_b32 v5, 4, v11
    v_lshrrev_b32 v6, 3, v11
    v_mul_lo_u32 v6, v6, s13
    v_and_b32 v7, 7, v11
    v_lshl_add_u32 v6, v7, 4, v6
    v_add_u32 v6, 1024, v6
    s_waitcnt vmcnt(0)
    s_mul_i32 s56, s11, 16
    s_mul_i32 s57, s56, 1056
    s_add_u32 m0, s15, s57
    s_mul_i32 s56, s56, s13
    s_add_u32 s56, s56, s12
    buffer_load_dwordx4 v5, s[48:51], s56 offen lds
    s_add_u32 s56, s56, s13
    s_add_u32 m0, m0, 1056
    s_nop 0
    buffer_load_dwordx4 v5, s[48:51], s56 offen lds
    s_add_u32 s56, s56, s13
    s_add_u32 m0, m0, 1056
    s_nop 0
    buffer_load_dwordx4 v5, s[48:51], s56 offen lds
    s_add_u32 s56, s56, s13
    s_add_u32 m0, m0, 1056
    s_nop 0
    buffer_load_dwordx4 v5, s[48:51], s56 offen lds
    s_add_u32 s56, s56, s13
    s_add_u32 m0, m0, 1056
    s_nop 0
    buffer_load_dwordx4 v5, s[48:51], s56 offen lds
    s_add_u32 s56, s56, s13
    s_add_u32 m0, m0, 1056
    s_nop 0
    buffer_load_dwordx4 v5, s[48:51], s56 offen lds
    s_add_u32 s56, s56, s13
    s_add_u32 m0, m0, 1056
    s_nop 0
    buffer_load_dwordx4 v5, s[48:51], s56 offen lds
    s_add_u32 s56, s56, s13
    s_add_u32 m0, m0, 1056
    s_nop 0
    buffer_load_dwordx4 v5, s[48:51], s56 offen lds
    s_add_u32 s56, s56, s13
    s_add_u32 m0, m0, 1056
    s_nop 0
    buffer_load_dwordx4 v5, s[48:51], s56 offen lds
    s_add_u32 s56, s56, s13
    s_add_u32 m0, m0, 1056
    s_nop 0
    buffer_load_dwordx4 v5, s[48:51], s56 offen lds
    s_add_u32 s56, s56, s13
    s_add_u32 m0, m0, 1056
    s_nop 0
    buffer_load_dwordx4 v5, s[48:51], s56 offen lds
    s_add_u32 s56, s56, s13
    s_add_u32 m0, m0, 1056
    s_nop 0
    buffer_load_dwordx4 v5, s[48:51], s56 offen lds
    s_add_u32 s56, s56, s13
    s_add_u32 m0, m0, 1056
    s_nop 0
    buffer_load_dwordx4 v5, s[48:51], s56 offen lds
    s_add_u32 s56, s56, s13
    s_add_u32 m0, m0, 1056
    s_nop 0
    buffer_load_dwordx4 v5, s[48:51], s56 offen lds
    s_add_u32 s56, s56, s13
    s_add_u32 m0, m0, 1056
    s_nop 0
    buffer_load_dwordx4 v5, s[48:51], s56 offen lds
    s_add_u32 s56, s56, s13
    s_add_u32 m0, m0, 1056
    s_nop 0
    buffer_load_dwordx4 v5, s[48:51], s56 offen lds
    s_lshl_b32 s56, s11, 1
    s_lshl_b32 s57, s56, 10
    s_add_u32 s57, s57, s15
    s_add_u32 m0, s57, 33792
    s_lshl_b32 s57, s13, 3
    s_mul_i32 s56, s56, s57
    s_add_u32 s56, s56, s12
    buffer_load_dwordx4 v6, s[48:51], s56 offen lds
    s_add_u32 s56, s56, s57
    s_add_u32 m0, m0, 1024
    s_nop 0
    buffer_load_dwordx4 v6, s[48:51], s56 offen lds
    s_cmp_eq_u32 s14, 1
    s_cselect_b32 s56, 2, 3
    s_cselect_b32 s57, 16, 4
    v_lshrrev_b32 v7, 4, v11
    v_lshlrev_b32 v7, s56, v7
    v_bfe_u32 v8, v11, 2, 2
    v_add_u32 v7, v7, v8
    v_and_b32 v8, 3, v11
    v_lshlrev_b32 v8, 3, v8
    v_add_u32 v8, s15, v8
    s_mul_i32 s59, s11, 18
    s_lshl_b32 s58, s59, 5
    v_mul_u32_u24 v9, 1056, v7
    v_add3_u32 v9, v9, v8, s58
    s_mul_i32 s58, s57, 1056
    v_add_u32 v4, s58, v9
    v_lshl_add_u32 v12, v7, 7, v8
    v_add_u32 v12, 33792, v12
    s_lshl_b32 s58, s57, 7
    v_add_u32 v13, s58, v12
    v_add_u32 v14, 448, v9
    v_add_u32 v15, 448, v4
    s_cmp_eq_u32 s11, 1
    s_cselect_b64 vcc, -1, 0
    v_cndmask_b32 v12, v14, v12, vcc
    v_cndmask_b32 v13, v15, v13, vcc
    s_mul_i32 s58, s10, 36864
    s_add_u32 s57, s59, 14
    s_lshl_b32 s57, s57, 10
    s_add_u32 s57, s57, s58
    s_lshl_b32 s59, s59, 10
    s_add_u32 s58, s58, s59
    s_waitcnt vmcnt(0)
    s_barrier
    ds_read_b64_tr_b16 v[16:17], v9 offset:0
    ds_read_b64_tr_b16 v[18:19], v4 offset:0
    ds_read_b64_tr_b16 v[20:21], v9 offset:32
    ds_read_b64_tr_b16 v[22:23], v4 offset:32
    ds_read_b64_tr_b16 v[24:25], v9 offset:64
    ds_read_b64_tr_b16 v[26:27], v4 offset:64
    ds_read_b64_tr_b16 v[28:29], v9 offset:96
    ds_read_b64_tr_b16 v[30:31], v4 offset:96
    ds_read_b64_tr_b16 v[32:33], v9 offset:128
    ds_read_b64_tr_b16 v[34:35], v4 offset:128
    ds_read_b64_tr_b16 v[36:37], v9 offset:160
    ds_read_b64_tr_b16 v[38:39], v4 offset:160
    s_waitcnt lgkmcnt(10)
    buffer_store_dwordx4 v[16:19], v5, s[44:47], s58 offen offset:0 sc1
    ds_read_b64_tr_b16 v[40:41], v9 offset:192
    ds_read_b64_tr_b16 v[42:43], v4 offset:192
    s_waitcnt lgkmcnt(10)
    buffer_store_dwordx4 v[20:23], v5, s[44:47], s58 offen offset:1024 sc1
    ds_read_b64_tr_b16 v[44:45], v9 offset:224
    ds_read_b64_tr_b16 v[46:47], v4 offset:224
    s_waitcnt lgkmcnt(10)
    buffer_store_dwordx4 v[24:27], v5, s[44:47], s58 offen offset:2048 sc1
    ds_read_b64_tr_b16 v[16:17], v9 offset:256
    ds_read_b64_tr_b16 v[18:19], v4 offset:256
    s_waitcnt lgkmcnt(10)
    buffer_store_dwordx4 v[28:31], v5, s[44:47], s58 offen offset:3072 sc1
    ds_read_b64_tr_b16 v[20:21], v9 offset:288
    ds_read_b64_tr_b16 v[22:23], v4 offset:288
    s_add_u32 s58, s58, 4096
    s_waitcnt lgkmcnt(10)
    buffer_store_dwordx4 v[32:35], v5, s[44:47], s58 offen offset:0 sc1
    ds_read_b64_tr_b16 v[24:25], v9 offset:320
    ds_read_b64_tr_b16 v[26:27], v4 offset:320
    s_waitcnt lgkmcnt(10)
    buffer_store_dwordx4 v[36:39], v5, s[44:47], s58 offen offset:1024 sc1
    ds_read_b64_tr_b16 v[28:29], v9 offset:352
    ds_read_b64_tr_b16 v[30:31], v4 offset:352
    s_waitcnt lgkmcnt(10)
    buffer_store_dwordx4 v[40:43], v5, s[44:47], s58 offen offset:2048 sc1
    ds_read_b64_tr_b16 v[32:33], v9 offset:384
    ds_read_b64_tr_b16 v[34:35], v4 offset:384
    s_waitcnt lgkmcnt(10)
    buffer_store_dwordx4 v[44:47], v5, s[44:47], s58 offen offset:3072 sc1
    ds_read_b64_tr_b16 v[36:37], v9 offset:416
    ds_read_b64_tr_b16 v[38:39], v4 offset:416
    s_add_u32 s58, s58, 4096
    s_waitcnt lgkmcnt(10)
    buffer_store_dwordx4 v[16:19], v5, s[44:47], s58 offen offset:0 sc1
    ds_read_b64_tr_b16 v[40:41], v12 offset:0
    ds_read_b64_tr_b16 v[42:43], v13 offset:0
    s_waitcnt lgkmcnt(10)
    buffer_store_dwordx4 v[20:23], v5, s[44:47], s58 offen offset:1024 sc1
    ds_read_b64_tr_b16 v[44:45], v12 offset:32
    ds_read_b64_tr_b16 v[46:47], v13 offset:32
    s_waitcnt lgkmcnt(10)
    buffer_store_dwordx4 v[24:27], v5, s[44:47], s58 offen offset:2048 sc1
    ds_read_b64_tr_b16 v[16:17], v12 offset:64
    ds_read_b64_tr_b16 v[18:19], v13 offset:64
    s_waitcnt lgkmcnt(10)
    buffer_store_dwordx4 v[28:31], v5, s[44:47], s58 offen offset:3072 sc1
    ds_read_b64_tr_b16 v[20:21], v12 offset:96
    ds_read_b64_tr_b16 v[22:23], v13 offset:96
    s_add_u32 s58, s58, 4096
    s_waitcnt lgkmcnt(10)
    buffer_store_dwordx4 v[32:35], v5, s[44:47], s58 offen offset:0 sc1
    s_waitcnt lgkmcnt(8)
    buffer_store_dwordx4 v[36:39], v5, s[44:47], s58 offen offset:1024 sc1
    s_waitcnt lgkmcnt(6)
    buffer_store_dwordx4 v[40:43], v5, s[44:47], s57 offen offset:0 sc1
    s_waitcnt lgkmcnt(4)
    buffer_store_dwordx4 v[44:47], v5, s[44:47], s57 offen offset:1024 sc1
    s_waitcnt lgkmcnt(2)
    buffer_store_dwordx4 v[16:19], v5, s[44:47], s57 offen offset:2048 sc1
    s_waitcnt lgkmcnt(0)
    buffer_store_dwordx4 v[20:23], v5, s[44:47], s57 offen offset:3072 sc1
    s_branch sequential_preLN__ssm_conv_h3__mixer_s_mlp__prompt_kernel_rl_done2
sequential_preLN__ssm_conv_h3__mixer_s_mlp__prompt_kernel_rl12:
    s_sub_u32 s10, s11, 9
    s_lshl_b32 s10, s10, 3
    s_add_u32 s10, s10, s5
    s_cmp_ge_u32 s10, 36
    s_cbranch_scc1 sequential_preLN__ssm_conv_h3__mixer_s_mlp__prompt_kernel_misc
    s_mul_i32 s12, s10, 36864
    s_mov_b64 s[48:49], s[30:31]
    s_mov_b32 s50, 663552
    s_movk_i32 s13, 1152
    s_mov_b32 s14, 0
    s_sub_u32 s15, s12, 663552
    s_cmp_ge_u32 s10, 18
    s_cselect_b64 s[48:49], s[32:33], s[48:49]
    s_cselect_b32 s12, s15, s12
    s_mov_b32 s15, 0
    s_mov_b32 s11, s3
    s_and_b32 s49, s49, 0xffff
    s_mov_b32 s51, 0x20000
    v_lshlrev_b32 v5, 4, v11
    v_lshrrev_b32 v6, 3, v11
    v_mul_lo_u32 v6, v6, s13
    v_and_b32 v7, 7, v11
    v_lshl_add_u32 v6, v7, 4, v6
    v_add_u32 v6, 1024, v6
    s_mul_i32 s56, s11, 4
    s_mul_i32 s57, s56, 1056
    s_add_u32 m0, s15, s57
    s_mul_i32 s56, s56, s13
    s_add_u32 s56, s56, s12
    buffer_load_dwordx4 v5, s[48:51], s56 offen lds
    s_add_u32 s56, s56, s13
    s_add_u32 m0, m0, 1056
    s_nop 0
    buffer_load_dwordx4 v5, s[48:51], s56 offen lds
    s_add_u32 s56, s56, s13
    s_add_u32 m0, m0, 1056
    s_nop 0
    buffer_load_dwordx4 v5, s[48:51], s56 offen lds
    s_add_u32 s56, s56, s13
    s_add_u32 m0, m0, 1056
    s_nop 0
    buffer_load_dwordx4 v5, s[48:51], s56 offen lds
    s_and_b32 s56, s11, 3
    s_lshl_b32 s57, s56, 10
    s_add_u32 s57, s57, s15
    s_add_u32 m0, s57, 33792
    s_lshl_b32 s57, s13, 3
    s_mul_i32 s56, s56, s57
    s_add_u32 s56, s56, s12
    buffer_load_dwordx4 v6, s[48:51], s56 offen lds
    s_cmp_eq_u32 s14, 1
    s_cselect_b32 s56, 2, 3
    s_cselect_b32 s57, 16, 4
    v_lshrrev_b32 v7, 4, v11
    v_lshlrev_b32 v7, s56, v7
    v_bfe_u32 v8, v11, 2, 2
    v_add_u32 v7, v7, v8
    v_and_b32 v8, 3, v11
    v_lshlrev_b32 v8, 3, v8
    v_add_u32 v8, s15, v8
    s_mov_b32 s59, s11
    s_lshl_b32 s58, s59, 5
    v_mul_u32_u24 v9, 1056, v7
    v_add3_u32 v9, v9, v8, s58
    s_mul_i32 s58, s57, 1056
    v_add_u32 v4, s58, v9
    v_lshl_add_u32 v12, v7, 7, v8
    v_add_u32 v12, 33792, v12
    s_lshl_b32 s58, s57, 7
    s_lshl_b32 s56, s11, 5
    v_add_u32 v12, s56, v12
    v_add_u32 v13, s58, v12
    v_mov_b32 v14, v9
    v_mov_b32 v15, v4
    s_cmp_lt_u32 s11, 4
    s_cselect_b64 vcc, -1, 0
    v_cndmask_b32 v12, v14, v12, vcc
    v_cndmask_b32 v13, v15, v13, vcc
    s_mul_i32 s58, s10, 36864
    s_cselect_b32 s57, 32, 0
    s_add_u32 s57, s57, s59
    s_lshl_b32 s57, s57, 10
    s_add_u32 s57, s57, s58
    s_lshl_b32 s59, s59, 10
    s_add_u32 s58, s58, s59
    s_waitcnt vmcnt(0)
    s_barrier
    ds_read_b64_tr_b16 v[16:17], v9 offset:0
    ds_read_b64_tr_b16 v[18:19], v4 offset:0
    ds_read_b64_tr_b16 v[20:21], v9 offset:256
    ds_read_b64_tr_b16 v[22:23], v4 offset:256
    ds_read_b64_tr_b16 v[24:25], v9 offset:512
    ds_read_b64_tr_b16 v[26:27], v4 offset:512
    ds_read_b64_tr_b16 v[28:29], v9 offset:768
    ds_read_b64_tr_b16 v[30:31], v4 offset:768
    ds_read_b64_tr_b16 v[32:33], v12 offset:0
    ds_read_b64_tr_b16 v[34:35], v13 offset:0
    s_waitcnt lgkmcnt(8)
    buffer_store_dwordx4 v[16:19], v5, s[44:47], s58 offen offset:0 sc1
    s_nop 1
    s_add_u32 s58, s58, 4096
    s_add_u32 s58, s58, 4096
    s_waitcnt lgkmcnt(6)
    buffer_store_dwordx4 v[20:23], v5, s[44:47], s58 offen offset:0 sc1
    s_nop 1
    s_add_u32 s58, s58, 4096
    s_add_u32 s58, s58, 4096
    s_waitcnt lgkmcnt(4)
    buffer_store_dwordx4 v[24:27], v5, s[44:47], s58 offen offset:0 sc1
    s_nop 1
    s_add_u32 s58, s58, 4096
    s_add_u32 s58, s58, 4096
    s_waitcnt lgkmcnt(2)
    buffer_store_dwordx4 v[28:31], v5, s[44:47], s58 offen offset:0 sc1
    s_waitcnt lgkmcnt(0)
    buffer_store_dwordx4 v[32:35], v5, s[44:47], s57 offen offset:0 sc1
    s_waitcnt vmcnt(0) lgkmcnt(0)
    s_barrier
    s_cmp_lg_u32 s3, 0
    s_cbranch_scc1 sequential_preLN__ssm_conv_h3__mixer_s_mlp__prompt_kernel_cpf
    s_mov_b64 exec, 1
    v_mov_b32 v1, 1
    v_mov_b32 v10, 0
    global_atomic_add v10, v1, s[40:41] offset:0 sc1
    s_mov_b64 exec, -1
sequential_preLN__ssm_conv_h3__mixer_s_mlp__prompt_kernel_cpf:
    s_cmp_ge_u32 s10, 8
    s_cbranch_scc1 sequential_preLN__ssm_conv_h3__mixer_s_mlp__prompt_kernel_common
    v_lshlrev_b32 v12, 7, v0
    s_mov_b32 s12, text_end-text_pc0
    v_cmp_gt_u32 vcc, s12, v12
    s_and_saveexec_b64 s[14:15], vcc
    s_cbranch_execz sequential_preLN__ssm_conv_h3__mixer_s_mlp__prompt_kernel_cpf_done
    global_load_dword v166, v12, s[6:7]
    v_add_u32 v12, 0x10000, v12
    v_cmp_gt_u32 vcc, s12, v12
    s_and_saveexec_b64 s[14:15], vcc
    s_cbranch_execz sequential_preLN__ssm_conv_h3__mixer_s_mlp__prompt_kernel_cpf_done
    s_waitcnt vmcnt(0)
    global_load_dword v166, v12, s[6:7]
    v_add_u32 v12, 0x10000, v12
sequential_preLN__ssm_conv_h3__mixer_s_mlp__prompt_kernel_cpf_done:
    s_mov_b64 exec, -1
    s_branch sequential_preLN__ssm_conv_h3__mixer_s_mlp__prompt_kernel_common
sequential_preLN__ssm_conv_h3__mixer_s_mlp__prompt_kernel_misc:
    s_cmp_lg_u32 s2, 255
    s_cbranch_scc1 sequential_preLN__ssm_conv_h3__mixer_s_mlp__prompt_kernel_common
    s_cmp_lg_u32 s3, 0
    s_cbranch_scc1 sequential_preLN__ssm_conv_h3__mixer_s_mlp__prompt_kernel_common
    v_lshlrev_b32 v12, 7, v11
    v_mov_b32 v16, 0
    s_mov_b32 s12, 40321024
    buffer_store_dword v16, v12, s[44:47], s12 offen sc1
    s_add_u32 s12, s12, 8192
    buffer_store_dword v16, v12, s[44:47], s12 offen sc1
    s_add_u32 s12, s12, 8192
    buffer_store_dword v16, v12, s[44:47], s12 offen sc1
    s_waitcnt vmcnt(0)
    s_mov_b64 exec, 1
    v_mov_b32 v1, 1
    v_mov_b32 v10, 0
    global_atomic_add v10, v1, s[40:41] offset:0 sc1
    s_mov_b64 exec, -1
    s_mov_b64 exec, 1
    v_mov_b32 v1, 1
    v_mov_b32 v10, 0
    global_atomic_add v1, v10, v1, s[40:41] offset:128 sc0 sc1
    s_mov_b64 exec, -1
    s_waitcnt vmcnt(0)
    v_readfirstlane_b32 s12, v1
    s_add_u32 s12, s12, 1
    s_mul_hi_u32 s13, s12, 29620465
    s_mul_i32 s13, s13, 145
    s_cmp_lg_u32 s12, s13
    s_cbranch_scc1 Lya2
    v_lshlrev_b32 v10, 7, v11
    v_mov_b32 v1, 1
    s_mov_b32 s12, 40337408
    s_mov_b32 exec_hi, 0
    buffer_store_dword v1, v10, s[44:47], s12 offen sc1
    s_mov_b32 exec_hi, -1
Lya2:
    s_branch sequential_preLN__ssm_conv_h3__mixer_s_mlp__prompt_kernel_common
sequential_preLN__ssm_conv_h3__mixer_s_mlp__prompt_kernel_rl_done2:
    s_waitcnt lgkmcnt(0)
    s_barrier
sequential_preLN__ssm_conv_h3__mixer_s_mlp__prompt_kernel_common:
    s_nop 7
    v_and_b32 v2, 63, v0
    s_lshl_b32 s6, s5, 3
    s_lshr_b32 s7, s4, 2
    s_add_u32 s6, s6, s7
    s_and_b32 s7, s4, 3
    s_lshl_b32 s8, s6, 5
    s_lshr_b32 s9, s7, 1
    s_add_u32 s9, s9, 1
    s_sub_u32 s10, 0, s9
    s_bitcmp1_b32 s7, 0
    s_cselect_b32 s9, s9, s10
    s_add_u32 s10, s8, s9
    s_lshl_b32 s11, s3, 2
    s_add_u32 s11, s11, s10
    v_and_b32 v5, 3, v2
    v_lshrrev_b32 v6, 2, v2
    v_add_u32 v7, s11, v5
    v_lshlrev_b32 v3, 4, v2
    v_add_u32 v4, 0x1000, v3
    v_and_b32 v15, 15, v2
    v_lshrrev_b32 v12, 4, v2
    s_lshl_b32 s15, s3, 10
    s_mov_b32 s48, s16
    s_and_b32 s49, s17, 0xffff
    s_mov_b32 s50, 2359296
    s_mov_b32 s51, 0x20000
    s_cmp_lt_u32 s4, 18
    s_cbranch_scc1 sequential_preLN__ssm_conv_h3__mixer_s_mlp__prompt_kernel_xdone
    s_mul_i32 s13, s10, 1152
    s_add_u32 s13, s13, s15
    v_add_u32 v8, s13, v3
    s_add_u32 m0, s15, 94208
    s_nop 0
    buffer_load_dwordx4 v8, s[48:51], 0 offen lds
    v_add_u32 v8, 0x2000, v8
    s_add_u32 m0, m0, 8192
    s_nop 0
    buffer_load_dwordx4 v8, s[48:51], 0 offen lds
    v_add_u32 v8, 0x2000, v8
    s_add_u32 m0, m0, 8192
    s_nop 0
    buffer_load_dwordx4 v8, s[48:51], 0 offen lds
    v_add_u32 v8, 0x2000, v8
    s_add_u32 m0, m0, 8192
    s_nop 0
    buffer_load_dwordx4 v8, s[48:51], 0 offen lds
    s_cmp_lt_u32 s3, 4
    s_cselect_b32 s13, 8192, 0
    v_add_u32 v8, s13, v8
    s_add_u32 m0, m0, s13
    s_nop 0
    buffer_load_dwordx4 v8, s[48:51], 0 offen lds
sequential_preLN__ssm_conv_h3__mixer_s_mlp__prompt_kernel_xdone:
    s_add_u32 s52, s42, 11943936
    s_addc_u32 s53, s43, 0
    s_and_b32 s53, s53, 0xffff
    s_mov_b32 s54, 2359296
    s_mov_b32 s55, 0x20000
    s_add_u32 s56, s42, 21381120
    s_addc_u32 s57, s43, 0
    s_and_b32 s57, s57, 0xffff
    s_mov_b32 s58, 32768
    s_mov_b32 s59, 0x20000
    s_mov_b32 s68, s38
    s_and_b32 s69, s39, 0xffff
    s_mov_b32 s70, 2359296
    s_mov_b32 s71, 0x20000
    s_ashr_i32 s12, s10, 4
    s_mul_i32 s13, s12, 18432
    s_add_u32 s13, s13, s15
    v_add_u32 v13, s13, v3
    s_lshl_b32 s13, s3, 2
    v_add_u32 v8, s13, v5
    v_mul_u32_u24 v8, 1152, v8
    v_lshl_add_u32 v8, v6, 3, v8
    v_add_u32 v8, 94208, v8
    v_ashrrev_i32 v9, 4, v7
    v_subrev_u32 v9, s12, v9
    v_mul_u32_u24 v9, 18432, v9
    v_and_b32 v10, 15, v7
    v_lshl_add_u32 v9, v10, 3, v9
    v_lshl_add_u32 v9, v6, 7, v9
    s_mul_i32 s14, s7, 9
    s_add_u32 s14, s14, s3
    s_mov_b32 s60, 0x3ae38e39
    s_mov_b32 s61, 0x3727c5ac
    s_mov_b32 s62, 0xc0135761
    v_mov_b32 v11, 0xbdd2d3e8
    s_mov_b32 s63, 0x3f803f80
    s_lshl_b32 s31, s6, 7
    s_add_u32 s31, s31, 40321024
    s_lshr_b32 s32, s6, 1
    s_lshl_b32 s32, s32, 7
    s_add_u32 s32, s32, 40329216
    s_lshl_b32 s33, s4, 7
    s_add_u32 s36, s33, 40333312
    s_add_u32 s33, s33, 40329216
    s_cmp_lg_u32 s3, 4
    s_cbranch_scc1 sequential_preLN__ssm_conv_h3__mixer_s_mlp__prompt_kernel_ab1
    s_nop 1
    v_readfirstlane_b32 s34, v111
    s_cmp_ge_u32 s34, 37
    s_cbranch_scc1 Lck1
    v_mov_b32 v10, 0
    s_mov_b32 s35, 0
Lpd2:
    global_load_dword v1, v10, s[40:41] offset:0 sc1
    s_add_u32 s35, s35, 1
    s_waitcnt vmcnt(0)
    v_readfirstlane_b32 s34, v1
    s_cmp_ge_u32 s34, 37
    s_cbranch_scc1 Lpd2_x
    s_sleep 16
    s_cmp_lt_u32 s35, 0x80000
    s_cbranch_scc1 Lpd2
Lpd2_x:
Lck1:
    s_waitcnt vmcnt(0)
    s_barrier
    s_add_u32 s37, s73, s3
    s_lshl_b32 s37, s37, 10
    s_add_u32 s37, s37, 0
    buffer_load_dwordx4 a[0:3], v3, s[44:47], s37 offen
    buffer_load_dwordx4 a[72:75], v4, s[44:47], s37 offen
    s_add_u32 s37, s37, 36864
    buffer_load_dwordx4 a[4:7], v3, s[44:47], s37 offen
    buffer_load_dwordx4 a[76:79], v4, s[44:47], s37 offen
    s_add_u32 s37, s37, 36864
    buffer_load_dwordx4 a[8:11], v3, s[44:47], s37 offen
    buffer_load_dwordx4 a[80:83], v4, s[44:47], s37 offen
    s_add_u32 s37, s37, 36864
    buffer_load_dwordx4 a[12:15], v3, s[44:47], s37 offen
    buffer_load_dwordx4 a[84:87], v4, s[44:47], s37 offen
    s_add_u32 s37, s37, 36864
    buffer_load_dwordx4 a[16:19], v3, s[44:47], s37 offen
    buffer_load_dwordx4 v[112:115], v4, s[44:47], s37 offen
    s_add_u32 s37, s37, 36864
    buffer_load_dwordx4 a[20:23], v3, s[44:47], s37 offen
    buffer_load_dwordx4 v[116:119], v4, s[44:47], s37 offen
    s_add_u32 s37, s37, 36864
    buffer_load_dwordx4 a[24:27], v3, s[44:47], s37 offen
    buffer_load_dwordx4 v[120:123], v4, s[44:47], s37 offen
    s_add_u32 s37, s37, 36864
    buffer_load_dwordx4 a[28:31], v3, s[44:47], s37 offen
    buffer_load_dwordx4 v[124:127], v4, s[44:47], s37 offen
    s_add_u32 s37, s37, 36864
    buffer_load_dwordx4 a[32:35], v3, s[44:47], s37 offen
    buffer_load_dwordx4 v[128:131], v4, s[44:47], s37 offen
    s_add_u32 s37, s37, 36864
    buffer_load_dwordx4 a[36:39], v3, s[44:47], s37 offen
    buffer_load_dwordx4 v[132:135], v4, s[44:47], s37 offen
    s_add_u32 s37, s37, 36864
    buffer_load_dwordx4 a[40:43], v3, s[44:47], s37 offen
    buffer_load_dwordx4 v[136:139], v4, s[44:47], s37 offen
    s_add_u32 s37, s37, 36864
    buffer_load_dwordx4 a[44:47], v3, s[44:47], s37 offen
    buffer_load_dwordx4 v[140:143], v4, s[44:47], s37 offen
    s_add_u32 s37, s37, 36864
    buffer_load_dwordx4 a[48:51], v3, s[44:47], s37 offen
    buffer_load_dwordx4 v[144:147], v4, s[44:47], s37 offen
    s_add_u32 s37, s37, 36864
    buffer_load_dwordx4 a[52:55], v3, s[44:47], s37 offen
    buffer_load_dwordx4 v[148:151], v4, s[44:47], s37 offen
    s_add_u32 s37, s37, 36864
    buffer_load_dwordx4 a[56:59], v3, s[44:47], s37 offen
    buffer_load_dwordx4 v[152:155], v4, s[44:47], s37 offen
    s_add_u32 s37, s37, 36864
    buffer_load_dwordx4 a[60:63], v3, s[44:47], s37 offen
    buffer_load_dwordx4 v[156:159], v4, s[44:47], s37 offen
    s_add_u32 s37, s37, 36864
    buffer_load_dwordx4 a[64:67], v3, s[44:47], s37 offen
    buffer_load_dwordx4 v[160:163], v4, s[44:47], s37 offen
    s_add_u32 s37, s37, 36864
    buffer_load_dwordx4 a[68:71], v3, s[44:47], s37 offen
    buffer_load_dwordx4 v[164:167], v4, s[44:47], s37 offen
    s_sub_u32 s20, s4, 18
    s_cmp_ge_u32 s20, 9
    s_cbranch_scc1 La_now34
    s_mov_b64 exec, 1
    v_mov_b32 v1, 1
    v_mov_b32 v10, 0
    global_atomic_add v10, v1, s[40:41] offset:64 sc1
    s_mov_b64 exec, -1
La_now34:
    ds_read_b64 v[16:17], v8 offset:0
    ds_read_b64 v[18:19], v8 offset:128
    ds_read_b64 v[20:21], v8 offset:256
    ds_read_b64 v[22:23], v8 offset:384
    ds_read_b64 v[24:25], v8 offset:512
    ds_read_b64 v[26:27], v8 offset:640
    ds_read_b64 v[28:29], v8 offset:768
    ds_read_b64 v[30:31], v8 offset:896
    ds_read_b64 v[32:33], v8 offset:1024
    v_mov_b32 v96, 0
    v_mov_b32 v107, 0
    v_mov_b32 v97, 0
    v_mov_b32 v108, 0
    s_waitcnt lgkmcnt(8)
    v_dot2c_f32_bf16 v96, s63, v16
    v_dot2c_f32_bf16 v97, v16, v16
    v_lshlrev_b32 v52, 16, v16
    v_and_b32 v53, 0xffff0000, v16
    v_dot2c_f32_bf16 v107, s63, v17
    v_dot2c_f32_bf16 v108, v17, v17
    v_lshlrev_b32 v54, 16, v17
    v_and_b32 v55, 0xffff0000, v17
    s_waitcnt lgkmcnt(7)
    v_dot2c_f32_bf16 v96, s63, v18
    v_dot2c_f32_bf16 v97, v18, v18
    v_lshlrev_b32 v56, 16, v18
    v_and_b32 v57, 0xffff0000, v18
    v_dot2c_f32_bf16 v107, s63, v19
    v_dot2c_f32_bf16 v108, v19, v19
    v_lshlrev_b32 v58, 16, v19
    v_and_b32 v59, 0xffff0000, v19
    s_waitcnt lgkmcnt(6)
    v_dot2c_f32_bf16 v96, s63, v20
    v_dot2c_f32_bf16 v97, v20, v20
    v_lshlrev_b32 v60, 16, v20
    v_and_b32 v61, 0xffff0000, v20
    v_dot2c_f32_bf16 v107, s63, v21
    v_dot2c_f32_bf16 v108, v21, v21
    v_lshlrev_b32 v62, 16, v21
    v_and_b32 v63, 0xffff0000, v21
    s_waitcnt lgkmcnt(5)
    v_dot2c_f32_bf16 v96, s63, v22
    v_dot2c_f32_bf16 v97, v22, v22
    v_lshlrev_b32 v64, 16, v22
    v_and_b32 v65, 0xffff0000, v22
    v_dot2c_f32_bf16 v107, s63, v23
    v_dot2c_f32_bf16 v108, v23, v23
    v_lshlrev_b32 v66, 16, v23
    v_and_b32 v67, 0xffff0000, v23
    s_waitcnt lgkmcnt(4)
    v_dot2c_f32_bf16 v96, s63, v24
    v_dot2c_f32_bf16 v97, v24, v24
    v_lshlrev_b32 v68, 16, v24
    v_and_b32 v69, 0xffff0000, v24
    v_dot2c_f32_bf16 v107, s63, v25
    v_dot2c_f32_bf16 v108, v25, v25
    v_lshlrev_b32 v70, 16, v25
    v_and_b32 v71, 0xffff0000, v25
    s_waitcnt lgkmcnt(3)
    v_dot2c_f32_bf16 v96, s63, v26
    v_dot2c_f32_bf16 v97, v26, v26
    v_lshlrev_b32 v72, 16, v26
    v_and_b32 v73, 0xffff0000, v26
    v_dot2c_f32_bf16 v107, s63, v27
    v_dot2c_f32_bf16 v108, v27, v27
    v_lshlrev_b32 v74, 16, v27
    v_and_b32 v75, 0xffff0000, v27
    s_waitcnt lgkmcnt(2)
    v_dot2c_f32_bf16 v96, s63, v28
    v_dot2c_f32_bf16 v97, v28, v28
    v_lshlrev_b32 v76, 16, v28
    v_and_b32 v77, 0xffff0000, v28
    v_dot2c_f32_bf16 v107, s63, v29
    v_dot2c_f32_bf16 v108, v29, v29
    v_lshlrev_b32 v78, 16, v29
    v_and_b32 v79, 0xffff0000, v29
    s_waitcnt lgkmcnt(1)
    v_dot2c_f32_bf16 v96, s63, v30
    v_dot2c_f32_bf16 v97, v30, v30
    v_lshlrev_b32 v80, 16, v30
    v_and_b32 v81, 0xffff0000, v30
    v_dot2c_f32_bf16 v107, s63, v31
    v_dot2c_f32_bf16 v108, v31, v31
    v_lshlrev_b32 v82, 16, v31
    v_and_b32 v83, 0xffff0000, v31
    s_waitcnt lgkmcnt(0)
    v_dot2c_f32_bf16 v96, s63, v32
    v_dot2c_f32_bf16 v97, v32, v32
    v_lshlrev_b32 v84, 16, v32
    v_and_b32 v85, 0xffff0000, v32
    v_dot2c_f32_bf16 v107, s63, v33
    v_dot2c_f32_bf16 v108, v33, v33
    v_lshlrev_b32 v86, 16, v33
    v_and_b32 v87, 0xffff0000, v33
    v_add_f32 v96, v96, v107
    v_add_f32 v97, v97, v108
    s_nop 0
    v_add_f32_dpp v96, v96, v96 row_ror:4 row_mask:0xf bank_mask:0xf
    v_add_f32_dpp v97, v97, v97 row_ror:4 row_mask:0xf bank_mask:0xf
    s_nop 0
    v_add_f32_dpp v96, v96, v96 row_ror:8 row_mask:0xf bank_mask:0xf
    v_add_f32_dpp v97, v97, v97 row_ror:8 row_mask:0xf bank_mask:0xf
    v_mov_b32 v99, v96
    v_mov_b32 v104, v97
    s_nop 0
    v_permlane16_swap_b32 v96, v99
    v_permlane16_swap_b32 v97, v104
    v_add_f32 v96, v96, v99
    v_add_f32 v97, v97, v104
    v_mov_b32 v99, v96
    v_mov_b32 v104, v97
    s_nop 0
    v_permlane32_swap_b32 v96, v99
    v_permlane32_swap_b32 v97, v104
    v_add_f32 v96, v96, v99
    v_add_f32 v97, v97, v104
    v_mul_f32 v100, s60, v96
    v_mul_f32 v97, s60, v97
    v_fma_f32 v97, -v100, v100, v97
    v_max_f32 v97, 0, v97
    v_add_f32 v97, s61, v97
    v_rsq_f32 v101, v97
    s_nop 0
    v_mul_f32 v98, v100, v101
    v_sub_f32 v98, 0, v98
    s_lshl_b32 s20, s4, 7
    s_add_u32 s20, s20, 40337408
    s_cmp_lg_u32 s3, 4
    s_cbranch_scc1 Lw3_done
    v_mov_b32 v10, 0
    s_mov_b32 s35, 0
Lw3_0:
    buffer_load_dword v1, v10, s[44:47], s20 offen sc1
    s_add_u32 s35, s35, 1
    s_waitcnt vmcnt(0)
    v_readfirstlane_b32 s34, v1
    s_cmp_gt_u32 s35, 0x80000
    s_cbranch_scc1 Lw3_done
    s_cmp_lg_u32 s34, 1
    s_cbranch_scc1 Lw3_0
Lw3_done:
    s_barrier
    s_add_u32 m0, s15, 0
    s_nop 0
    buffer_load_dwordx4 v13, s[52:55], 0 offen sc1 lds
    v_add_u32 v13, 0x2000, v13
    s_add_u32 m0, m0, 8192
    s_nop 0
    buffer_load_dwordx4 v13, s[52:55], 0 offen sc1 lds
    v_add_u32 v13, 0x2000, v13
    s_add_u32 m0, m0, 8192
    s_nop 0
    buffer_load_dwordx4 v13, s[52:55], 0 offen sc1 lds
    v_add_u32 v13, 0x2000, v13
    s_add_u32 m0, m0, 8192
    s_nop 0
    buffer_load_dwordx4 v13, s[52:55], 0 offen sc1 lds
    v_add_u32 v13, 0x2000, v13
    s_add_u32 m0, m0, 8192
    s_nop 0
    buffer_load_dwordx4 v13, s[52:55], 0 offen sc1 lds
    v_add_u32 v13, 0x2000, v13
    s_add_u32 m0, m0, 8192
    s_nop 0
    buffer_load_dwordx4 v13, s[52:55], 0 offen sc1 lds
    s_cmp_lt_u32 s3, 6
    s_cselect_b32 s13, 8192, 0
    v_add_u32 v13, s13, v13
    s_add_u32 m0, m0, s13
    s_nop 0
    buffer_load_dwordx4 v13, s[52:55], 0 offen sc1 lds
    v_mov_b32 v10, 0
    global_load_dword v110, v10, s[40:41] offset:64 sc1
    s_waitcnt vmcnt(0)
    s_barrier
    ds_read_b64 v[34:35], v9 offset:0
    ds_read_b64 v[36:37], v9 offset:2048
    ds_read_b64 v[38:39], v9 offset:4096
    ds_read_b64 v[40:41], v9 offset:6144
    ds_read_b64 v[42:43], v9 offset:8192
    ds_read_b64 v[44:45], v9 offset:10240
    ds_read_b64 v[46:47], v9 offset:12288
    ds_read_b64 v[48:49], v9 offset:14336
    ds_read_b64 v[50:51], v9 offset:16384
    v_mov_b32 v96, 0
    v_mov_b32 v107, 0
    v_mov_b32 v97, 0
    v_mov_b32 v108, 0
    s_waitcnt lgkmcnt(8)
    v_lshlrev_b32 v88, 16, v34
    v_and_b32 v89, 0xffff0000, v34
    v_lshlrev_b32 v90, 16, v35
    v_and_b32 v91, 0xffff0000, v35
    v_fma_f32 v92, v52, v101, v98
    v_fma_f32 v93, v53, v101, v98
    v_fma_f32 v94, v54, v101, v98
    v_fma_f32 v95, v55, v101, v98
    v_fma_f32 v52, v92, v88, v52
    v_fma_f32 v53, v93, v89, v53
    v_fma_f32 v54, v94, v90, v54
    v_fma_f32 v55, v95, v91, v55
    v_add_f32 v96, v96, v52
    v_fmac_f32 v97, v52, v52
    v_add_f32 v107, v107, v53
    v_fmac_f32 v108, v53, v53
    v_add_f32 v96, v96, v54
    v_fmac_f32 v97, v54, v54
    v_add_f32 v107, v107, v55
    v_fmac_f32 v108, v55, v55
    s_waitcnt lgkmcnt(7)
    v_lshlrev_b32 v88, 16, v36
    v_and_b32 v89, 0xffff0000, v36
    v_lshlrev_b32 v90, 16, v37
    v_and_b32 v91, 0xffff0000, v37
    v_fma_f32 v92, v56, v101, v98
    v_fma_f32 v93, v57, v101, v98
    v_fma_f32 v94, v58, v101, v98
    v_fma_f32 v95, v59, v101, v98
    v_fma_f32 v56, v92, v88, v56
    v_fma_f32 v57, v93, v89, v57
    v_fma_f32 v58, v94, v90, v58
    v_fma_f32 v59, v95, v91, v59
    v_add_f32 v96, v96, v56
    v_fmac_f32 v97, v56, v56
    v_add_f32 v107, v107, v57
    v_fmac_f32 v108, v57, v57
    v_add_f32 v96, v96, v58
    v_fmac_f32 v97, v58, v58
    v_add_f32 v107, v107, v59
    v_fmac_f32 v108, v59, v59
    s_waitcnt lgkmcnt(6)
    v_lshlrev_b32 v88, 16, v38
    v_and_b32 v89, 0xffff0000, v38
    v_lshlrev_b32 v90, 16, v39
    v_and_b32 v91, 0xffff0000, v39
    v_fma_f32 v92, v60, v101, v98
    v_fma_f32 v93, v61, v101, v98
    v_fma_f32 v94, v62, v101, v98
    v_fma_f32 v95, v63, v101, v98
    v_fma_f32 v60, v92, v88, v60
    v_fma_f32 v61, v93, v89, v61
    v_fma_f32 v62, v94, v90, v62
    v_fma_f32 v63, v95, v91, v63
    v_add_f32 v96, v96, v60
    v_fmac_f32 v97, v60, v60
    v_add_f32 v107, v107, v61
    v_fmac_f32 v108, v61, v61
    v_add_f32 v96, v96, v62
    v_fmac_f32 v97, v62, v62
    v_add_f32 v107, v107, v63
    v_fmac_f32 v108, v63, v63
    s_waitcnt lgkmcnt(5)
    v_lshlrev_b32 v88, 16, v40
    v_and_b32 v89, 0xffff0000, v40
    v_lshlrev_b32 v90, 16, v41
    v_and_b32 v91, 0xffff0000, v41
    v_fma_f32 v92, v64, v101, v98
    v_fma_f32 v93, v65, v101, v98
    v_fma_f32 v94, v66, v101, v98
    v_fma_f32 v95, v67, v101, v98
    v_fma_f32 v64, v92, v88, v64
    v_fma_f32 v65, v93, v89, v65
    v_fma_f32 v66, v94, v90, v66
    v_fma_f32 v67, v95, v91, v67
    v_add_f32 v96, v96, v64
    v_fmac_f32 v97, v64, v64
    v_add_f32 v107, v107, v65
    v_fmac_f32 v108, v65, v65
    v_add_f32 v96, v96, v66
    v_fmac_f32 v97, v66, v66
    v_add_f32 v107, v107, v67
    v_fmac_f32 v108, v67, v67
    s_waitcnt lgkmcnt(4)
    v_lshlrev_b32 v88, 16, v42
    v_and_b32 v89, 0xffff0000, v42
    v_lshlrev_b32 v90, 16, v43
    v_and_b32 v91, 0xffff0000, v43
    v_fma_f32 v92, v68, v101, v98
    v_fma_f32 v93, v69, v101, v98
    v_fma_f32 v94, v70, v101, v98
    v_fma_f32 v95, v71, v101, v98
    v_fma_f32 v68, v92, v88, v68
    v_fma_f32 v69, v93, v89, v69
    v_fma_f32 v70, v94, v90, v70
    v_fma_f32 v71, v95, v91, v71
    v_add_f32 v96, v96, v68
    v_fmac_f32 v97, v68, v68
    v_add_f32 v107, v107, v69
    v_fmac_f32 v108, v69, v69
    v_add_f32 v96, v96, v70
    v_fmac_f32 v97, v70, v70
    v_add_f32 v107, v107, v71
    v_fmac_f32 v108, v71, v71
    s_waitcnt lgkmcnt(3)
    v_lshlrev_b32 v88, 16, v44
    v_and_b32 v89, 0xffff0000, v44
    v_lshlrev_b32 v90, 16, v45
    v_and_b32 v91, 0xffff0000, v45
    v_fma_f32 v92, v72, v101, v98
    v_fma_f32 v93, v73, v101, v98
    v_fma_f32 v94, v74, v101, v98
    v_fma_f32 v95, v75, v101, v98
    v_fma_f32 v72, v92, v88, v72
    v_fma_f32 v73, v93, v89, v73
    v_fma_f32 v74, v94, v90, v74
    v_fma_f32 v75, v95, v91, v75
    v_add_f32 v96, v96, v72
    v_fmac_f32 v97, v72, v72
    v_add_f32 v107, v107, v73
    v_fmac_f32 v108, v73, v73
    v_add_f32 v96, v96, v74
    v_fmac_f32 v97, v74, v74
    v_add_f32 v107, v107, v75
    v_fmac_f32 v108, v75, v75
    s_waitcnt lgkmcnt(2)
    v_lshlrev_b32 v88, 16, v46
    v_and_b32 v89, 0xffff0000, v46
    v_lshlrev_b32 v90, 16, v47
    v_and_b32 v91, 0xffff0000, v47
    v_fma_f32 v92, v76, v101, v98
    v_fma_f32 v93, v77, v101, v98
    v_fma_f32 v94, v78, v101, v98
    v_fma_f32 v95, v79, v101, v98
    v_fma_f32 v76, v92, v88, v76
    v_fma_f32 v77, v93, v89, v77
    v_fma_f32 v78, v94, v90, v78
    v_fma_f32 v79, v95, v91, v79
    v_add_f32 v96, v96, v76
    v_fmac_f32 v97, v76, v76
    v_add_f32 v107, v107, v77
    v_fmac_f32 v108, v77, v77
    v_add_f32 v96, v96, v78
    v_fmac_f32 v97, v78, v78
    v_add_f32 v107, v107, v79
    v_fmac_f32 v108, v79, v79
    s_waitcnt lgkmcnt(1)
    v_lshlrev_b32 v88, 16, v48
    v_and_b32 v89, 0xffff0000, v48
    v_lshlrev_b32 v90, 16, v49
    v_and_b32 v91, 0xffff0000, v49
    v_fma_f32 v92, v80, v101, v98
    v_fma_f32 v93, v81, v101, v98
    v_fma_f32 v94, v82, v101, v98
    v_fma_f32 v95, v83, v101, v98
    v_fma_f32 v80, v92, v88, v80
    v_fma_f32 v81, v93, v89, v81
    v_fma_f32 v82, v94, v90, v82
    v_fma_f32 v83, v95, v91, v83
    v_add_f32 v96, v96, v80
    v_fmac_f32 v97, v80, v80
    v_add_f32 v107, v107, v81
    v_fmac_f32 v108, v81, v81
    v_add_f32 v96, v96, v82
    v_fmac_f32 v97, v82, v82
    v_add_f32 v107, v107, v83
    v_fmac_f32 v108, v83, v83
    s_waitcnt lgkmcnt(0)
    v_lshlrev_b32 v88, 16, v50
    v_and_b32 v89, 0xffff0000, v50
    v_lshlrev_b32 v90, 16, v51
    v_and_b32 v91, 0xffff0000, v51
    v_fma_f32 v92, v84, v101, v98
    v_fma_f32 v93, v85, v101, v98
    v_fma_f32 v94, v86, v101, v98
    v_fma_f32 v95, v87, v101, v98
    v_fma_f32 v84, v92, v88, v84
    v_fma_f32 v85, v93, v89, v85
    v_fma_f32 v86, v94, v90, v86
    v_fma_f32 v87, v95, v91, v87
    v_add_f32 v96, v96, v84
    v_fmac_f32 v97, v84, v84
    v_add_f32 v107, v107, v85
    v_fmac_f32 v108, v85, v85
    v_add_f32 v96, v96, v86
    v_fmac_f32 v97, v86, v86
    v_add_f32 v107, v107, v87
    v_fmac_f32 v108, v87, v87
    v_add_f32 v96, v96, v107
    v_add_f32 v97, v97, v108
    s_nop 0
    v_add_f32_dpp v96, v96, v96 row_ror:4 row_mask:0xf bank_mask:0xf
    v_add_f32_dpp v97, v97, v97 row_ror:4 row_mask:0xf bank_mask:0xf
    s_nop 0
    v_add_f32_dpp v96, v96, v96 row_ror:8 row_mask:0xf bank_mask:0xf
    v_add_f32_dpp v97, v97, v97 row_ror:8 row_mask:0xf bank_mask:0xf
    v_mov_b32 v99, v96
    v_mov_b32 v104, v97
    s_nop 0
    v_permlane16_swap_b32 v96, v99
    v_permlane16_swap_b32 v97, v104
    v_add_f32 v96, v96, v99
    v_add_f32 v97, v97, v104
    v_mov_b32 v99, v96
    v_mov_b32 v104, v97
    s_nop 0
    v_permlane32_swap_b32 v96, v99
    v_permlane32_swap_b32 v97, v104
    v_add_f32 v96, v96, v99
    v_add_f32 v97, v97, v104
    v_mul_f32 v102, s60, v96
    v_mul_f32 v97, s60, v97
    v_fma_f32 v97, -v102, v102, v97
    v_max_f32 v97, 0, v97
    v_add_f32 v97, s61, v97
    v_rsq_f32 v103, v97
    s_nop 0
    v_mul_f32 v98, v102, v103
    v_sub_f32 v98, 0, v98
    v_lshlrev_b32 v13, 4, v7
    s_mov_b64 exec, 15
    buffer_store_dwordx4 v[100:103], v13, s[56:59], 0 offen sc1
    s_mov_b64 exec, -1
    v_mul_f32 v105, v103, v103
    v_subrev_f32 v97, s61, v97
    v_mul_f32 v105, v105, v97
    v_add_f32 v105, s61, v105
    v_rsq_f32 v106, v105
    s_nop 0
    v_mul_f32 v98, v98, v106
    v_mul_f32 v106, v106, v103
    s_lshl_b32 s15, s3, 2
    v_add_u32 v13, s15, v5
    v_mul_u32_u24 v13, 1184, v13
    v_lshl_add_u32 v13, v6, 3, v13
    v_add_u32 v13, 55296, v13
    v_fma_f32 v52, v52, v106, v98
    v_fma_f32 v53, v53, v106, v98
    v_fma_f32 v54, v54, v106, v98
    v_fma_f32 v55, v55, v106, v98
    v_cvt_pk_bf16_f32 v16, v52, v53
    v_cvt_pk_bf16_f32 v17, v54, v55
    ds_write_b64 v13, v[16:17] offset:0
    v_fma_f32 v56, v56, v106, v98
    v_fma_f32 v57, v57, v106, v98
    v_fma_f32 v58, v58, v106, v98
    v_fma_f32 v59, v59, v106, v98
    v_cvt_pk_bf16_f32 v18, v56, v57
    v_cvt_pk_bf16_f32 v19, v58, v59
    ds_write_b64 v13, v[18:19] offset:128
    v_fma_f32 v60, v60, v106, v98
    v_fma_f32 v61, v61, v106, v98
    v_fma_f32 v62, v62, v106, v98
    v_fma_f32 v63, v63, v106, v98
    v_cvt_pk_bf16_f32 v20, v60, v61
    v_cvt_pk_bf16_f32 v21, v62, v63
    ds_write_b64 v13, v[20:21] offset:256
    v_fma_f32 v64, v64, v106, v98
    v_fma_f32 v65, v65, v106, v98
    v_fma_f32 v66, v66, v106, v98
    v_fma_f32 v67, v67, v106, v98
    v_cvt_pk_bf16_f32 v22, v64, v65
    v_cvt_pk_bf16_f32 v23, v66, v67
    ds_write_b64 v13, v[22:23] offset:384
    v_fma_f32 v68, v68, v106, v98
    v_fma_f32 v69, v69, v106, v98
    v_fma_f32 v70, v70, v106, v98
    v_fma_f32 v71, v71, v106, v98
    v_cvt_pk_bf16_f32 v24, v68, v69
    v_cvt_pk_bf16_f32 v25, v70, v71
    ds_write_b64 v13, v[24:25] offset:512
    v_fma_f32 v72, v72, v106, v98
    v_fma_f32 v73, v73, v106, v98
    v_fma_f32 v74, v74, v106, v98
    v_fma_f32 v75, v75, v106, v98
    v_cvt_pk_bf16_f32 v26, v72, v73
    v_cvt_pk_bf16_f32 v27, v74, v75
    ds_write_b64 v13, v[26:27] offset:640
    v_fma_f32 v76, v76, v106, v98
    v_fma_f32 v77, v77, v106, v98
    v_fma_f32 v78, v78, v106, v98
    v_fma_f32 v79, v79, v106, v98
    v_cvt_pk_bf16_f32 v28, v76, v77
    v_cvt_pk_bf16_f32 v29, v78, v79
    ds_write_b64 v13, v[28:29] offset:768
    v_fma_f32 v80, v80, v106, v98
    v_fma_f32 v81, v81, v106, v98
    v_fma_f32 v82, v82, v106, v98
    v_fma_f32 v83, v83, v106, v98
    v_cvt_pk_bf16_f32 v30, v80, v81
    v_cvt_pk_bf16_f32 v31, v82, v83
    ds_write_b64 v13, v[30:31] offset:896
    v_fma_f32 v84, v84, v106, v98
    v_fma_f32 v85, v85, v106, v98
    v_fma_f32 v86, v86, v106, v98
    v_fma_f32 v87, v87, v106, v98
    v_cvt_pk_bf16_f32 v32, v84, v85
    v_cvt_pk_bf16_f32 v33, v86, v87
    ds_write_b64 v13, v[32:33] offset:1024
    v_mul_u32_u24 v14, 1184, v15
    v_lshl_add_u32 v14, v12, 4, v14
    v_add_u32 v14, 55296, v14
    s_waitcnt lgkmcnt(0)
    s_barrier
    s_add_u32 s37, s73, s3
    s_lshl_b32 s37, s37, 10
    s_add_u32 s37, s37, 663552
    ds_read_b128 v[68:71], v14 offset:0
    ds_read_b128 v[72:75], v14 offset:18944
    ds_read_b128 v[76:79], v14 offset:64
    ds_read_b128 v[80:83], v14 offset:19008
    ds_read_b128 v[84:87], v14 offset:128
    ds_read_b128 v[88:91], v14 offset:19072
    ds_read_b128 v[92:95], v14 offset:192
    ds_read_b128 v[96:99], v14 offset:19136
    s_waitcnt lgkmcnt(7)
    v_mfma_f32_16x16x32_bf16 v[52:55], a[0:3], v[68:71], 0
    s_waitcnt lgkmcnt(6)
    v_mfma_f32_16x16x32_bf16 v[56:59], a[0:3], v[72:75], 0
    v_mfma_f32_16x16x32_bf16 v[60:63], a[72:75], v[68:71], 0
    v_mfma_f32_16x16x32_bf16 v[64:67], a[72:75], v[72:75], 0
    buffer_load_dwordx4 a[0:3], v3, s[44:47], s37 offen
    buffer_load_dwordx4 a[72:75], v4, s[44:47], s37 offen
    s_add_u32 s37, s37, 36864
    ds_read_b128 v[68:71], v14 offset:256
    ds_read_b128 v[72:75], v14 offset:19200
    s_waitcnt lgkmcnt(7)
    v_mfma_f32_16x16x32_bf16 v[52:55], a[4:7], v[76:79], v[52:55]
    s_waitcnt lgkmcnt(6)
    v_mfma_f32_16x16x32_bf16 v[56:59], a[4:7], v[80:83], v[56:59]
    v_mfma_f32_16x16x32_bf16 v[60:63], a[76:79], v[76:79], v[60:63]
    v_mfma_f32_16x16x32_bf16 v[64:67], a[76:79], v[80:83], v[64:67]
    buffer_load_dwordx4 a[4:7], v3, s[44:47], s37 offen
    buffer_load_dwordx4 a[76:79], v4, s[44:47], s37 offen
    s_add_u32 s37, s37, 36864
    ds_read_b128 v[76:79], v14 offset:320
    ds_read_b128 v[80:83], v14 offset:19264
    s_waitcnt lgkmcnt(7)
    v_mfma_f32_16x16x32_bf16 v[52:55], a[8:11], v[84:87], v[52:55]
    s_waitcnt lgkmcnt(6)
    v_mfma_f32_16x16x32_bf16 v[56:59], a[8:11], v[88:91], v[56:59]
    v_mfma_f32_16x16x32_bf16 v[60:63], a[80:83], v[84:87], v[60:63]
    v_mfma_f32_16x16x32_bf16 v[64:67], a[80:83], v[88:91], v[64:67]
    buffer_load_dwordx4 a[8:11], v3, s[44:47], s37 offen
    buffer_load_dwordx4 a[80:83], v4, s[44:47], s37 offen
    s_add_u32 s37, s37, 36864
    ds_read_b128 v[84:87], v14 offset:384
    ds_read_b128 v[88:91], v14 offset:19328
    s_waitcnt lgkmcnt(7)
    v_mfma_f32_16x16x32_bf16 v[52:55], a[12:15], v[92:95], v[52:55]
    s_waitcnt lgkmcnt(6)
    v_mfma_f32_16x16x32_bf16 v[56:59], a[12:15], v[96:99], v[56:59]
    v_mfma_f32_16x16x32_bf16 v[60:63], a[84:87], v[92:95], v[60:63]
    v_mfma_f32_16x16x32_bf16 v[64:67], a[84:87], v[96:99], v[64:67]
    buffer_load_dwordx4 a[12:15], v3, s[44:47], s37 offen
    buffer_load_dwordx4 a[84:87], v4, s[44:47], s37 offen
    s_add_u32 s37, s37, 36864
    ds_read_b128 v[92:95], v14 offset:448
    ds_read_b128 v[96:99], v14 offset:19392
    s_waitcnt lgkmcnt(7)
    v_mfma_f32_16x16x32_bf16 v[52:55], a[16:19], v[68:71], v[52:55]
    s_waitcnt lgkmcnt(6)
    v_mfma_f32_16x16x32_bf16 v[56:59], a[16:19], v[72:75], v[56:59]
    v_mfma_f32_16x16x32_bf16 v[60:63], v[112:115], v[68:71], v[60:63]
    v_mfma_f32_16x16x32_bf16 v[64:67], v[112:115], v[72:75], v[64:67]
    buffer_load_dwordx4 a[16:19], v3, s[44:47], s37 offen
    buffer_load_dwordx4 v[112:115], v4, s[44:47], s37 offen
    s_add_u32 s37, s37, 36864
    ds_read_b128 v[68:71], v14 offset:512
    ds_read_b128 v[72:75], v14 offset:19456
    s_waitcnt lgkmcnt(7)
    v_mfma_f32_16x16x32_bf16 v[52:55], a[20:23], v[76:79], v[52:55]
    s_waitcnt lgkmcnt(6)
    v_mfma_f32_16x16x32_bf16 v[56:59], a[20:23], v[80:83], v[56:59]
    v_mfma_f32_16x16x32_bf16 v[60:63], v[116:119], v[76:79], v[60:63]
    v_mfma_f32_16x16x32_bf16 v[64:67], v[116:119], v[80:83], v[64:67]
    buffer_load_dwordx4 a[20:23], v3, s[44:47], s37 offen
    buffer_load_dwordx4 v[116:119], v4, s[44:47], s37 offen
    s_add_u32 s37, s37, 36864
    ds_read_b128 v[76:79], v14 offset:576
    ds_read_b128 v[80:83], v14 offset:19520
    s_waitcnt lgkmcnt(7)
    v_mfma_f32_16x16x32_bf16 v[52:55], a[24:27], v[84:87], v[52:55]
    s_waitcnt lgkmcnt(6)
    v_mfma_f32_16x16x32_bf16 v[56:59], a[24:27], v[88:91], v[56:59]
    v_mfma_f32_16x16x32_bf16 v[60:63], v[120:123], v[84:87], v[60:63]
    v_mfma_f32_16x16x32_bf16 v[64:67], v[120:123], v[88:91], v[64:67]
    buffer_load_dwordx4 a[24:27], v3, s[44:47], s37 offen
    buffer_load_dwordx4 v[120:123], v4, s[44:47], s37 offen
    s_add_u32 s37, s37, 36864
    ds_read_b128 v[84:87], v14 offset:640
    ds_read_b128 v[88:91], v14 offset:19584
    s_waitcnt lgkmcnt(7)
    v_mfma_f32_16x16x32_bf16 v[52:55], a[28:31], v[92:95], v[52:55]
    s_waitcnt lgkmcnt(6)
    v_mfma_f32_16x16x32_bf16 v[56:59], a[28:31], v[96:99], v[56:59]
    v_mfma_f32_16x16x32_bf16 v[60:63], v[124:127], v[92:95], v[60:63]
    v_mfma_f32_16x16x32_bf16 v[64:67], v[124:127], v[96:99], v[64:67]
    buffer_load_dwordx4 a[28:31], v3, s[44:47], s37 offen
    buffer_load_dwordx4 v[124:127], v4, s[44:47], s37 offen
    s_add_u32 s37, s37, 36864
    ds_read_b128 v[92:95], v14 offset:704
    ds_read_b128 v[96:99], v14 offset:19648
    s_waitcnt lgkmcnt(7)
    v_mfma_f32_16x16x32_bf16 v[52:55], a[32:35], v[68:71], v[52:55]
    s_waitcnt lgkmcnt(6)
    v_mfma_f32_16x16x32_bf16 v[56:59], a[32:35], v[72:75], v[56:59]
    v_mfma_f32_16x16x32_bf16 v[60:63], v[128:131], v[68:71], v[60:63]
    v_mfma_f32_16x16x32_bf16 v[64:67], v[128:131], v[72:75], v[64:67]
    buffer_load_dwordx4 a[32:35], v3, s[44:47], s37 offen
    buffer_load_dwordx4 v[128:131], v4, s[44:47], s37 offen
    s_add_u32 s37, s37, 36864
    ds_read_b128 v[68:71], v14 offset:768
    ds_read_b128 v[72:75], v14 offset:19712
    s_waitcnt lgkmcnt(7)
    v_mfma_f32_16x16x32_bf16 v[52:55], a[36:39], v[76:79], v[52:55]
    s_waitcnt lgkmcnt(6)
    v_mfma_f32_16x16x32_bf16 v[56:59], a[36:39], v[80:83], v[56:59]
    v_mfma_f32_16x16x32_bf16 v[60:63], v[132:135], v[76:79], v[60:63]
    v_mfma_f32_16x16x32_bf16 v[64:67], v[132:135], v[80:83], v[64:67]
    buffer_load_dwordx4 a[36:39], v3, s[44:47], s37 offen
    buffer_load_dwordx4 v[132:135], v4, s[44:47], s37 offen
    s_add_u32 s37, s37, 36864
    ds_read_b128 v[76:79], v14 offset:832
    ds_read_b128 v[80:83], v14 offset:19776
    s_waitcnt lgkmcnt(7)
    v_mfma_f32_16x16x32_bf16 v[52:55], a[40:43], v[84:87], v[52:55]
    s_waitcnt lgkmcnt(6)
    v_mfma_f32_16x16x32_bf16 v[56:59], a[40:43], v[88:91], v[56:59]
    v_mfma_f32_16x16x32_bf16 v[60:63], v[136:139], v[84:87], v[60:63]
    v_mfma_f32_16x16x32_bf16 v[64:67], v[136:139], v[88:91], v[64:67]
    buffer_load_dwordx4 a[40:43], v3, s[44:47], s37 offen
    buffer_load_dwordx4 v[136:139], v4, s[44:47], s37 offen
    s_add_u32 s37, s37, 36864
    ds_read_b128 v[84:87], v14 offset:896
    ds_read_b128 v[88:91], v14 offset:19840
    s_waitcnt lgkmcnt(7)
    v_mfma_f32_16x16x32_bf16 v[52:55], a[44:47], v[92:95], v[52:55]
    s_waitcnt lgkmcnt(6)
    v_mfma_f32_16x16x32_bf16 v[56:59], a[44:47], v[96:99], v[56:59]
    v_mfma_f32_16x16x32_bf16 v[60:63], v[140:143], v[92:95], v[60:63]
    v_mfma_f32_16x16x32_bf16 v[64:67], v[140:143], v[96:99], v[64:67]
    buffer_load_dwordx4 a[44:47], v3, s[44:47], s37 offen
    buffer_load_dwordx4 v[140:143], v4, s[44:47], s37 offen
    s_add_u32 s37, s37, 36864
    ds_read_b128 v[92:95], v14 offset:960
    ds_read_b128 v[96:99], v14 offset:19904
    s_waitcnt lgkmcnt(7)
    v_mfma_f32_16x16x32_bf16 v[52:55], a[48:51], v[68:71], v[52:55]
    s_waitcnt lgkmcnt(6)
    v_mfma_f32_16x16x32_bf16 v[56:59], a[48:51], v[72:75], v[56:59]
    v_mfma_f32_16x16x32_bf16 v[60:63], v[144:147], v[68:71], v[60:63]
    v_mfma_f32_16x16x32_bf16 v[64:67], v[144:147], v[72:75], v[64:67]
    buffer_load_dwordx4 a[48:51], v3, s[44:47], s37 offen
    buffer_load_dwordx4 v[144:147], v4, s[44:47], s37 offen
    s_add_u32 s37, s37, 36864
    ds_read_b128 v[68:71], v14 offset:1024
    ds_read_b128 v[72:75], v14 offset:19968
    s_waitcnt lgkmcnt(7)
    v_mfma_f32_16x16x32_bf16 v[52:55], a[52:55], v[76:79], v[52:55]
    s_waitcnt lgkmcnt(6)
    v_mfma_f32_16x16x32_bf16 v[56:59], a[52:55], v[80:83], v[56:59]
    v_mfma_f32_16x16x32_bf16 v[60:63], v[148:151], v[76:79], v[60:63]
    v_mfma_f32_16x16x32_bf16 v[64:67], v[148:151], v[80:83], v[64:67]
    buffer_load_dwordx4 a[52:55], v3, s[44:47], s37 offen
    buffer_load_dwordx4 v[148:151], v4, s[44:47], s37 offen
    s_add_u32 s37, s37, 36864
    ds_read_b128 v[76:79], v14 offset:1088
    ds_read_b128 v[80:83], v14 offset:20032
    s_waitcnt lgkmcnt(7)
    v_mfma_f32_16x16x32_bf16 v[52:55], a[56:59], v[84:87], v[52:55]
    s_waitcnt lgkmcnt(6)
    v_mfma_f32_16x16x32_bf16 v[56:59], a[56:59], v[88:91], v[56:59]
    v_mfma_f32_16x16x32_bf16 v[60:63], v[152:155], v[84:87], v[60:63]
    v_mfma_f32_16x16x32_bf16 v[64:67], v[152:155], v[88:91], v[64:67]
    buffer_load_dwordx4 a[56:59], v3, s[44:47], s37 offen
    buffer_load_dwordx4 v[152:155], v4, s[44:47], s37 offen
    s_add_u32 s37, s37, 36864
    s_waitcnt lgkmcnt(5)
    v_mfma_f32_16x16x32_bf16 v[52:55], a[60:63], v[92:95], v[52:55]
    s_waitcnt lgkmcnt(4)
    v_mfma_f32_16x16x32_bf16 v[56:59], a[60:63], v[96:99], v[56:59]
    v_mfma_f32_16x16x32_bf16 v[60:63], v[156:159], v[92:95], v[60:63]
    v_mfma_f32_16x16x32_bf16 v[64:67], v[156:159], v[96:99], v[64:67]
    buffer_load_dwordx4 a[60:63], v3, s[44:47], s37 offen
    buffer_load_dwordx4 v[156:159], v4, s[44:47], s37 offen
    s_add_u32 s37, s37, 36864
    s_waitcnt lgkmcnt(3)
    v_mfma_f32_16x16x32_bf16 v[52:55], a[64:67], v[68:71], v[52:55]
    s_waitcnt lgkmcnt(2)
    v_mfma_f32_16x16x32_bf16 v[56:59], a[64:67], v[72:75], v[56:59]
    v_mfma_f32_16x16x32_bf16 v[60:63], v[160:163], v[68:71], v[60:63]
    v_mfma_f32_16x16x32_bf16 v[64:67], v[160:163], v[72:75], v[64:67]
    buffer_load_dwordx4 a[64:67], v3, s[44:47], s37 offen
    buffer_load_dwordx4 v[160:163], v4, s[44:47], s37 offen
    s_add_u32 s37, s37, 36864
    s_waitcnt lgkmcnt(1)
    v_mfma_f32_16x16x32_bf16 v[52:55], a[68:71], v[76:79], v[52:55]
    s_waitcnt lgkmcnt(0)
    v_mfma_f32_16x16x32_bf16 v[56:59], a[68:71], v[80:83], v[56:59]
    v_mfma_f32_16x16x32_bf16 v[60:63], v[164:167], v[76:79], v[60:63]
    v_mfma_f32_16x16x32_bf16 v[64:67], v[164:167], v[80:83], v[64:67]
    buffer_load_dwordx4 a[68:71], v3, s[44:47], s37 offen
    buffer_load_dwordx4 v[164:167], v4, s[44:47], s37 offen
    v_add_u32 v13, s10, v15
    s_movk_i32 s15, 2048
    v_cmp_gt_u32 s[64:65], s15, v13
    v_add_u32 v13, 16, v13
    v_cmp_gt_u32 s[66:67], s15, v13
    v_mul_f32 v16, v52, v52
    v_mul_f32 v17, v53, v53
    v_mul_f32 v18, v54, v54
    v_mul_f32 v19, v55, v55
    v_mul_f32 v20, v56, v56
    v_mul_f32 v21, v57, v57
    v_mul_f32 v22, v58, v58
    v_mul_f32 v23, v59, v59
    v_mul_f32 v24, v60, v60
    v_mul_f32 v25, v61, v61
    v_mul_f32 v26, v62, v62
    v_mul_f32 v27, v63, v63
    v_mul_f32 v28, v64, v64
    v_mul_f32 v29, v65, v65
    v_mul_f32 v30, v66, v66
    v_mul_f32 v31, v67, v67
    v_fma_f32 v16, v16, v11, s62
    v_fma_f32 v17, v17, v11, s62
    v_fma_f32 v18, v18, v11, s62
    v_fma_f32 v19, v19, v11, s62
    v_fma_f32 v20, v20, v11, s62
    v_fma_f32 v21, v21, v11, s62
    v_fma_f32 v22, v22, v11, s62
    v_fma_f32 v23, v23, v11, s62
    v_fma_f32 v24, v24, v11, s62
    v_fma_f32 v25, v25, v11, s62
    v_fma_f32 v26, v26, v11, s62
    v_fma_f32 v27, v27, v11, s62
    v_fma_f32 v28, v28, v11, s62
    v_fma_f32 v29, v29, v11, s62
    v_fma_f32 v30, v30, v11, s62
    v_fma_f32 v31, v31, v11, s62
    v_mul_f32 v16, v16, v52
    v_mul_f32 v17, v17, v53
    v_mul_f32 v18, v18, v54
    v_mul_f32 v19, v19, v55
    v_mul_f32 v20, v20, v56
    v_mul_f32 v21, v21, v57
    v_mul_f32 v22, v22, v58
    v_mul_f32 v23, v23, v59
    v_mul_f32 v24, v24, v60
    v_mul_f32 v25, v25, v61
    v_mul_f32 v26, v26, v62
    v_mul_f32 v27, v27, v63
    v_mul_f32 v28, v28, v64
    v_mul_f32 v29, v29, v65
    v_mul_f32 v30, v30, v66
    v_mul_f32 v31, v31, v67
    v_exp_f32 v16, v16
    v_exp_f32 v17, v17
    v_exp_f32 v18, v18
    v_exp_f32 v19, v19
    v_exp_f32 v20, v20
    v_exp_f32 v21, v21
    v_exp_f32 v22, v22
    v_exp_f32 v23, v23
    v_exp_f32 v24, v24
    v_exp_f32 v25, v25
    v_exp_f32 v26, v26
    v_exp_f32 v27, v27
    v_exp_f32 v28, v28
    v_exp_f32 v29, v29
    v_exp_f32 v30, v30
    v_exp_f32 v31, v31
    v_add_f32 v16, 1.0, v16
    v_add_f32 v17, 1.0, v17
    v_add_f32 v18, 1.0, v18
    v_add_f32 v19, 1.0, v19
    v_add_f32 v20, 1.0, v20
    v_add_f32 v21, 1.0, v21
    v_add_f32 v22, 1.0, v22
    v_add_f32 v23, 1.0, v23
    v_add_f32 v24, 1.0, v24
    v_add_f32 v25, 1.0, v25
    v_add_f32 v26, 1.0, v26
    v_add_f32 v27, 1.0, v27
    v_add_f32 v28, 1.0, v28
    v_add_f32 v29, 1.0, v29
    v_add_f32 v30, 1.0, v30
    v_add_f32 v31, 1.0, v31
    v_rcp_f32 v16, v16
    v_rcp_f32 v17, v17
    v_rcp_f32 v18, v18
    v_rcp_f32 v19, v19
    v_rcp_f32 v20, v20
    v_rcp_f32 v21, v21
    v_rcp_f32 v22, v22
    v_rcp_f32 v23, v23
    v_rcp_f32 v24, v24
    v_rcp_f32 v25, v25
    v_rcp_f32 v26, v26
    v_rcp_f32 v27, v27
    v_rcp_f32 v28, v28
    v_rcp_f32 v29, v29
    v_rcp_f32 v30, v30
    v_rcp_f32 v31, v31
    v_mul_f32 v16, v16, v52
    v_mul_f32 v17, v17, v53
    v_mul_f32 v18, v18, v54
    v_mul_f32 v19, v19, v55
    v_mul_f32 v20, v20, v56
    v_mul_f32 v21, v21, v57
    v_mul_f32 v22, v22, v58
    v_mul_f32 v23, v23, v59
    v_mul_f32 v24, v24, v60
    v_mul_f32 v25, v25, v61
    v_mul_f32 v26, v26, v62
    v_mul_f32 v27, v27, v63
    v_mul_f32 v28, v28, v64
    v_mul_f32 v29, v29, v65
    v_mul_f32 v30, v30, v66
    v_mul_f32 v31, v31, v67
    v_and_b32 v13, 1, v12
    v_mul_u32_u24 v13, 18432, v13
    v_lshrrev_b32 v10, 1, v12
    v_lshl_add_u32 v13, v10, 8, v13
    v_lshl_add_u32 v13, v15, 4, v13
    s_add_u32 s20, s14, 0
    s_lshr_b32 s21, s20, 1
    s_mul_i32 s22, s6, 36
    s_add_u32 s21, s21, s22
    s_lshl_b32 s21, s21, 10
    s_and_b32 s20, s20, 1
    s_lshl_b32 s20, s20, 9
    s_add_u32 s21, s21, s20
    s_add_u32 s21, s21, 14303232
    v_cvt_pk_bf16_f32 v40, v16, v17
    v_cvt_pk_bf16_f32 v41, v18, v19
    v_cndmask_b32 v40, 0, v40, s[64:65]
    v_cndmask_b32 v41, 0, v41, s[64:65]
    v_cvt_pk_bf16_f32 v42, v20, v21
    v_cvt_pk_bf16_f32 v43, v22, v23
    v_cndmask_b32 v42, 0, v42, s[66:67]
    v_cndmask_b32 v43, 0, v43, s[66:67]
    s_nop 0
    v_permlane16_swap_b32 v40, v42
    v_permlane16_swap_b32 v41, v43
    buffer_store_dwordx4 v[40:43], v13, s[44:47], s21 offen sc1
    s_add_u32 s20, s14, 4
    s_nop 0
    s_lshr_b32 s21, s20, 1
    s_mul_i32 s22, s6, 36
    s_add_u32 s21, s21, s22
    s_lshl_b32 s21, s21, 10
    s_and_b32 s20, s20, 1
    s_lshl_b32 s20, s20, 9
    s_add_u32 s21, s21, s20
    s_add_u32 s21, s21, 14303232
    v_cvt_pk_bf16_f32 v44, v24, v25
    v_cvt_pk_bf16_f32 v45, v26, v27
    v_cndmask_b32 v44, 0, v44, s[64:65]
    v_cndmask_b32 v45, 0, v45, s[64:65]
    v_cvt_pk_bf16_f32 v46, v28, v29
    v_cvt_pk_bf16_f32 v47, v30, v31
    v_cndmask_b32 v46, 0, v46, s[66:67]
    v_cndmask_b32 v47, 0, v47, s[66:67]
    s_nop 0
    v_permlane16_swap_b32 v44, v46
    v_permlane16_swap_b32 v45, v47
    buffer_store_dwordx4 v[44:47], v13, s[44:47], s21 offen sc1
    s_nop 1
    v_readfirstlane_b32 s34, v110
    s_cmp_ge_u32 s34, 72
    s_cbranch_scc1 Lck4
    v_mov_b32 v10, 0
    s_mov_b32 s35, 0
Lpd5:
    global_load_dword v1, v10, s[40:41] offset:64 sc1
    s_add_u32 s35, s35, 1
    s_waitcnt vmcnt(0)
    v_readfirstlane_b32 s34, v1
    s_cmp_ge_u32 s34, 72
    s_cbranch_scc1 Lpd5_x
    s_sleep 8
    s_cmp_lt_u32 s35, 0x80000
    s_cbranch_scc1 Lpd5
Lpd5_x:
Lck4:
    s_waitcnt vmcnt(0) lgkmcnt(0)
    s_barrier
    s_cmp_lg_u32 s3, 4
    s_cbranch_scc1 Lsig6
    s_mov_b64 exec, 1
    v_mov_b32 v1, 1
    v_mov_b32 v10, 0
    buffer_atomic_add v1, v10, s[44:47], s31 offen sc1
    s_mov_b64 exec, -1
Lsig6:
    s_mul_i32 s28, s5, 663552
    s_add_u32 s28, s28, 1327104
    s_lshl_b32 s29, s3, 10
    s_add_u32 s29, s29, s28
    s_add_u32 s29, s29, 8192
    s_lshl_b32 s30, s3, 11
    s_add_u32 s28, s28, s30
    s_cmp_ge_u32 s3, 4
    s_cselect_b32 s30, 4096, 0
    s_add_u32 s28, s28, s30
    v_add_u32 v5, s8, v15
    v_lshlrev_b32 v7, 4, v5
    s_movk_i32 s12, 1152
    v_mul_lo_u32 v5, v5, s12
    v_lshl_add_u32 v5, v12, 3, v5
    s_lshl_b32 s12, s14, 5
    v_add_u32 v5, s12, v5
    v_lshlrev_b32 v6, 7, v12
    v_lshl_add_u32 v6, v15, 3, v6
    s_lshl_b32 s12, s14, 9
    v_add_u32 v6, s12, v6
    s_mul_i32 s12, s6, 36864
    s_add_u32 s13, s12, 18432
    s_add_u32 s22, s12, 2048
    s_add_u32 s23, s13, 2048
    s_movk_i32 s15, 18432
    buffer_load_dwordx2 v[16:17], v5, s[48:51], 0 offen offset:0
    buffer_load_dwordx2 v[24:25], v6, s[52:55], s12 offen sc1
    buffer_load_dwordx2 v[18:19], v5, s[48:51], s15 offen offset:0
    buffer_load_dwordx2 v[26:27], v6, s[52:55], s13 offen sc1
    buffer_load_dwordx2 v[20:21], v5, s[48:51], 0 offen offset:128
    buffer_load_dwordx2 v[28:29], v6, s[52:55], s22 offen sc1
    buffer_load_dwordx2 v[22:23], v5, s[48:51], s15 offen offset:128
    buffer_load_dwordx2 v[30:31], v6, s[52:55], s23 offen sc1
    s_mul_i32 s20, s6, 36864
    s_add_u32 s20, s20, 14303232
    s_lshl_b32 s21, s3, 10
    s_add_u32 s20, s20, s21
    s_add_u32 s21, s21, 94208
    v_add_u32 v13, s21, v3
    v_add_u32 v14, 94208, v3
    s_cmp_lg_u32 s3, 4
    s_cbranch_scc1 Lw7_done
    v_mov_b32 v10, 0
    s_mov_b32 s35, 0
Lw7_0:
    buffer_load_dword v1, v10, s[44:47], s31 offen sc1
    s_add_u32 s35, s35, 1
    s_waitcnt vmcnt(0)
    v_readfirstlane_b32 s34, v1
    s_cmp_gt_u32 s35, 0x80000
    s_cbranch_scc1 Lw7_done
    s_cmp_lg_u32 s34, 4
    s_cbranch_scc1 Lw7_0
Lw7_done:
    s_barrier
    buffer_load_dwordx4 v[40:43], v3, s[44:47], s20 offen sc1
    s_add_u32 s20, s20, 8192
    buffer_load_dwordx4 v[44:47], v3, s[44:47], s20 offen sc1
    s_add_u32 s20, s20, 8192
    buffer_load_dwordx4 v[48:51], v3, s[44:47], s20 offen sc1
    s_add_u32 s20, s20, 8192
    buffer_load_dwordx4 v[52:55], v3, s[44:47], s20 offen sc1
    s_add_u32 s20, s20, 8192
    s_sub_u32 s21, s20, 8192
    s_cmp_lt_u32 s3, 4
    s_cselect_b32 s20, s20, s21
    buffer_load_dwordx4 v[56:59], v3, s[44:47], s20 offen sc1
    buffer_load_dwordx4 v[32:35], v7, s[56:59], 0 offen offset:0 sc1
    buffer_load_dwordx4 v[36:39], v7, s[56:59], 0 offen offset:256 sc1
    s_cmp_ge_u32 s3, 6
    s_cbranch_scc1 Lpf8
    s_cmp_ge_u32 s3, 3
    s_cselect_b32 s20, 5308416, 0
    s_cselect_b32 s21, 3, 0
    s_add_u32 s20, s20, 1327104
    s_sub_u32 s21, s3, s21
    s_mul_i32 s21, s21, 54
    s_mul_i32 s22, s4, 162
    s_add_u32 s21, s21, s22
    s_lshl_b32 s21, s21, 7
    s_add_u32 s20, s20, s21
    s_mul_i32 s21, s5, 663552
    s_add_u32 s20, s20, s21
    v_lshlrev_b32 v1, 7, v2
    s_mov_b32 exec_hi, 0x3fffff
    buffer_load_dword v1, v1, s[44:47], s20 offen
    s_mov_b64 exec, -1
Lpf8:
    s_waitcnt vmcnt(6)
    ds_write_b128 v13, v[40:43] offset:0
    s_waitcnt vmcnt(5)
    ds_write_b128 v13, v[44:47] offset:8192
    s_waitcnt vmcnt(4)
    ds_write_b128 v13, v[48:51] offset:16384
    s_waitcnt vmcnt(3)
    ds_write_b128 v13, v[52:55] offset:24576
    s_cmp_lt_u32 s3, 4
    s_cselect_b32 s21, 8192, 0
    v_add_u32 v13, s21, v13
    s_waitcnt vmcnt(2)
    ds_write_b128 v13, v[56:59] offset:24576
    s_waitcnt lgkmcnt(0)
    s_barrier
    ds_read_b128 v[76:79], v14 offset:0
    ds_read_b128 v[80:83], v14 offset:18432
    ds_read_b128 v[84:87], v14 offset:1024
    ds_read_b128 v[88:91], v14 offset:19456
    ds_read_b128 v[92:95], v14 offset:2048
    ds_read_b128 v[96:99], v14 offset:20480
    ds_read_b128 v[100:103], v14 offset:3072
    ds_read_b128 v[104:107], v14 offset:21504
    s_waitcnt lgkmcnt(7)
    v_mfma_f32_16x16x32_bf16 v[60:63], a[0:3], v[76:79], 0
    s_waitcnt lgkmcnt(6)
    v_mfma_f32_16x16x32_bf16 v[64:67], a[0:3], v[80:83], 0
    v_mfma_f32_16x16x32_bf16 v[68:71], a[72:75], v[76:79], 0
    v_mfma_f32_16x16x32_bf16 v[72:75], a[72:75], v[80:83], 0
    s_add_u32 s30, s28, 0
    buffer_load_dwordx4 a[0:3], v3, s[44:47], s30 offen
    ds_read_b128 v[76:79], v14 offset:4096
    ds_read_b128 v[80:83], v14 offset:22528
    s_waitcnt lgkmcnt(7)
    v_mfma_f32_16x16x32_bf16 v[60:63], a[4:7], v[84:87], v[60:63]
    s_waitcnt lgkmcnt(6)
    v_mfma_f32_16x16x32_bf16 v[64:67], a[4:7], v[88:91], v[64:67]
    v_mfma_f32_16x16x32_bf16 v[68:71], a[76:79], v[84:87], v[68:71]
    v_mfma_f32_16x16x32_bf16 v[72:75], a[76:79], v[88:91], v[72:75]
    s_add_u32 s30, s28, 1024
    buffer_load_dwordx4 a[4:7], v3, s[44:47], s30 offen
    ds_read_b128 v[84:87], v14 offset:5120
    ds_read_b128 v[88:91], v14 offset:23552
    s_waitcnt lgkmcnt(7)
    v_mfma_f32_16x16x32_bf16 v[60:63], a[8:11], v[92:95], v[60:63]
    s_waitcnt lgkmcnt(6)
    v_mfma_f32_16x16x32_bf16 v[64:67], a[8:11], v[96:99], v[64:67]
    v_mfma_f32_16x16x32_bf16 v[68:71], a[80:83], v[92:95], v[68:71]
    v_mfma_f32_16x16x32_bf16 v[72:75], a[80:83], v[96:99], v[72:75]
    s_add_u32 s30, s28, 36864
    buffer_load_dwordx4 a[8:11], v3, s[44:47], s30 offen
    ds_read_b128 v[92:95], v14 offset:6144
    ds_read_b128 v[96:99], v14 offset:24576
    s_waitcnt lgkmcnt(7)
    v_mfma_f32_16x16x32_bf16 v[60:63], a[12:15], v[100:103], v[60:63]
    s_waitcnt lgkmcnt(6)
    v_mfma_f32_16x16x32_bf16 v[64:67], a[12:15], v[104:107], v[64:67]
    v_mfma_f32_16x16x32_bf16 v[68:71], a[84:87], v[100:103], v[68:71]
    v_mfma_f32_16x16x32_bf16 v[72:75], a[84:87], v[104:107], v[72:75]
    s_add_u32 s30, s28, 37888
    buffer_load_dwordx4 a[12:15], v3, s[44:47], s30 offen
    ds_read_b128 v[100:103], v14 offset:7168
    ds_read_b128 v[104:107], v14 offset:25600
    s_waitcnt lgkmcnt(7)
    v_mfma_f32_16x16x32_bf16 v[60:63], a[16:19], v[76:79], v[60:63]
    s_waitcnt lgkmcnt(6)
    v_mfma_f32_16x16x32_bf16 v[64:67], a[16:19], v[80:83], v[64:67]
    v_mfma_f32_16x16x32_bf16 v[68:71], v[112:115], v[76:79], v[68:71]
    v_mfma_f32_16x16x32_bf16 v[72:75], v[112:115], v[80:83], v[72:75]
    s_add_u32 s30, s28, 73728
    buffer_load_dwordx4 a[16:19], v3, s[44:47], s30 offen
    ds_read_b128 v[76:79], v14 offset:8192
    ds_read_b128 v[80:83], v14 offset:26624
    s_waitcnt lgkmcnt(7)
    v_mfma_f32_16x16x32_bf16 v[60:63], a[20:23], v[84:87], v[60:63]
    s_waitcnt lgkmcnt(6)
    v_mfma_f32_16x16x32_bf16 v[64:67], a[20:23], v[88:91], v[64:67]
    v_mfma_f32_16x16x32_bf16 v[68:71], v[116:119], v[84:87], v[68:71]
    v_mfma_f32_16x16x32_bf16 v[72:75], v[116:119], v[88:91], v[72:75]
    s_add_u32 s30, s28, 74752
    buffer_load_dwordx4 a[20:23], v3, s[44:47], s30 offen
    ds_read_b128 v[84:87], v14 offset:9216
    ds_read_b128 v[88:91], v14 offset:27648
    s_waitcnt lgkmcnt(7)
    v_mfma_f32_16x16x32_bf16 v[60:63], a[24:27], v[92:95], v[60:63]
    s_waitcnt lgkmcnt(6)
    v_mfma_f32_16x16x32_bf16 v[64:67], a[24:27], v[96:99], v[64:67]
    v_mfma_f32_16x16x32_bf16 v[68:71], v[120:123], v[92:95], v[68:71]
    v_mfma_f32_16x16x32_bf16 v[72:75], v[120:123], v[96:99], v[72:75]
    s_add_u32 s30, s28, 110592
    buffer_load_dwordx4 a[24:27], v3, s[44:47], s30 offen
    ds_read_b128 v[92:95], v14 offset:10240
    ds_read_b128 v[96:99], v14 offset:28672
    s_waitcnt lgkmcnt(7)
    v_mfma_f32_16x16x32_bf16 v[60:63], a[28:31], v[100:103], v[60:63]
    s_waitcnt lgkmcnt(6)
    v_mfma_f32_16x16x32_bf16 v[64:67], a[28:31], v[104:107], v[64:67]
    v_mfma_f32_16x16x32_bf16 v[68:71], v[124:127], v[100:103], v[68:71]
    v_mfma_f32_16x16x32_bf16 v[72:75], v[124:127], v[104:107], v[72:75]
    s_add_u32 s30, s28, 111616
    buffer_load_dwordx4 a[28:31], v3, s[44:47], s30 offen
    ds_read_b128 v[100:103], v14 offset:11264
    ds_read_b128 v[104:107], v14 offset:29696
    s_waitcnt lgkmcnt(7)
    v_mfma_f32_16x16x32_bf16 v[60:63], a[32:35], v[76:79], v[60:63]
    s_waitcnt lgkmcnt(6)
    v_mfma_f32_16x16x32_bf16 v[64:67], a[32:35], v[80:83], v[64:67]
    v_mfma_f32_16x16x32_bf16 v[68:71], v[128:131], v[76:79], v[68:71]
    v_mfma_f32_16x16x32_bf16 v[72:75], v[128:131], v[80:83], v[72:75]
    s_add_u32 s30, s28, 147456
    buffer_load_dwordx4 a[32:35], v3, s[44:47], s30 offen
    ds_read_b128 v[76:79], v14 offset:12288
    ds_read_b128 v[80:83], v14 offset:30720
    s_waitcnt lgkmcnt(7)
    v_mfma_f32_16x16x32_bf16 v[60:63], a[36:39], v[84:87], v[60:63]
    s_waitcnt lgkmcnt(6)
    v_mfma_f32_16x16x32_bf16 v[64:67], a[36:39], v[88:91], v[64:67]
    v_mfma_f32_16x16x32_bf16 v[68:71], v[132:135], v[84:87], v[68:71]
    v_mfma_f32_16x16x32_bf16 v[72:75], v[132:135], v[88:91], v[72:75]
    s_add_u32 s30, s28, 148480
    buffer_load_dwordx4 a[36:39], v3, s[44:47], s30 offen
    ds_read_b128 v[84:87], v14 offset:13312
    ds_read_b128 v[88:91], v14 offset:31744
    s_waitcnt lgkmcnt(7)
    v_mfma_f32_16x16x32_bf16 v[60:63], a[40:43], v[92:95], v[60:63]
    s_waitcnt lgkmcnt(6)
    v_mfma_f32_16x16x32_bf16 v[64:67], a[40:43], v[96:99], v[64:67]
    v_mfma_f32_16x16x32_bf16 v[68:71], v[136:139], v[92:95], v[68:71]
    v_mfma_f32_16x16x32_bf16 v[72:75], v[136:139], v[96:99], v[72:75]
    s_add_u32 s30, s28, 184320
    buffer_load_dwordx4 a[40:43], v3, s[44:47], s30 offen
    ds_read_b128 v[92:95], v14 offset:14336
    ds_read_b128 v[96:99], v14 offset:32768
    s_waitcnt lgkmcnt(7)
    v_mfma_f32_16x16x32_bf16 v[60:63], a[44:47], v[100:103], v[60:63]
    s_waitcnt lgkmcnt(6)
    v_mfma_f32_16x16x32_bf16 v[64:67], a[44:47], v[104:107], v[64:67]
    v_mfma_f32_16x16x32_bf16 v[68:71], v[140:143], v[100:103], v[68:71]
    v_mfma_f32_16x16x32_bf16 v[72:75], v[140:143], v[104:107], v[72:75]
    s_add_u32 s30, s28, 185344
    buffer_load_dwordx4 a[44:47], v3, s[44:47], s30 offen
    ds_read_b128 v[100:103], v14 offset:15360
    ds_read_b128 v[104:107], v14 offset:33792
    s_waitcnt lgkmcnt(7)
    v_mfma_f32_16x16x32_bf16 v[60:63], a[48:51], v[76:79], v[60:63]
    s_waitcnt lgkmcnt(6)
    v_mfma_f32_16x16x32_bf16 v[64:67], a[48:51], v[80:83], v[64:67]
    v_mfma_f32_16x16x32_bf16 v[68:71], v[144:147], v[76:79], v[68:71]
    v_mfma_f32_16x16x32_bf16 v[72:75], v[144:147], v[80:83], v[72:75]
    s_add_u32 s30, s28, 221184
    buffer_load_dwordx4 a[48:51], v3, s[44:47], s30 offen
    ds_read_b128 v[76:79], v14 offset:16384
    ds_read_b128 v[80:83], v14 offset:34816
    s_waitcnt lgkmcnt(7)
    v_mfma_f32_16x16x32_bf16 v[60:63], a[52:55], v[84:87], v[60:63]
    s_waitcnt lgkmcnt(6)
    v_mfma_f32_16x16x32_bf16 v[64:67], a[52:55], v[88:91], v[64:67]
    v_mfma_f32_16x16x32_bf16 v[68:71], v[148:151], v[84:87], v[68:71]
    v_mfma_f32_16x16x32_bf16 v[72:75], v[148:151], v[88:91], v[72:75]
    s_add_u32 s30, s28, 222208
    buffer_load_dwordx4 a[52:55], v3, s[44:47], s30 offen
    ds_read_b128 v[84:87], v14 offset:17408
    ds_read_b128 v[88:91], v14 offset:35840
    s_waitcnt lgkmcnt(7)
    v_mfma_f32_16x16x32_bf16 v[60:63], a[56:59], v[92:95], v[60:63]
    s_waitcnt lgkmcnt(6)
    v_mfma_f32_16x16x32_bf16 v[64:67], a[56:59], v[96:99], v[64:67]
    v_mfma_f32_16x16x32_bf16 v[68:71], v[152:155], v[92:95], v[68:71]
    v_mfma_f32_16x16x32_bf16 v[72:75], v[152:155], v[96:99], v[72:75]
    s_add_u32 s30, s28, 258048
    buffer_load_dwordx4 a[56:59], v3, s[44:47], s30 offen
    s_waitcnt lgkmcnt(5)
    v_mfma_f32_16x16x32_bf16 v[60:63], a[60:63], v[100:103], v[60:63]
    s_waitcnt lgkmcnt(4)
    v_mfma_f32_16x16x32_bf16 v[64:67], a[60:63], v[104:107], v[64:67]
    v_mfma_f32_16x16x32_bf16 v[68:71], v[156:159], v[100:103], v[68:71]
    v_mfma_f32_16x16x32_bf16 v[72:75], v[156:159], v[104:107], v[72:75]
    s_add_u32 s30, s28, 259072
    buffer_load_dwordx4 a[60:63], v3, s[44:47], s30 offen
    s_waitcnt lgkmcnt(3)
    v_mfma_f32_16x16x32_bf16 v[60:63], a[64:67], v[76:79], v[60:63]
    s_waitcnt lgkmcnt(2)
    v_mfma_f32_16x16x32_bf16 v[64:67], a[64:67], v[80:83], v[64:67]
    v_mfma_f32_16x16x32_bf16 v[68:71], v[160:163], v[76:79], v[68:71]
    v_mfma_f32_16x16x32_bf16 v[72:75], v[160:163], v[80:83], v[72:75]
    s_add_u32 s30, s28, 294912
    buffer_load_dwordx4 a[64:67], v3, s[44:47], s30 offen
    s_waitcnt lgkmcnt(1)
    v_mfma_f32_16x16x32_bf16 v[60:63], a[68:71], v[84:87], v[60:63]
    s_waitcnt lgkmcnt(0)
    v_mfma_f32_16x16x32_bf16 v[64:67], a[68:71], v[88:91], v[64:67]
    v_mfma_f32_16x16x32_bf16 v[68:71], v[164:167], v[84:87], v[68:71]
    v_mfma_f32_16x16x32_bf16 v[72:75], v[164:167], v[88:91], v[72:75]
    s_add_u32 s30, s28, 295936
    buffer_load_dwordx4 a[68:71], v3, s[44:47], s30 offen
    s_add_u32 s30, s28, 331776
    buffer_load_dwordx4 a[72:75], v3, s[44:47], s30 offen
    s_add_u32 s30, s28, 332800
    buffer_load_dwordx4 a[76:79], v3, s[44:47], s30 offen
    s_add_u32 s30, s28, 368640
    buffer_load_dwordx4 a[80:83], v3, s[44:47], s30 offen
    s_add_u32 s30, s28, 369664
    buffer_load_dwordx4 a[84:87], v3, s[44:47], s30 offen
    v_and_b32 v13, 1, v12
    v_mul_u32_u24 v13, 18432, v13
    v_lshrrev_b32 v10, 1, v12
    v_lshl_add_u32 v13, v10, 8, v13
    v_lshl_add_u32 v13, v15, 4, v13
    s_lshr_b32 s21, s14, 1
    s_mul_i32 s22, s6, 36
    s_add_u32 s21, s21, s22
    s_lshl_b32 s21, s21, 10
    s_and_b32 s20, s14, 1
    s_lshl_b32 s20, s20, 9
    s_add_u32 s21, s21, s20
    s_add_u32 s24, s21, 19021824
    s_add_u32 s25, s21, 19023872
    s_add_u32 s26, s21, 16662528
    s_add_u32 s27, s21, 16664576
    s_waitcnt vmcnt(23)
    v_mul_f32 v32, v32, v33
    v_mul_f32 v34, v34, v35
    s_waitcnt vmcnt(22)
    v_mul_f32 v36, v36, v37
    v_mul_f32 v38, v38, v39
    v_lshlrev_b32 v76, 16, v16
    v_and_b32 v77, 0xffff0000, v16
    v_lshlrev_b32 v80, 16, v24
    v_and_b32 v81, 0xffff0000, v24
    v_lshlrev_b32 v78, 16, v17
    v_and_b32 v79, 0xffff0000, v17
    v_lshlrev_b32 v82, 16, v25
    v_and_b32 v83, 0xffff0000, v25
    v_fma_f32 v84, v76, v33, -v32
    v_fma_f32 v85, v77, v33, -v32
    v_fma_f32 v86, v78, v33, -v32
    v_fma_f32 v87, v79, v33, -v32
    v_fma_f32 v76, v84, v80, v76
    v_fma_f32 v77, v85, v81, v77
    v_fma_f32 v78, v86, v82, v78
    v_fma_f32 v79, v87, v83, v79
    v_fma_f32 v84, v76, v35, -v34
    v_fma_f32 v85, v77, v35, -v34
    v_fma_f32 v86, v78, v35, -v34
    v_fma_f32 v87, v79, v35, -v34
    v_add_f32 v84, v84, v60
    v_add_f32 v85, v85, v61
    v_add_f32 v86, v86, v62
    v_add_f32 v87, v87, v63
    v_cvt_pk_bf16_f32 v100, v76, v77
    v_cvt_pk_bf16_f32 v101, v78, v79
    v_cvt_pk_bf16_f32 v104, v84, v85
    v_cvt_pk_bf16_f32 v105, v86, v87
    v_lshlrev_b32 v88, 16, v18
    v_and_b32 v89, 0xffff0000, v18
    v_lshlrev_b32 v92, 16, v26
    v_and_b32 v93, 0xffff0000, v26
    v_lshlrev_b32 v90, 16, v19
    v_and_b32 v91, 0xffff0000, v19
    v_lshlrev_b32 v94, 16, v27
    v_and_b32 v95, 0xffff0000, v27
    v_fma_f32 v96, v88, v37, -v36
    v_fma_f32 v97, v89, v37, -v36
    v_fma_f32 v98, v90, v37, -v36
    v_fma_f32 v99, v91, v37, -v36
    v_fma_f32 v88, v96, v92, v88
    v_fma_f32 v89, v97, v93, v89
    v_fma_f32 v90, v98, v94, v90
    v_fma_f32 v91, v99, v95, v91
    v_fma_f32 v96, v88, v39, -v38
    v_fma_f32 v97, v89, v39, -v38
    v_fma_f32 v98, v90, v39, -v38
    v_fma_f32 v99, v91, v39, -v38
    v_add_f32 v96, v96, v64
    v_add_f32 v97, v97, v65
    v_add_f32 v98, v98, v66
    v_add_f32 v99, v99, v67
    v_cvt_pk_bf16_f32 v102, v88, v89
    v_cvt_pk_bf16_f32 v103, v90, v91
    v_cvt_pk_bf16_f32 v106, v96, v97
    v_cvt_pk_bf16_f32 v107, v98, v99
    s_nop 0
    v_permlane16_swap_b32 v104, v106
    v_permlane16_swap_b32 v105, v107
    v_permlane16_swap_b32 v100, v102
    v_permlane16_swap_b32 v101, v103
    buffer_store_dwordx4 v[104:107], v13, s[44:47], s26 offen sc1
    buffer_store_dwordx4 v[100:103], v13, s[44:47], s24 offen sc1
    v_mov_b32 v76, 0
    v_mov_b32 v77, 0
    v_dot2c_f32_bf16 v76, s63, v104
    v_dot2c_f32_bf16 v77, v104, v104
    v_dot2c_f32_bf16 v76, s63, v105
    v_dot2c_f32_bf16 v77, v105, v105
    v_dot2c_f32_bf16 v76, s63, v106
    v_dot2c_f32_bf16 v77, v106, v106
    v_dot2c_f32_bf16 v76, s63, v107
    v_dot2c_f32_bf16 v77, v107, v107
    s_nop 1
    v_mov_b32 v78, v76
    v_mov_b32 v79, v77
    s_nop 0
    v_permlane32_swap_b32 v76, v78
    v_permlane32_swap_b32 v77, v79
    v_add_f32 v76, v76, v78
    v_add_f32 v77, v77, v79
    v_lshrrev_b32 v10, 1, v3
    s_mul_i32 s20, s6, 36
    s_add_u32 s20, s20, s14
    s_lshl_b32 s20, s20, 8
    s_add_u32 s20, s20, 42483712
    s_mov_b32 exec_hi, 0
    buffer_store_dwordx2 v[76:77], v10, s[44:47], s20 offen offset:0 sc1
    s_mov_b32 exec_hi, -1
    v_lshlrev_b32 v76, 16, v20
    v_and_b32 v77, 0xffff0000, v20
    v_lshlrev_b32 v80, 16, v28
    v_and_b32 v81, 0xffff0000, v28
    v_lshlrev_b32 v78, 16, v21
    v_and_b32 v79, 0xffff0000, v21
    v_lshlrev_b32 v82, 16, v29
    v_and_b32 v83, 0xffff0000, v29
    v_fma_f32 v84, v76, v33, -v32
    v_fma_f32 v85, v77, v33, -v32
    v_fma_f32 v86, v78, v33, -v32
    v_fma_f32 v87, v79, v33, -v32
    v_fma_f32 v76, v84, v80, v76
    v_fma_f32 v77, v85, v81, v77
    v_fma_f32 v78, v86, v82, v78
    v_fma_f32 v79, v87, v83, v79
    v_fma_f32 v84, v76, v35, -v34
    v_fma_f32 v85, v77, v35, -v34
    v_fma_f32 v86, v78, v35, -v34
    v_fma_f32 v87, v79, v35, -v34
    v_add_f32 v84, v84, v68
    v_add_f32 v85, v85, v69
    v_add_f32 v86, v86, v70
    v_add_f32 v87, v87, v71
    v_cvt_pk_bf16_f32 v40, v76, v77
    v_cvt_pk_bf16_f32 v41, v78, v79
    v_cvt_pk_bf16_f32 v44, v84, v85
    v_cvt_pk_bf16_f32 v45, v86, v87
    v_lshlrev_b32 v88, 16, v22
    v_and_b32 v89, 0xffff0000, v22
    v_lshlrev_b32 v92, 16, v30
    v_and_b32 v93, 0xffff0000, v30
    v_lshlrev_b32 v90, 16, v23
    v_and_b32 v91, 0xffff0000, v23
    v_lshlrev_b32 v94, 16, v31
    v_and_b32 v95, 0xffff0000, v31
    v_fma_f32 v96, v88, v37, -v36
    v_fma_f32 v97, v89, v37, -v36
    v_fma_f32 v98, v90, v37, -v36
    v_fma_f32 v99, v91, v37, -v36
    v_fma_f32 v88, v96, v92, v88
    v_fma_f32 v89, v97, v93, v89
    v_fma_f32 v90, v98, v94, v90
    v_fma_f32 v91, v99, v95, v91
    v_fma_f32 v96, v88, v39, -v38
    v_fma_f32 v97, v89, v39, -v38
    v_fma_f32 v98, v90, v39, -v38
    v_fma_f32 v99, v91, v39, -v38
    v_add_f32 v96, v96, v72
    v_add_f32 v97, v97, v73
    v_add_f32 v98, v98, v74
    v_add_f32 v99, v99, v75
    v_cvt_pk_bf16_f32 v42, v88, v89
    v_cvt_pk_bf16_f32 v43, v90, v91
    v_cvt_pk_bf16_f32 v46, v96, v97
    v_cvt_pk_bf16_f32 v47, v98, v99
    s_nop 0
    v_permlane16_swap_b32 v44, v46
    v_permlane16_swap_b32 v45, v47
    v_permlane16_swap_b32 v40, v42
    v_permlane16_swap_b32 v41, v43
    buffer_store_dwordx4 v[44:47], v13, s[44:47], s27 offen sc1
    buffer_store_dwordx4 v[40:43], v13, s[44:47], s25 offen sc1
    v_mov_b32 v80, 0
    v_mov_b32 v81, 0
    v_dot2c_f32_bf16 v80, s63, v44
    v_dot2c_f32_bf16 v81, v44, v44
    v_dot2c_f32_bf16 v80, s63, v45
    v_dot2c_f32_bf16 v81, v45, v45
    v_dot2c_f32_bf16 v80, s63, v46
    v_dot2c_f32_bf16 v81, v46, v46
    v_dot2c_f32_bf16 v80, s63, v47
    v_dot2c_f32_bf16 v81, v47, v47
    s_nop 1
    v_mov_b32 v82, v80
    v_mov_b32 v83, v81
    s_nop 0
    v_permlane32_swap_b32 v80, v82
    v_permlane32_swap_b32 v81, v83
    v_add_f32 v80, v80, v82
    v_add_f32 v81, v81, v83
    s_mov_b32 exec_hi, 0
    buffer_store_dwordx2 v[80:81], v10, s[44:47], s20 offen offset:1024 sc1
    s_mov_b32 exec_hi, -1
    s_waitcnt vmcnt(0) lgkmcnt(0)
    s_barrier
    s_cmp_lg_u32 s3, 4
    s_cbranch_scc1 Lsig9
    s_mov_b64 exec, 1
    v_mov_b32 v1, 1
    v_mov_b32 v10, 0
    buffer_atomic_add v1, v10, s[44:47], s32 offen sc1
    s_mov_b64 exec, -1
Lsig9:
    s_branch sequential_preLN__ssm_conv_h3__mixer_s_mlp__prompt_kernel_cb
sequential_preLN__ssm_conv_h3__mixer_s_mlp__prompt_kernel_ab1:
    s_waitcnt vmcnt(0)
    s_barrier
    s_add_u32 s37, s73, s3
    s_lshl_b32 s37, s37, 10
    s_add_u32 s37, s37, 0
    buffer_load_dwordx4 a[0:3], v3, s[44:47], s37 offen
    s_add_u32 s37, s37, 36864
    buffer_load_dwordx4 a[4:7], v3, s[44:47], s37 offen
    s_add_u32 s37, s37, 36864
    buffer_load_dwordx4 a[8:11], v3, s[44:47], s37 offen
    s_add_u32 s37, s37, 36864
    buffer_load_dwordx4 a[12:15], v3, s[44:47], s37 offen
    s_add_u32 s37, s37, 36864
    buffer_load_dwordx4 a[16:19], v3, s[44:47], s37 offen
    s_add_u32 s37, s37, 36864
    buffer_load_dwordx4 a[20:23], v3, s[44:47], s37 offen
    s_add_u32 s37, s37, 36864
    buffer_load_dwordx4 a[24:27], v3, s[44:47], s37 offen
    s_add_u32 s37, s37, 36864
    buffer_load_dwordx4 a[28:31], v3, s[44:47], s37 offen
    s_add_u32 s37, s37, 36864
    buffer_load_dwordx4 a[32:35], v3, s[44:47], s37 offen
    s_add_u32 s37, s37, 36864
    buffer_load_dwordx4 a[36:39], v3, s[44:47], s37 offen
    s_add_u32 s37, s37, 36864
    buffer_load_dwordx4 a[40:43], v3, s[44:47], s37 offen
    s_add_u32 s37, s37, 36864
    buffer_load_dwordx4 a[44:47], v3, s[44:47], s37 offen
    s_add_u32 s37, s37, 36864
    buffer_load_dwordx4 a[48:51], v3, s[44:47], s37 offen
    s_add_u32 s37, s37, 36864
    buffer_load_dwordx4 a[52:55], v3, s[44:47], s37 offen
    s_add_u32 s37, s37, 36864
    buffer_load_dwordx4 a[56:59], v3, s[44:47], s37 offen
    s_add_u32 s37, s37, 36864
    buffer_load_dwordx4 a[60:63], v3, s[44:47], s37 offen
    s_add_u32 s37, s37, 36864
    buffer_load_dwordx4 a[64:67], v3, s[44:47], s37 offen
    s_add_u32 s37, s37, 36864
    buffer_load_dwordx4 a[68:71], v3, s[44:47], s37 offen
    s_add_u32 s37, s73, s3
    s_lshl_b32 s37, s37, 10
    s_add_u32 s37, s37, 663552
    buffer_load_dwordx4 a[72:75], v3, s[44:47], s37 offen
    s_add_u32 s37, s37, 36864
    buffer_load_dwordx4 a[76:79], v3, s[44:47], s37 offen
    s_add_u32 s37, s37, 36864
    buffer_load_dwordx4 a[80:83], v3, s[44:47], s37 offen
    s_add_u32 s37, s37, 36864
    buffer_load_dwordx4 a[84:87], v3, s[44:47], s37 offen
    s_add_u32 s37, s37, 36864
    buffer_load_dwordx4 v[112:115], v3, s[44:47], s37 offen
    s_add_u32 s37, s37, 36864
    buffer_load_dwordx4 v[116:119], v3, s[44:47], s37 offen
    s_add_u32 s37, s37, 36864
    buffer_load_dwordx4 v[120:123], v3, s[44:47], s37 offen
    s_add_u32 s37, s37, 36864
    buffer_load_dwordx4 v[124:127], v3, s[44:47], s37 offen
    s_add_u32 s37, s37, 36864
    buffer_load_dwordx4 v[128:131], v3, s[44:47], s37 offen
    s_add_u32 s37, s37, 36864
    buffer_load_dwordx4 v[132:135], v3, s[44:47], s37 offen
    s_add_u32 s37, s37, 36864
    buffer_load_dwordx4 v[136:139], v3, s[44:47], s37 offen
    s_add_u32 s37, s37, 36864
    buffer_load_dwordx4 v[140:143], v3, s[44:47], s37 offen
    s_add_u32 s37, s37, 36864
    buffer_load_dwordx4 v[144:147], v3, s[44:47], s37 offen
    s_add_u32 s37, s37, 36864
    buffer_load_dwordx4 v[148:151], v3, s[44:47], s37 offen
    s_add_u32 s37, s37, 36864
    buffer_load_dwordx4 v[152:155], v3, s[44:47], s37 offen
    s_add_u32 s37, s37, 36864
    buffer_load_dwordx4 v[156:159], v3, s[44:47], s37 offen
    s_add_u32 s37, s37, 36864
    buffer_load_dwordx4 v[160:163], v3, s[44:47], s37 offen
    s_add_u32 s37, s37, 36864
    buffer_load_dwordx4 v[164:167], v3, s[44:47], s37 offen
    ds_read_b64 v[16:17], v8 offset:0
    ds_read_b64 v[18:19], v8 offset:128
    ds_read_b64 v[20:21], v8 offset:256
    ds_read_b64 v[22:23], v8 offset:384
    ds_read_b64 v[24:25], v8 offset:512
    ds_read_b64 v[26:27], v8 offset:640
    ds_read_b64 v[28:29], v8 offset:768
    ds_read_b64 v[30:31], v8 offset:896
    ds_read_b64 v[32:33], v8 offset:1024
    v_mov_b32 v96, 0
    v_mov_b32 v107, 0
    v_mov_b32 v97, 0
    v_mov_b32 v108, 0
    s_waitcnt lgkmcnt(8)
    v_dot2c_f32_bf16 v96, s63, v16
    v_dot2c_f32_bf16 v97, v16, v16
    v_lshlrev_b32 v52, 16, v16
    v_and_b32 v53, 0xffff0000, v16
    v_dot2c_f32_bf16 v107, s63, v17
    v_dot2c_f32_bf16 v108, v17, v17
    v_lshlrev_b32 v54, 16, v17
    v_and_b32 v55, 0xffff0000, v17
    s_waitcnt lgkmcnt(7)
    v_dot2c_f32_bf16 v96, s63, v18
    v_dot2c_f32_bf16 v97, v18, v18
    v_lshlrev_b32 v56, 16, v18
    v_and_b32 v57, 0xffff0000, v18
    v_dot2c_f32_bf16 v107, s63, v19
    v_dot2c_f32_bf16 v108, v19, v19
    v_lshlrev_b32 v58, 16, v19
    v_and_b32 v59, 0xffff0000, v19
    s_waitcnt lgkmcnt(6)
    v_dot2c_f32_bf16 v96, s63, v20
    v_dot2c_f32_bf16 v97, v20, v20
    v_lshlrev_b32 v60, 16, v20
    v_and_b32 v61, 0xffff0000, v20
    v_dot2c_f32_bf16 v107, s63, v21
    v_dot2c_f32_bf16 v108, v21, v21
    v_lshlrev_b32 v62, 16, v21
    v_and_b32 v63, 0xffff0000, v21
    s_waitcnt lgkmcnt(5)
    v_dot2c_f32_bf16 v96, s63, v22
    v_dot2c_f32_bf16 v97, v22, v22
    v_lshlrev_b32 v64, 16, v22
    v_and_b32 v65, 0xffff0000, v22
    v_dot2c_f32_bf16 v107, s63, v23
    v_dot2c_f32_bf16 v108, v23, v23
    v_lshlrev_b32 v66, 16, v23
    v_and_b32 v67, 0xffff0000, v23
    s_waitcnt lgkmcnt(4)
    v_dot2c_f32_bf16 v96, s63, v24
    v_dot2c_f32_bf16 v97, v24, v24
    v_lshlrev_b32 v68, 16, v24
    v_and_b32 v69, 0xffff0000, v24
    v_dot2c_f32_bf16 v107, s63, v25
    v_dot2c_f32_bf16 v108, v25, v25
    v_lshlrev_b32 v70, 16, v25
    v_and_b32 v71, 0xffff0000, v25
    s_waitcnt lgkmcnt(3)
    v_dot2c_f32_bf16 v96, s63, v26
    v_dot2c_f32_bf16 v97, v26, v26
    v_lshlrev_b32 v72, 16, v26
    v_and_b32 v73, 0xffff0000, v26
    v_dot2c_f32_bf16 v107, s63, v27
    v_dot2c_f32_bf16 v108, v27, v27
    v_lshlrev_b32 v74, 16, v27
    v_and_b32 v75, 0xffff0000, v27
    s_waitcnt lgkmcnt(2)
    v_dot2c_f32_bf16 v96, s63, v28
    v_dot2c_f32_bf16 v97, v28, v28
    v_lshlrev_b32 v76, 16, v28
    v_and_b32 v77, 0xffff0000, v28
    v_dot2c_f32_bf16 v107, s63, v29
    v_dot2c_f32_bf16 v108, v29, v29
    v_lshlrev_b32 v78, 16, v29
    v_and_b32 v79, 0xffff0000, v29
    s_waitcnt lgkmcnt(1)
    v_dot2c_f32_bf16 v96, s63, v30
    v_dot2c_f32_bf16 v97, v30, v30
    v_lshlrev_b32 v80, 16, v30
    v_and_b32 v81, 0xffff0000, v30
    v_dot2c_f32_bf16 v107, s63, v31
    v_dot2c_f32_bf16 v108, v31, v31
    v_lshlrev_b32 v82, 16, v31
    v_and_b32 v83, 0xffff0000, v31
    s_waitcnt lgkmcnt(0)
    v_dot2c_f32_bf16 v96, s63, v32
    v_dot2c_f32_bf16 v97, v32, v32
    v_lshlrev_b32 v84, 16, v32
    v_and_b32 v85, 0xffff0000, v32
    v_dot2c_f32_bf16 v107, s63, v33
    v_dot2c_f32_bf16 v108, v33, v33
    v_lshlrev_b32 v86, 16, v33
    v_and_b32 v87, 0xffff0000, v33
    v_add_f32 v96, v96, v107
    v_add_f32 v97, v97, v108
    s_nop 0
    v_add_f32_dpp v96, v96, v96 row_ror:4 row_mask:0xf bank_mask:0xf
    v_add_f32_dpp v97, v97, v97 row_ror:4 row_mask:0xf bank_mask:0xf
    s_nop 0
    v_add_f32_dpp v96, v96, v96 row_ror:8 row_mask:0xf bank_mask:0xf
    v_add_f32_dpp v97, v97, v97 row_ror:8 row_mask:0xf bank_mask:0xf
    v_mov_b32 v99, v96
    v_mov_b32 v104, v97
    s_nop 0
    v_permlane16_swap_b32 v96, v99
    v_permlane16_swap_b32 v97, v104
    v_add_f32 v96, v96, v99
    v_add_f32 v97, v97, v104
    v_mov_b32 v99, v96
    v_mov_b32 v104, v97
    s_nop 0
    v_permlane32_swap_b32 v96, v99
    v_permlane32_swap_b32 v97, v104
    v_add_f32 v96, v96, v99
    v_add_f32 v97, v97, v104
    v_mul_f32 v100, s60, v96
    v_mul_f32 v97, s60, v97
    v_fma_f32 v97, -v100, v100, v97
    v_max_f32 v97, 0, v97
    v_add_f32 v97, s61, v97
    v_rsq_f32 v101, v97
    s_nop 0
    v_mul_f32 v98, v100, v101
    v_sub_f32 v98, 0, v98
    s_lshl_b32 s20, s4, 7
    s_add_u32 s20, s20, 40337408
    s_cmp_lg_u32 s3, 4
    s_cbranch_scc1 Lw10_done
    v_mov_b32 v10, 0
    s_mov_b32 s35, 0
Lw10_0:
    buffer_load_dword v1, v10, s[44:47], s20 offen sc1
    s_add_u32 s35, s35, 1
    s_waitcnt vmcnt(0)
    v_readfirstlane_b32 s34, v1
    s_cmp_gt_u32 s35, 0x80000
    s_cbranch_scc1 Lw10_done
    s_cmp_lg_u32 s34, 1
    s_cbranch_scc1 Lw10_0
Lw10_done:
    s_barrier
    s_add_u32 m0, s15, 0
    s_nop 0
    buffer_load_dwordx4 v13, s[52:55], 0 offen sc1 lds
    v_add_u32 v13, 0x2000, v13
    s_add_u32 m0, m0, 8192
    s_nop 0
    buffer_load_dwordx4 v13, s[52:55], 0 offen sc1 lds
    v_add_u32 v13, 0x2000, v13
    s_add_u32 m0, m0, 8192
    s_nop 0
    buffer_load_dwordx4 v13, s[52:55], 0 offen sc1 lds
    v_add_u32 v13, 0x2000, v13
    s_add_u32 m0, m0, 8192
    s_nop 0
    buffer_load_dwordx4 v13, s[52:55], 0 offen sc1 lds
    v_add_u32 v13, 0x2000, v13
    s_add_u32 m0, m0, 8192
    s_nop 0
    buffer_load_dwordx4 v13, s[52:55], 0 offen sc1 lds
    v_add_u32 v13, 0x2000, v13
    s_add_u32 m0, m0, 8192
    s_nop 0
    buffer_load_dwordx4 v13, s[52:55], 0 offen sc1 lds
    s_cmp_lt_u32 s3, 6
    s_cselect_b32 s13, 8192, 0
    v_add_u32 v13, s13, v13
    s_add_u32 m0, m0, s13
    s_nop 0
    buffer_load_dwordx4 v13, s[52:55], 0 offen sc1 lds
    s_waitcnt vmcnt(0)
    s_barrier
    ds_read_b64 v[34:35], v9 offset:0
    ds_read_b64 v[36:37], v9 offset:2048
    ds_read_b64 v[38:39], v9 offset:4096
    ds_read_b64 v[40:41], v9 offset:6144
    ds_read_b64 v[42:43], v9 offset:8192
    ds_read_b64 v[44:45], v9 offset:10240
    ds_read_b64 v[46:47], v9 offset:12288
    ds_read_b64 v[48:49], v9 offset:14336
    ds_read_b64 v[50:51], v9 offset:16384
    v_mov_b32 v96, 0
    v_mov_b32 v107, 0
    v_mov_b32 v97, 0
    v_mov_b32 v108, 0
    s_waitcnt lgkmcnt(8)
    v_lshlrev_b32 v88, 16, v34
    v_and_b32 v89, 0xffff0000, v34
    v_lshlrev_b32 v90, 16, v35
    v_and_b32 v91, 0xffff0000, v35
    v_fma_f32 v92, v52, v101, v98
    v_fma_f32 v93, v53, v101, v98
    v_fma_f32 v94, v54, v101, v98
    v_fma_f32 v95, v55, v101, v98
    v_fma_f32 v52, v92, v88, v52
    v_fma_f32 v53, v93, v89, v53
    v_fma_f32 v54, v94, v90, v54
    v_fma_f32 v55, v95, v91, v55
    v_add_f32 v96, v96, v52
    v_fmac_f32 v97, v52, v52
    v_add_f32 v107, v107, v53
    v_fmac_f32 v108, v53, v53
    v_add_f32 v96, v96, v54
    v_fmac_f32 v97, v54, v54
    v_add_f32 v107, v107, v55
    v_fmac_f32 v108, v55, v55
    s_waitcnt lgkmcnt(7)
    v_lshlrev_b32 v88, 16, v36
    v_and_b32 v89, 0xffff0000, v36
    v_lshlrev_b32 v90, 16, v37
    v_and_b32 v91, 0xffff0000, v37
    v_fma_f32 v92, v56, v101, v98
    v_fma_f32 v93, v57, v101, v98
    v_fma_f32 v94, v58, v101, v98
    v_fma_f32 v95, v59, v101, v98
    v_fma_f32 v56, v92, v88, v56
    v_fma_f32 v57, v93, v89, v57
    v_fma_f32 v58, v94, v90, v58
    v_fma_f32 v59, v95, v91, v59
    v_add_f32 v96, v96, v56
    v_fmac_f32 v97, v56, v56
    v_add_f32 v107, v107, v57
    v_fmac_f32 v108, v57, v57
    v_add_f32 v96, v96, v58
    v_fmac_f32 v97, v58, v58
    v_add_f32 v107, v107, v59
    v_fmac_f32 v108, v59, v59
    s_waitcnt lgkmcnt(6)
    v_lshlrev_b32 v88, 16, v38
    v_and_b32 v89, 0xffff0000, v38
    v_lshlrev_b32 v90, 16, v39
    v_and_b32 v91, 0xffff0000, v39
    v_fma_f32 v92, v60, v101, v98
    v_fma_f32 v93, v61, v101, v98
    v_fma_f32 v94, v62, v101, v98
    v_fma_f32 v95, v63, v101, v98
    v_fma_f32 v60, v92, v88, v60
    v_fma_f32 v61, v93, v89, v61
    v_fma_f32 v62, v94, v90, v62
    v_fma_f32 v63, v95, v91, v63
    v_add_f32 v96, v96, v60
    v_fmac_f32 v97, v60, v60
    v_add_f32 v107, v107, v61
    v_fmac_f32 v108, v61, v61
    v_add_f32 v96, v96, v62
    v_fmac_f32 v97, v62, v62
    v_add_f32 v107, v107, v63
    v_fmac_f32 v108, v63, v63
    s_waitcnt lgkmcnt(5)
    v_lshlrev_b32 v88, 16, v40
    v_and_b32 v89, 0xffff0000, v40
    v_lshlrev_b32 v90, 16, v41
    v_and_b32 v91, 0xffff0000, v41
    v_fma_f32 v92, v64, v101, v98
    v_fma_f32 v93, v65, v101, v98
    v_fma_f32 v94, v66, v101, v98
    v_fma_f32 v95, v67, v101, v98
    v_fma_f32 v64, v92, v88, v64
    v_fma_f32 v65, v93, v89, v65
    v_fma_f32 v66, v94, v90, v66
    v_fma_f32 v67, v95, v91, v67
    v_add_f32 v96, v96, v64
    v_fmac_f32 v97, v64, v64
    v_add_f32 v107, v107, v65
    v_fmac_f32 v108, v65, v65
    v_add_f32 v96, v96, v66
    v_fmac_f32 v97, v66, v66
    v_add_f32 v107, v107, v67
    v_fmac_f32 v108, v67, v67
    s_waitcnt lgkmcnt(4)
    v_lshlrev_b32 v88, 16, v42
    v_and_b32 v89, 0xffff0000, v42
    v_lshlrev_b32 v90, 16, v43
    v_and_b32 v91, 0xffff0000, v43
    v_fma_f32 v92, v68, v101, v98
    v_fma_f32 v93, v69, v101, v98
    v_fma_f32 v94, v70, v101, v98
    v_fma_f32 v95, v71, v101, v98
    v_fma_f32 v68, v92, v88, v68
    v_fma_f32 v69, v93, v89, v69
    v_fma_f32 v70, v94, v90, v70
    v_fma_f32 v71, v95, v91, v71
    v_add_f32 v96, v96, v68
    v_fmac_f32 v97, v68, v68
    v_add_f32 v107, v107, v69
    v_fmac_f32 v108, v69, v69
    v_add_f32 v96, v96, v70
    v_fmac_f32 v97, v70, v70
    v_add_f32 v107, v107, v71
    v_fmac_f32 v108, v71, v71
    s_waitcnt lgkmcnt(3)
    v_lshlrev_b32 v88, 16, v44
    v_and_b32 v89, 0xffff0000, v44
    v_lshlrev_b32 v90, 16, v45
    v_and_b32 v91, 0xffff0000, v45
    v_fma_f32 v92, v72, v101, v98
    v_fma_f32 v93, v73, v101, v98
    v_fma_f32 v94, v74, v101, v98
    v_fma_f32 v95, v75, v101, v98
    v_fma_f32 v72, v92, v88, v72
    v_fma_f32 v73, v93, v89, v73
    v_fma_f32 v74, v94, v90, v74
    v_fma_f32 v75, v95, v91, v75
    v_add_f32 v96, v96, v72
    v_fmac_f32 v97, v72, v72
    v_add_f32 v107, v107, v73
    v_fmac_f32 v108, v73, v73
    v_add_f32 v96, v96, v74
    v_fmac_f32 v97, v74, v74
    v_add_f32 v107, v107, v75
    v_fmac_f32 v108, v75, v75
    s_waitcnt lgkmcnt(2)
    v_lshlrev_b32 v88, 16, v46
    v_and_b32 v89, 0xffff0000, v46
    v_lshlrev_b32 v90, 16, v47
    v_and_b32 v91, 0xffff0000, v47
    v_fma_f32 v92, v76, v101, v98
    v_fma_f32 v93, v77, v101, v98
    v_fma_f32 v94, v78, v101, v98
    v_fma_f32 v95, v79, v101, v98
    v_fma_f32 v76, v92, v88, v76
    v_fma_f32 v77, v93, v89, v77
    v_fma_f32 v78, v94, v90, v78
    v_fma_f32 v79, v95, v91, v79
    v_add_f32 v96, v96, v76
    v_fmac_f32 v97, v76, v76
    v_add_f32 v107, v107, v77
    v_fmac_f32 v108, v77, v77
    v_add_f32 v96, v96, v78
    v_fmac_f32 v97, v78, v78
    v_add_f32 v107, v107, v79
    v_fmac_f32 v108, v79, v79
    s_waitcnt lgkmcnt(1)
    v_lshlrev_b32 v88, 16, v48
    v_and_b32 v89, 0xffff0000, v48
    v_lshlrev_b32 v90, 16, v49
    v_and_b32 v91, 0xffff0000, v49
    v_fma_f32 v92, v80, v101, v98
    v_fma_f32 v93, v81, v101, v98
    v_fma_f32 v94, v82, v101, v98
    v_fma_f32 v95, v83, v101, v98
    v_fma_f32 v80, v92, v88, v80
    v_fma_f32 v81, v93, v89, v81
    v_fma_f32 v82, v94, v90, v82
    v_fma_f32 v83, v95, v91, v83
    v_add_f32 v96, v96, v80
    v_fmac_f32 v97, v80, v80
    v_add_f32 v107, v107, v81
    v_fmac_f32 v108, v81, v81
    v_add_f32 v96, v96, v82
    v_fmac_f32 v97, v82, v82
    v_add_f32 v107, v107, v83
    v_fmac_f32 v108, v83, v83
    s_waitcnt lgkmcnt(0)
    v_lshlrev_b32 v88, 16, v50
    v_and_b32 v89, 0xffff0000, v50
    v_lshlrev_b32 v90, 16, v51
    v_and_b32 v91, 0xffff0000, v51
    v_fma_f32 v92, v84, v101, v98
    v_fma_f32 v93, v85, v101, v98
    v_fma_f32 v94, v86, v101, v98
    v_fma_f32 v95, v87, v101, v98
    v_fma_f32 v84, v92, v88, v84
    v_fma_f32 v85, v93, v89, v85
    v_fma_f32 v86, v94, v90, v86
    v_fma_f32 v87, v95, v91, v87
    v_add_f32 v96, v96, v84
    v_fmac_f32 v97, v84, v84
    v_add_f32 v107, v107, v85
    v_fmac_f32 v108, v85, v85
    v_add_f32 v96, v96, v86
    v_fmac_f32 v97, v86, v86
    v_add_f32 v107, v107, v87
    v_fmac_f32 v108, v87, v87
    v_add_f32 v96, v96, v107
    v_add_f32 v97, v97, v108
    s_nop 0
    v_add_f32_dpp v96, v96, v96 row_ror:4 row_mask:0xf bank_mask:0xf
    v_add_f32_dpp v97, v97, v97 row_ror:4 row_mask:0xf bank_mask:0xf
    s_nop 0
    v_add_f32_dpp v96, v96, v96 row_ror:8 row_mask:0xf bank_mask:0xf
    v_add_f32_dpp v97, v97, v97 row_ror:8 row_mask:0xf bank_mask:0xf
    v_mov_b32 v99, v96
    v_mov_b32 v104, v97
    s_nop 0
    v_permlane16_swap_b32 v96, v99
    v_permlane16_swap_b32 v97, v104
    v_add_f32 v96, v96, v99
    v_add_f32 v97, v97, v104
    v_mov_b32 v99, v96
    v_mov_b32 v104, v97
    s_nop 0
    v_permlane32_swap_b32 v96, v99
    v_permlane32_swap_b32 v97, v104
    v_add_f32 v96, v96, v99
    v_add_f32 v97, v97, v104
    v_mul_f32 v102, s60, v96
    v_mul_f32 v97, s60, v97
    v_fma_f32 v97, -v102, v102, v97
    v_max_f32 v97, 0, v97
    v_add_f32 v97, s61, v97
    v_rsq_f32 v103, v97
    s_nop 0
    v_mul_f32 v98, v102, v103
    v_sub_f32 v98, 0, v98
    v_lshlrev_b32 v13, 4, v7
    s_mov_b64 exec, 15
    buffer_store_dwordx4 v[100:103], v13, s[56:59], 0 offen sc1
    s_mov_b64 exec, -1
    v_mul_f32 v105, v103, v103
    v_subrev_f32 v97, s61, v97
    v_mul_f32 v105, v105, v97
    v_add_f32 v105, s61, v105
    v_rsq_f32 v106, v105
    s_nop 0
    v_mul_f32 v98, v98, v106
    v_mul_f32 v106, v106, v103
    s_lshl_b32 s15, s3, 2
    v_add_u32 v13, s15, v5
    v_mul_u32_u24 v13, 1184, v13
    v_lshl_add_u32 v13, v6, 3, v13
    v_add_u32 v13, 55296, v13
    v_fma_f32 v52, v52, v106, v98
    v_fma_f32 v53, v53, v106, v98
    v_fma_f32 v54, v54, v106, v98
    v_fma_f32 v55, v55, v106, v98
    v_cvt_pk_bf16_f32 v16, v52, v53
    v_cvt_pk_bf16_f32 v17, v54, v55
    ds_write_b64 v13, v[16:17] offset:0
    v_fma_f32 v56, v56, v106, v98
    v_fma_f32 v57, v57, v106, v98
    v_fma_f32 v58, v58, v106, v98
    v_fma_f32 v59, v59, v106, v98
    v_cvt_pk_bf16_f32 v18, v56, v57
    v_cvt_pk_bf16_f32 v19, v58, v59
    ds_write_b64 v13, v[18:19] offset:128
    v_fma_f32 v60, v60, v106, v98
    v_fma_f32 v61, v61, v106, v98
    v_fma_f32 v62, v62, v106, v98
    v_fma_f32 v63, v63, v106, v98
    v_cvt_pk_bf16_f32 v20, v60, v61
    v_cvt_pk_bf16_f32 v21, v62, v63
    ds_write_b64 v13, v[20:21] offset:256
    v_fma_f32 v64, v64, v106, v98
    v_fma_f32 v65, v65, v106, v98
    v_fma_f32 v66, v66, v106, v98
    v_fma_f32 v67, v67, v106, v98
    v_cvt_pk_bf16_f32 v22, v64, v65
    v_cvt_pk_bf16_f32 v23, v66, v67
    ds_write_b64 v13, v[22:23] offset:384
    v_fma_f32 v68, v68, v106, v98
    v_fma_f32 v69, v69, v106, v98
    v_fma_f32 v70, v70, v106, v98
    v_fma_f32 v71, v71, v106, v98
    v_cvt_pk_bf16_f32 v24, v68, v69
    v_cvt_pk_bf16_f32 v25, v70, v71
    ds_write_b64 v13, v[24:25] offset:512
    v_fma_f32 v72, v72, v106, v98
    v_fma_f32 v73, v73, v106, v98
    v_fma_f32 v74, v74, v106, v98
    v_fma_f32 v75, v75, v106, v98
    v_cvt_pk_bf16_f32 v26, v72, v73
    v_cvt_pk_bf16_f32 v27, v74, v75
    ds_write_b64 v13, v[26:27] offset:640
    v_fma_f32 v76, v76, v106, v98
    v_fma_f32 v77, v77, v106, v98
    v_fma_f32 v78, v78, v106, v98
    v_fma_f32 v79, v79, v106, v98
    v_cvt_pk_bf16_f32 v28, v76, v77
    v_cvt_pk_bf16_f32 v29, v78, v79
    ds_write_b64 v13, v[28:29] offset:768
    v_fma_f32 v80, v80, v106, v98
    v_fma_f32 v81, v81, v106, v98
    v_fma_f32 v82, v82, v106, v98
    v_fma_f32 v83, v83, v106, v98
    v_cvt_pk_bf16_f32 v30, v80, v81
    v_cvt_pk_bf16_f32 v31, v82, v83
    ds_write_b64 v13, v[30:31] offset:896
    v_fma_f32 v84, v84, v106, v98
    v_fma_f32 v85, v85, v106, v98
    v_fma_f32 v86, v86, v106, v98
    v_fma_f32 v87, v87, v106, v98
    v_cvt_pk_bf16_f32 v32, v84, v85
    v_cvt_pk_bf16_f32 v33, v86, v87
    ds_write_b64 v13, v[32:33] offset:1024
    v_mul_u32_u24 v14, 1184, v15
    v_lshl_add_u32 v14, v12, 4, v14
    v_add_u32 v14, 55296, v14
    s_waitcnt lgkmcnt(0)
    s_barrier
    s_add_u32 s37, s73, s3
    s_lshl_b32 s37, s37, 10
    s_add_u32 s37, s37, 663552
    ds_read_b128 v[68:71], v14 offset:0
    ds_read_b128 v[72:75], v14 offset:18944
    ds_read_b128 v[76:79], v14 offset:64
    ds_read_b128 v[80:83], v14 offset:19008
    ds_read_b128 v[84:87], v14 offset:128
    ds_read_b128 v[88:91], v14 offset:19072
    ds_read_b128 v[92:95], v14 offset:192
    ds_read_b128 v[96:99], v14 offset:19136
    s_waitcnt lgkmcnt(7)
    v_mfma_f32_16x16x32_bf16 v[52:55], a[0:3], v[68:71], 0
    s_waitcnt lgkmcnt(6)
    v_mfma_f32_16x16x32_bf16 v[56:59], a[0:3], v[72:75], 0
    ds_read_b128 v[68:71], v14 offset:256
    ds_read_b128 v[72:75], v14 offset:19200
    s_waitcnt lgkmcnt(7)
    v_mfma_f32_16x16x32_bf16 v[52:55], a[4:7], v[76:79], v[52:55]
    s_waitcnt lgkmcnt(6)
    v_mfma_f32_16x16x32_bf16 v[56:59], a[4:7], v[80:83], v[56:59]
    ds_read_b128 v[76:79], v14 offset:320
    ds_read_b128 v[80:83], v14 offset:19264
    s_waitcnt lgkmcnt(7)
    v_mfma_f32_16x16x32_bf16 v[52:55], a[8:11], v[84:87], v[52:55]
    s_waitcnt lgkmcnt(6)
    v_mfma_f32_16x16x32_bf16 v[56:59], a[8:11], v[88:91], v[56:59]
    ds_read_b128 v[84:87], v14 offset:384
    ds_read_b128 v[88:91], v14 offset:19328
    s_waitcnt lgkmcnt(7)
    v_mfma_f32_16x16x32_bf16 v[52:55], a[12:15], v[92:95], v[52:55]
    s_waitcnt lgkmcnt(6)
    v_mfma_f32_16x16x32_bf16 v[56:59], a[12:15], v[96:99], v[56:59]
    ds_read_b128 v[92:95], v14 offset:448
    ds_read_b128 v[96:99], v14 offset:19392
    s_waitcnt lgkmcnt(7)
    v_mfma_f32_16x16x32_bf16 v[52:55], a[16:19], v[68:71], v[52:55]
    s_waitcnt lgkmcnt(6)
    v_mfma_f32_16x16x32_bf16 v[56:59], a[16:19], v[72:75], v[56:59]
    ds_read_b128 v[68:71], v14 offset:512
    ds_read_b128 v[72:75], v14 offset:19456
    s_waitcnt lgkmcnt(7)
    v_mfma_f32_16x16x32_bf16 v[52:55], a[20:23], v[76:79], v[52:55]
    s_waitcnt lgkmcnt(6)
    v_mfma_f32_16x16x32_bf16 v[56:59], a[20:23], v[80:83], v[56:59]
    ds_read_b128 v[76:79], v14 offset:576
    ds_read_b128 v[80:83], v14 offset:19520
    s_waitcnt lgkmcnt(7)
    v_mfma_f32_16x16x32_bf16 v[52:55], a[24:27], v[84:87], v[52:55]
    s_waitcnt lgkmcnt(6)
    v_mfma_f32_16x16x32_bf16 v[56:59], a[24:27], v[88:91], v[56:59]
    ds_read_b128 v[84:87], v14 offset:640
    ds_read_b128 v[88:91], v14 offset:19584
    s_waitcnt lgkmcnt(7)
    v_mfma_f32_16x16x32_bf16 v[52:55], a[28:31], v[92:95], v[52:55]
    s_waitcnt lgkmcnt(6)
    v_mfma_f32_16x16x32_bf16 v[56:59], a[28:31], v[96:99], v[56:59]
    ds_read_b128 v[92:95], v14 offset:704
    ds_read_b128 v[96:99], v14 offset:19648
    s_waitcnt lgkmcnt(7)
    v_mfma_f32_16x16x32_bf16 v[52:55], a[32:35], v[68:71], v[52:55]
    s_waitcnt lgkmcnt(6)
    v_mfma_f32_16x16x32_bf16 v[56:59], a[32:35], v[72:75], v[56:59]
    ds_read_b128 v[68:71], v14 offset:768
    ds_read_b128 v[72:75], v14 offset:19712
    s_waitcnt lgkmcnt(7)
    v_mfma_f32_16x16x32_bf16 v[52:55], a[36:39], v[76:79], v[52:55]
    s_waitcnt lgkmcnt(6)
    v_mfma_f32_16x16x32_bf16 v[56:59], a[36:39], v[80:83], v[56:59]
    ds_read_b128 v[76:79], v14 offset:832
    ds_read_b128 v[80:83], v14 offset:19776
    s_waitcnt lgkmcnt(7)
    v_mfma_f32_16x16x32_bf16 v[52:55], a[40:43], v[84:87], v[52:55]
    s_waitcnt lgkmcnt(6)
    v_mfma_f32_16x16x32_bf16 v[56:59], a[40:43], v[88:91], v[56:59]
    ds_read_b128 v[84:87], v14 offset:896
    ds_read_b128 v[88:91], v14 offset:19840
    s_waitcnt lgkmcnt(7)
    v_mfma_f32_16x16x32_bf16 v[52:55], a[44:47], v[92:95], v[52:55]
    s_waitcnt lgkmcnt(6)
    v_mfma_f32_16x16x32_bf16 v[56:59], a[44:47], v[96:99], v[56:59]
    ds_read_b128 v[92:95], v14 offset:960
    ds_read_b128 v[96:99], v14 offset:19904
    s_waitcnt lgkmcnt(7)
    v_mfma_f32_16x16x32_bf16 v[52:55], a[48:51], v[68:71], v[52:55]
    s_waitcnt lgkmcnt(6)
    v_mfma_f32_16x16x32_bf16 v[56:59], a[48:51], v[72:75], v[56:59]
    ds_read_b128 v[68:71], v14 offset:1024
    ds_read_b128 v[72:75], v14 offset:19968
    s_waitcnt lgkmcnt(7)
    v_mfma_f32_16x16x32_bf16 v[52:55], a[52:55], v[76:79], v[52:55]
    s_waitcnt lgkmcnt(6)
    v_mfma_f32_16x16x32_bf16 v[56:59], a[52:55], v[80:83], v[56:59]
    ds_read_b128 v[76:79], v14 offset:1088
    ds_read_b128 v[80:83], v14 offset:20032
    s_waitcnt lgkmcnt(7)
    v_mfma_f32_16x16x32_bf16 v[52:55], a[56:59], v[84:87], v[52:55]
    s_waitcnt lgkmcnt(6)
    v_mfma_f32_16x16x32_bf16 v[56:59], a[56:59], v[88:91], v[56:59]
    s_waitcnt lgkmcnt(5)
    v_mfma_f32_16x16x32_bf16 v[52:55], a[60:63], v[92:95], v[52:55]
    s_waitcnt lgkmcnt(4)
    v_mfma_f32_16x16x32_bf16 v[56:59], a[60:63], v[96:99], v[56:59]
    s_waitcnt lgkmcnt(3)
    v_mfma_f32_16x16x32_bf16 v[52:55], a[64:67], v[68:71], v[52:55]
    s_waitcnt lgkmcnt(2)
    v_mfma_f32_16x16x32_bf16 v[56:59], a[64:67], v[72:75], v[56:59]
    s_waitcnt lgkmcnt(1)
    v_mfma_f32_16x16x32_bf16 v[52:55], a[68:71], v[76:79], v[52:55]
    s_waitcnt lgkmcnt(0)
    v_mfma_f32_16x16x32_bf16 v[56:59], a[68:71], v[80:83], v[56:59]
    v_add_u32 v13, s10, v15
    s_movk_i32 s15, 2048
    v_cmp_gt_u32 s[64:65], s15, v13
    v_add_u32 v13, 16, v13
    v_cmp_gt_u32 s[66:67], s15, v13
    s_nop 0
    v_mul_f32 v16, v52, v52
    v_mul_f32 v17, v53, v53
    v_mul_f32 v18, v54, v54
    v_mul_f32 v19, v55, v55
    v_mul_f32 v20, v56, v56
    v_mul_f32 v21, v57, v57
    v_mul_f32 v22, v58, v58
    v_mul_f32 v23, v59, v59
    v_fma_f32 v16, v16, v11, s62
    v_fma_f32 v17, v17, v11, s62
    v_fma_f32 v18, v18, v11, s62
    v_fma_f32 v19, v19, v11, s62
    v_fma_f32 v20, v20, v11, s62
    v_fma_f32 v21, v21, v11, s62
    v_fma_f32 v22, v22, v11, s62
    v_fma_f32 v23, v23, v11, s62
    v_mul_f32 v16, v16, v52
    v_mul_f32 v17, v17, v53
    v_mul_f32 v18, v18, v54
    v_mul_f32 v19, v19, v55
    v_mul_f32 v20, v20, v56
    v_mul_f32 v21, v21, v57
    v_mul_f32 v22, v22, v58
    v_mul_f32 v23, v23, v59
    v_exp_f32 v16, v16
    v_exp_f32 v17, v17
    v_exp_f32 v18, v18
    v_exp_f32 v19, v19
    v_exp_f32 v20, v20
    v_exp_f32 v21, v21
    v_exp_f32 v22, v22
    v_exp_f32 v23, v23
    v_add_f32 v16, 1.0, v16
    v_add_f32 v17, 1.0, v17
    v_add_f32 v18, 1.0, v18
    v_add_f32 v19, 1.0, v19
    v_add_f32 v20, 1.0, v20
    v_add_f32 v21, 1.0, v21
    v_add_f32 v22, 1.0, v22
    v_add_f32 v23, 1.0, v23
    v_rcp_f32 v16, v16
    v_rcp_f32 v17, v17
    v_rcp_f32 v18, v18
    v_rcp_f32 v19, v19
    v_rcp_f32 v20, v20
    v_rcp_f32 v21, v21
    v_rcp_f32 v22, v22
    v_rcp_f32 v23, v23
    v_mul_f32 v16, v16, v52
    v_mul_f32 v17, v17, v53
    v_mul_f32 v18, v18, v54
    v_mul_f32 v19, v19, v55
    v_mul_f32 v20, v20, v56
    v_mul_f32 v21, v21, v57
    v_mul_f32 v22, v22, v58
    v_mul_f32 v23, v23, v59
    v_and_b32 v13, 1, v12
    v_mul_u32_u24 v13, 18432, v13
    v_lshrrev_b32 v10, 1, v12
    v_lshl_add_u32 v13, v10, 8, v13
    v_lshl_add_u32 v13, v15, 4, v13
    s_add_u32 s20, s14, 0
    s_lshr_b32 s21, s20, 1
    s_mul_i32 s22, s6, 36
    s_add_u32 s21, s21, s22
    s_lshl_b32 s21, s21, 10
    s_and_b32 s20, s20, 1
    s_lshl_b32 s20, s20, 9
    s_add_u32 s21, s21, s20
    s_add_u32 s21, s21, 14303232
    v_cvt_pk_bf16_f32 v40, v16, v17
    v_cvt_pk_bf16_f32 v41, v18, v19
    v_cndmask_b32 v40, 0, v40, s[64:65]
    v_cndmask_b32 v41, 0, v41, s[64:65]
    v_cvt_pk_bf16_f32 v42, v20, v21
    v_cvt_pk_bf16_f32 v43, v22, v23
    v_cndmask_b32 v42, 0, v42, s[66:67]
    v_cndmask_b32 v43, 0, v43, s[66:67]
    s_nop 0
    v_permlane16_swap_b32 v40, v42
    v_permlane16_swap_b32 v41, v43
    buffer_store_dwordx4 v[40:43], v13, s[44:47], s21 offen sc1
    s_waitcnt vmcnt(0) lgkmcnt(0)
    s_barrier
    s_cmp_lg_u32 s3, 4
    s_cbranch_scc1 Lsig11
    s_mov_b64 exec, 1
    v_mov_b32 v1, 1
    v_mov_b32 v10, 0
    buffer_atomic_add v1, v10, s[44:47], s31 offen sc1
    s_mov_b64 exec, -1
Lsig11:
    s_mul_i32 s28, s5, 663552
    s_add_u32 s28, s28, 1327104
    s_lshl_b32 s29, s3, 10
    s_add_u32 s29, s29, s28
    s_add_u32 s29, s29, 8192
    s_lshl_b32 s30, s3, 11
    s_add_u32 s28, s28, s30
    s_cmp_ge_u32 s3, 4
    s_cselect_b32 s30, 4096, 0
    s_add_u32 s28, s28, s30
    s_cmp_ge_u32 s3, 6
    s_cbranch_scc1 Lpf12
    s_cmp_ge_u32 s3, 3
    s_cselect_b32 s20, 5308416, 0
    s_cselect_b32 s21, 3, 0
    s_add_u32 s20, s20, 1327104
    s_sub_u32 s21, s3, s21
    s_mul_i32 s21, s21, 54
    s_mul_i32 s22, s4, 162
    s_add_u32 s21, s21, s22
    s_lshl_b32 s21, s21, 7
    s_add_u32 s20, s20, s21
    s_mul_i32 s21, s5, 663552
    s_add_u32 s20, s20, s21
    v_lshlrev_b32 v1, 7, v2
    s_mov_b32 exec_hi, 0x3fffff
    buffer_load_dword v1, v1, s[44:47], s20 offen
    s_mov_b64 exec, -1
Lpf12:
    s_add_u32 s30, s28, 0
    s_add_u32 s37, s28, 0
    s_cmp_lt_u32 s3, 4
    s_cselect_b32 s30, s30, s37
    buffer_load_dwordx4 a[0:3], v3, s[44:47], s30 offen
    s_add_u32 s30, s28, 1024
    s_add_u32 s37, s28, 1024
    s_cmp_lt_u32 s3, 4
    s_cselect_b32 s30, s30, s37
    buffer_load_dwordx4 a[4:7], v3, s[44:47], s30 offen
    s_add_u32 s30, s29, 0
    s_add_u32 s37, s28, 36864
    s_cmp_lt_u32 s3, 4
    s_cselect_b32 s30, s30, s37
    buffer_load_dwordx4 a[8:11], v3, s[44:47], s30 offen
    s_add_u32 s30, s28, 36864
    s_add_u32 s37, s28, 37888
    s_cmp_lt_u32 s3, 4
    s_cselect_b32 s30, s30, s37
    buffer_load_dwordx4 a[12:15], v3, s[44:47], s30 offen
    s_add_u32 s30, s28, 37888
    s_add_u32 s37, s28, 73728
    s_cmp_lt_u32 s3, 4
    s_cselect_b32 s30, s30, s37
    buffer_load_dwordx4 a[16:19], v3, s[44:47], s30 offen
    s_add_u32 s30, s29, 36864
    s_add_u32 s37, s28, 74752
    s_cmp_lt_u32 s3, 4
    s_cselect_b32 s30, s30, s37
    buffer_load_dwordx4 a[20:23], v3, s[44:47], s30 offen
    s_add_u32 s30, s28, 73728
    s_add_u32 s37, s28, 110592
    s_cmp_lt_u32 s3, 4
    s_cselect_b32 s30, s30, s37
    buffer_load_dwordx4 a[24:27], v3, s[44:47], s30 offen
    s_add_u32 s30, s28, 74752
    s_add_u32 s37, s28, 111616
    s_cmp_lt_u32 s3, 4
    s_cselect_b32 s30, s30, s37
    buffer_load_dwordx4 a[28:31], v3, s[44:47], s30 offen
    s_add_u32 s30, s29, 73728
    s_add_u32 s37, s28, 147456
    s_cmp_lt_u32 s3, 4
    s_cselect_b32 s30, s30, s37
    buffer_load_dwordx4 a[32:35], v3, s[44:47], s30 offen
    s_add_u32 s30, s28, 110592
    s_add_u32 s37, s28, 148480
    s_cmp_lt_u32 s3, 4
    s_cselect_b32 s30, s30, s37
    buffer_load_dwordx4 a[36:39], v3, s[44:47], s30 offen
    s_add_u32 s30, s28, 111616
    s_add_u32 s37, s28, 184320
    s_cmp_lt_u32 s3, 4
    s_cselect_b32 s30, s30, s37
    buffer_load_dwordx4 a[40:43], v3, s[44:47], s30 offen
    s_add_u32 s30, s29, 110592
    s_add_u32 s37, s28, 185344
    s_cmp_lt_u32 s3, 4
    s_cselect_b32 s30, s30, s37
    buffer_load_dwordx4 a[44:47], v3, s[44:47], s30 offen
    s_add_u32 s30, s28, 147456
    s_add_u32 s37, s28, 221184
    s_cmp_lt_u32 s3, 4
    s_cselect_b32 s30, s30, s37
    buffer_load_dwordx4 a[48:51], v3, s[44:47], s30 offen
    s_add_u32 s30, s28, 148480
    s_add_u32 s37, s28, 222208
    s_cmp_lt_u32 s3, 4
    s_cselect_b32 s30, s30, s37
    buffer_load_dwordx4 a[52:55], v3, s[44:47], s30 offen
    s_add_u32 s30, s29, 147456
    s_add_u32 s37, s28, 258048
    s_cmp_lt_u32 s3, 4
    s_cselect_b32 s30, s30, s37
    buffer_load_dwordx4 a[56:59], v3, s[44:47], s30 offen
    s_add_u32 s30, s28, 184320
    s_add_u32 s37, s28, 259072
    s_cmp_lt_u32 s3, 4
    s_cselect_b32 s30, s30, s37
    buffer_load_dwordx4 a[60:63], v3, s[44:47], s30 offen
    s_add_u32 s30, s28, 185344
    s_add_u32 s37, s28, 294912
    s_cmp_lt_u32 s3, 4
    s_cselect_b32 s30, s30, s37
    buffer_load_dwordx4 a[64:67], v3, s[44:47], s30 offen
    s_add_u32 s30, s29, 184320
    s_add_u32 s37, s28, 295936
    s_cmp_lt_u32 s3, 4
    s_cselect_b32 s30, s30, s37
    buffer_load_dwordx4 a[68:71], v3, s[44:47], s30 offen
    v_add_u32 v5, s8, v15
    v_lshlrev_b32 v7, 4, v5
    s_movk_i32 s12, 1152
    v_mul_lo_u32 v5, v5, s12
    v_lshl_add_u32 v5, v12, 3, v5
    s_lshl_b32 s12, s14, 5
    v_add_u32 v5, s12, v5
    v_lshlrev_b32 v6, 7, v12
    v_lshl_add_u32 v6, v15, 3, v6
    s_lshl_b32 s12, s14, 9
    v_add_u32 v6, s12, v6
    s_mul_i32 s12, s6, 36864
    s_add_u32 s13, s12, 18432
    s_add_u32 s22, s12, 2048
    s_add_u32 s23, s13, 2048
    s_movk_i32 s15, 18432
    buffer_load_dwordx2 v[16:17], v5, s[48:51], 0 offen offset:0
    buffer_load_dwordx2 v[24:25], v6, s[52:55], s12 offen sc1
    buffer_load_dwordx2 v[18:19], v5, s[48:51], s15 offen offset:0
    buffer_load_dwordx2 v[26:27], v6, s[52:55], s13 offen sc1
    s_mul_i32 s20, s6, 36864
    s_add_u32 s20, s20, 14303232
    s_lshl_b32 s21, s3, 10
    s_add_u32 s20, s20, s21
    s_add_u32 s21, s21, 94208
    v_add_u32 v13, s21, v3
    v_add_u32 v14, 94208, v3
    s_cmp_lg_u32 s3, 4
    s_cbranch_scc1 Lw13_done
    v_mov_b32 v10, 0
    s_mov_b32 s35, 0
Lw13_0:
    buffer_load_dword v1, v10, s[44:47], s31 offen sc1
    s_add_u32 s35, s35, 1
    s_waitcnt vmcnt(0)
    v_readfirstlane_b32 s34, v1
    s_cmp_gt_u32 s35, 0x80000
    s_cbranch_scc1 Lw13_done
    s_cmp_lg_u32 s34, 4
    s_cbranch_scc1 Lw13_0
Lw13_done:
    s_barrier
    buffer_load_dwordx4 v[40:43], v3, s[44:47], s20 offen sc1
    s_add_u32 s20, s20, 8192
    buffer_load_dwordx4 v[44:47], v3, s[44:47], s20 offen sc1
    s_add_u32 s20, s20, 8192
    buffer_load_dwordx4 v[48:51], v3, s[44:47], s20 offen sc1
    s_add_u32 s20, s20, 8192
    buffer_load_dwordx4 v[52:55], v3, s[44:47], s20 offen sc1
    s_add_u32 s20, s20, 8192
    s_sub_u32 s21, s20, 8192
    s_cmp_lt_u32 s3, 4
    s_cselect_b32 s20, s20, s21
    buffer_load_dwordx4 v[56:59], v3, s[44:47], s20 offen sc1
    buffer_load_dwordx4 v[32:35], v7, s[56:59], 0 offen offset:0 sc1
    buffer_load_dwordx4 v[36:39], v7, s[56:59], 0 offen offset:256 sc1
    s_waitcnt vmcnt(6)
    ds_write_b128 v13, v[40:43] offset:0
    s_waitcnt vmcnt(5)
    ds_write_b128 v13, v[44:47] offset:8192
    s_waitcnt vmcnt(4)
    ds_write_b128 v13, v[48:51] offset:16384
    s_waitcnt vmcnt(3)
    ds_write_b128 v13, v[52:55] offset:24576
    s_cmp_lt_u32 s3, 4
    s_cselect_b32 s21, 8192, 0
    v_add_u32 v13, s21, v13
    s_waitcnt vmcnt(2)
    ds_write_b128 v13, v[56:59] offset:24576
    s_waitcnt lgkmcnt(0)
    s_barrier
    ds_read_b128 v[76:79], v14 offset:0
    ds_read_b128 v[80:83], v14 offset:18432
    ds_read_b128 v[84:87], v14 offset:1024
    ds_read_b128 v[88:91], v14 offset:19456
    ds_read_b128 v[92:95], v14 offset:2048
    ds_read_b128 v[96:99], v14 offset:20480
    ds_read_b128 v[100:103], v14 offset:3072
    ds_read_b128 v[104:107], v14 offset:21504
    s_waitcnt lgkmcnt(7)
    v_mfma_f32_16x16x32_bf16 v[60:63], a[72:75], v[76:79], 0
    s_waitcnt lgkmcnt(6)
    v_mfma_f32_16x16x32_bf16 v[64:67], a[72:75], v[80:83], 0
    ds_read_b128 v[76:79], v14 offset:4096
    ds_read_b128 v[80:83], v14 offset:22528
    s_waitcnt lgkmcnt(7)
    v_mfma_f32_16x16x32_bf16 v[60:63], a[76:79], v[84:87], v[60:63]
    s_waitcnt lgkmcnt(6)
    v_mfma_f32_16x16x32_bf16 v[64:67], a[76:79], v[88:91], v[64:67]
    ds_read_b128 v[84:87], v14 offset:5120
    ds_read_b128 v[88:91], v14 offset:23552
    s_waitcnt lgkmcnt(7)
    v_mfma_f32_16x16x32_bf16 v[60:63], a[80:83], v[92:95], v[60:63]
    s_waitcnt lgkmcnt(6)
    v_mfma_f32_16x16x32_bf16 v[64:67], a[80:83], v[96:99], v[64:67]
    ds_read_b128 v[92:95], v14 offset:6144
    ds_read_b128 v[96:99], v14 offset:24576
    s_waitcnt lgkmcnt(7)
    v_mfma_f32_16x16x32_bf16 v[60:63], a[84:87], v[100:103], v[60:63]
    s_waitcnt lgkmcnt(6)
    v_mfma_f32_16x16x32_bf16 v[64:67], a[84:87], v[104:107], v[64:67]
    ds_read_b128 v[100:103], v14 offset:7168
    ds_read_b128 v[104:107], v14 offset:25600
    s_waitcnt lgkmcnt(7)
    v_mfma_f32_16x16x32_bf16 v[60:63], v[112:115], v[76:79], v[60:63]
    s_waitcnt lgkmcnt(6)
    v_mfma_f32_16x16x32_bf16 v[64:67], v[112:115], v[80:83], v[64:67]
    ds_read_b128 v[76:79], v14 offset:8192
    ds_read_b128 v[80:83], v14 offset:26624
    s_waitcnt lgkmcnt(7)
    v_mfma_f32_16x16x32_bf16 v[60:63], v[116:119], v[84:87], v[60:63]
    s_waitcnt lgkmcnt(6)
    v_mfma_f32_16x16x32_bf16 v[64:67], v[116:119], v[88:91], v[64:67]
    ds_read_b128 v[84:87], v14 offset:9216
    ds_read_b128 v[88:91], v14 offset:27648
    s_waitcnt lgkmcnt(7)
    v_mfma_f32_16x16x32_bf16 v[60:63], v[120:123], v[92:95], v[60:63]
    s_waitcnt lgkmcnt(6)
    v_mfma_f32_16x16x32_bf16 v[64:67], v[120:123], v[96:99], v[64:67]
    ds_read_b128 v[92:95], v14 offset:10240
    ds_read_b128 v[96:99], v14 offset:28672
    s_waitcnt lgkmcnt(7)
    v_mfma_f32_16x16x32_bf16 v[60:63], v[124:127], v[100:103], v[60:63]
    s_waitcnt lgkmcnt(6)
    v_mfma_f32_16x16x32_bf16 v[64:67], v[124:127], v[104:107], v[64:67]
    ds_read_b128 v[100:103], v14 offset:11264
    ds_read_b128 v[104:107], v14 offset:29696
    s_waitcnt lgkmcnt(7)
    v_mfma_f32_16x16x32_bf16 v[60:63], v[128:131], v[76:79], v[60:63]
    s_waitcnt lgkmcnt(6)
    v_mfma_f32_16x16x32_bf16 v[64:67], v[128:131], v[80:83], v[64:67]
    ds_read_b128 v[76:79], v14 offset:12288
    ds_read_b128 v[80:83], v14 offset:30720
    s_waitcnt lgkmcnt(7)
    v_mfma_f32_16x16x32_bf16 v[60:63], v[132:135], v[84:87], v[60:63]
    s_waitcnt lgkmcnt(6)
    v_mfma_f32_16x16x32_bf16 v[64:67], v[132:135], v[88:91], v[64:67]
    ds_read_b128 v[84:87], v14 offset:13312
    ds_read_b128 v[88:91], v14 offset:31744
    s_waitcnt lgkmcnt(7)
    v_mfma_f32_16x16x32_bf16 v[60:63], v[136:139], v[92:95], v[60:63]
    s_waitcnt lgkmcnt(6)
    v_mfma_f32_16x16x32_bf16 v[64:67], v[136:139], v[96:99], v[64:67]
    ds_read_b128 v[92:95], v14 offset:14336
    ds_read_b128 v[96:99], v14 offset:32768
    s_waitcnt lgkmcnt(7)
    v_mfma_f32_16x16x32_bf16 v[60:63], v[140:143], v[100:103], v[60:63]
    s_waitcnt lgkmcnt(6)
    v_mfma_f32_16x16x32_bf16 v[64:67], v[140:143], v[104:107], v[64:67]
    ds_read_b128 v[100:103], v14 offset:15360
    ds_read_b128 v[104:107], v14 offset:33792
    s_waitcnt lgkmcnt(7)
    v_mfma_f32_16x16x32_bf16 v[60:63], v[144:147], v[76:79], v[60:63]
    s_waitcnt lgkmcnt(6)
    v_mfma_f32_16x16x32_bf16 v[64:67], v[144:147], v[80:83], v[64:67]
    ds_read_b128 v[76:79], v14 offset:16384
    ds_read_b128 v[80:83], v14 offset:34816
    s_waitcnt lgkmcnt(7)
    v_mfma_f32_16x16x32_bf16 v[60:63], v[148:151], v[84:87], v[60:63]
    s_waitcnt lgkmcnt(6)
    v_mfma_f32_16x16x32_bf16 v[64:67], v[148:151], v[88:91], v[64:67]
    ds_read_b128 v[84:87], v14 offset:17408
    ds_read_b128 v[88:91], v14 offset:35840
    s_waitcnt lgkmcnt(7)
    v_mfma_f32_16x16x32_bf16 v[60:63], v[152:155], v[92:95], v[60:63]
    s_waitcnt lgkmcnt(6)
    v_mfma_f32_16x16x32_bf16 v[64:67], v[152:155], v[96:99], v[64:67]
    s_waitcnt lgkmcnt(5)
    v_mfma_f32_16x16x32_bf16 v[60:63], v[156:159], v[100:103], v[60:63]
    s_waitcnt lgkmcnt(4)
    v_mfma_f32_16x16x32_bf16 v[64:67], v[156:159], v[104:107], v[64:67]
    s_waitcnt lgkmcnt(3)
    v_mfma_f32_16x16x32_bf16 v[60:63], v[160:163], v[76:79], v[60:63]
    s_waitcnt lgkmcnt(2)
    v_mfma_f32_16x16x32_bf16 v[64:67], v[160:163], v[80:83], v[64:67]
    s_waitcnt lgkmcnt(1)
    v_mfma_f32_16x16x32_bf16 v[60:63], v[164:167], v[84:87], v[60:63]
    s_waitcnt lgkmcnt(0)
    v_mfma_f32_16x16x32_bf16 v[64:67], v[164:167], v[88:91], v[64:67]
    s_add_u32 s30, s28, 221184
    s_add_u32 s37, s28, 331776
    s_cmp_lt_u32 s3, 4
    s_cselect_b32 s30, s30, s37
    buffer_load_dwordx4 a[72:75], v3, s[44:47], s30 offen
    s_add_u32 s30, s28, 222208
    s_add_u32 s37, s28, 332800
    s_cmp_lt_u32 s3, 4
    s_cselect_b32 s30, s30, s37
    buffer_load_dwordx4 a[76:79], v3, s[44:47], s30 offen
    s_add_u32 s30, s29, 221184
    s_add_u32 s37, s28, 368640
    s_cmp_lt_u32 s3, 4
    s_cselect_b32 s30, s30, s37
    buffer_load_dwordx4 a[80:83], v3, s[44:47], s30 offen
    s_add_u32 s30, s28, 258048
    s_add_u32 s37, s28, 369664
    s_cmp_lt_u32 s3, 4
    s_cselect_b32 s30, s30, s37
    buffer_load_dwordx4 a[84:87], v3, s[44:47], s30 offen
    v_and_b32 v13, 1, v12
    v_mul_u32_u24 v13, 18432, v13
    v_lshrrev_b32 v10, 1, v12
    v_lshl_add_u32 v13, v10, 8, v13
    v_lshl_add_u32 v13, v15, 4, v13
    s_lshr_b32 s21, s14, 1
    s_mul_i32 s22, s6, 36
    s_add_u32 s21, s21, s22
    s_lshl_b32 s21, s21, 10
    s_and_b32 s20, s14, 1
    s_lshl_b32 s20, s20, 9
    s_add_u32 s21, s21, s20
    s_add_u32 s24, s21, 19021824
    s_add_u32 s25, s21, 19023872
    s_add_u32 s26, s21, 16662528
    s_add_u32 s27, s21, 16664576
    s_waitcnt vmcnt(5)
    v_mul_f32 v32, v32, v33
    v_mul_f32 v34, v34, v35
    s_waitcnt vmcnt(4)
    v_mul_f32 v36, v36, v37
    v_mul_f32 v38, v38, v39
    v_lshlrev_b32 v76, 16, v16
    v_and_b32 v77, 0xffff0000, v16
    v_lshlrev_b32 v80, 16, v24
    v_and_b32 v81, 0xffff0000, v24
    v_lshlrev_b32 v78, 16, v17
    v_and_b32 v79, 0xffff0000, v17
    v_lshlrev_b32 v82, 16, v25
    v_and_b32 v83, 0xffff0000, v25
    v_fma_f32 v84, v76, v33, -v32
    v_fma_f32 v85, v77, v33, -v32
    v_fma_f32 v86, v78, v33, -v32
    v_fma_f32 v87, v79, v33, -v32
    v_fma_f32 v76, v84, v80, v76
    v_fma_f32 v77, v85, v81, v77
    v_fma_f32 v78, v86, v82, v78
    v_fma_f32 v79, v87, v83, v79
    v_fma_f32 v84, v76, v35, -v34
    v_fma_f32 v85, v77, v35, -v34
    v_fma_f32 v86, v78, v35, -v34
    v_fma_f32 v87, v79, v35, -v34
    v_add_f32 v84, v84, v60
    v_add_f32 v85, v85, v61
    v_add_f32 v86, v86, v62
    v_add_f32 v87, v87, v63
    v_cvt_pk_bf16_f32 v100, v76, v77
    v_cvt_pk_bf16_f32 v101, v78, v79
    v_cvt_pk_bf16_f32 v104, v84, v85
    v_cvt_pk_bf16_f32 v105, v86, v87
    v_lshlrev_b32 v88, 16, v18
    v_and_b32 v89, 0xffff0000, v18
    v_lshlrev_b32 v92, 16, v26
    v_and_b32 v93, 0xffff0000, v26
    v_lshlrev_b32 v90, 16, v19
    v_and_b32 v91, 0xffff0000, v19
    v_lshlrev_b32 v94, 16, v27
    v_and_b32 v95, 0xffff0000, v27
    v_fma_f32 v96, v88, v37, -v36
    v_fma_f32 v97, v89, v37, -v36
    v_fma_f32 v98, v90, v37, -v36
    v_fma_f32 v99, v91, v37, -v36
    v_fma_f32 v88, v96, v92, v88
    v_fma_f32 v89, v97, v93, v89
    v_fma_f32 v90, v98, v94, v90
    v_fma_f32 v91, v99, v95, v91
    v_fma_f32 v96, v88, v39, -v38
    v_fma_f32 v97, v89, v39, -v38
    v_fma_f32 v98, v90, v39, -v38
    v_fma_f32 v99, v91, v39, -v38
    v_add_f32 v96, v96, v64
    v_add_f32 v97, v97, v65
    v_add_f32 v98, v98, v66
    v_add_f32 v99, v99, v67
    v_cvt_pk_bf16_f32 v102, v88, v89
    v_cvt_pk_bf16_f32 v103, v90, v91
    v_cvt_pk_bf16_f32 v106, v96, v97
    v_cvt_pk_bf16_f32 v107, v98, v99
    s_nop 0
    v_permlane16_swap_b32 v104, v106
    v_permlane16_swap_b32 v105, v107
    v_permlane16_swap_b32 v100, v102
    v_permlane16_swap_b32 v101, v103
    buffer_store_dwordx4 v[104:107], v13, s[44:47], s26 offen sc1
    buffer_store_dwordx4 v[100:103], v13, s[44:47], s24 offen sc1
    v_mov_b32 v76, 0
    v_mov_b32 v77, 0
    v_dot2c_f32_bf16 v76, s63, v104
    v_dot2c_f32_bf16 v77, v104, v104
    v_dot2c_f32_bf16 v76, s63, v105
    v_dot2c_f32_bf16 v77, v105, v105
    v_dot2c_f32_bf16 v76, s63, v106
    v_dot2c_f32_bf16 v77, v106, v106
    v_dot2c_f32_bf16 v76, s63, v107
    v_dot2c_f32_bf16 v77, v107, v107
    s_nop 1
    v_mov_b32 v78, v76
    v_mov_b32 v79, v77
    s_nop 0
    v_permlane32_swap_b32 v76, v78
    v_permlane32_swap_b32 v77, v79
    v_add_f32 v76, v76, v78
    v_add_f32 v77, v77, v79
    v_lshrrev_b32 v10, 1, v3
    s_mul_i32 s20, s6, 36
    s_add_u32 s20, s20, s14
    s_lshl_b32 s20, s20, 8
    s_add_u32 s20, s20, 42483712
    s_mov_b32 exec_hi, 0
    buffer_store_dwordx2 v[76:77], v10, s[44:47], s20 offen offset:0 sc1
    s_mov_b32 exec_hi, -1
    s_waitcnt vmcnt(0) lgkmcnt(0)
    s_barrier
    s_cmp_lg_u32 s3, 4
    s_cbranch_scc1 Lsig14
    s_mov_b64 exec, 1
    v_mov_b32 v1, 1
    v_mov_b32 v10, 0
    buffer_atomic_add v1, v10, s[44:47], s32 offen sc1
    s_mov_b64 exec, -1
Lsig14:
    s_cmp_ge_u32 s3, 4
    s_cbranch_scc1 sequential_preLN__ssm_conv_h3__mixer_s_mlp__prompt_kernel_cb
sequential_preLN__ssm_conv_h3__mixer_s_mlp__prompt_kernel_ca:
    s_nop 4
    s_lshl_b32 s8, s4, 6
    s_mul_i32 s13, s5, 663552
    s_add_u32 s14, s13, 1327104
    s_add_u32 s15, s13, 6635520
    s_lshl_b32 s20, s3, 11
    v_add_u32 v4, s20, v3
    s_lshl_b32 s20, s3, 10
    s_add_u32 s21, s20, 8192
    v_add_u32 v8, s21, v3
    s_add_u32 s21, s20, 16384
    v_add_u32 v0, s21, v3
    s_lshl_b32 s20, s3, 12
    v_add_u32 v2, s20, v3
    s_lshl_b32 s20, s3, 11
    s_add_u32 s20, s20, 20480
    v_add_u32 v13, s20, v3
    s_lshl_b32 s9, s3, 3
    v_lshrrev_b32 v5, 7, v3
    v_add_u32 v5, s9, v5
    v_and_b32 v6, 0x70, v3
    v_mul_u32_u24 v7, 1184, v5
    v_add_u32 v7, v7, v6
    v_and_b32 v5, 15, v5
    v_lshlrev_b32 v5, 4, v5
    v_lshl_add_u32 v5, v6, 4, v5
    s_lshr_b32 s12, s3, 1
    s_lshl_b32 s20, s4, 2
    s_add_u32 s12, s12, s20
    s_mul_i32 s12, s12, 18432
    s_add_u32 s12, s12, 16662528
    v_lshrrev_b32 v9, 7, v3
    v_add_u32 v9, s9, v9
    v_and_b32 v9, 31, v9
    v_lshlrev_b32 v9, 3, v9
    v_lshl_add_u32 v9, v6, 4, v9
    v_cmp_gt_u32 vcc, 64, v6
    v_mov_b32 v14, 0x7ff00000
    s_nop 0
    v_cndmask_b32 v14, v14, v9, vcc
    s_lshr_b32 s20, s3, 2
    s_lshl_b32 s21, s4, 1
    s_add_u32 s20, s20, s21
    s_mul_i32 s20, s20, 9216
    s_add_u32 s20, s20, 42483712
    s_cmp_lg_u32 s3, 4
    s_cbranch_scc1 Lw15_done
    v_mov_b32 v10, 0
    s_mov_b32 s35, 0
Lw15_0:
    buffer_load_dword v1, v10, s[44:47], s33 offen sc1
    s_add_u32 s35, s35, 1
    s_waitcnt vmcnt(0)
    v_readfirstlane_b32 s34, v1
    s_cmp_gt_u32 s35, 0x80000
    s_cbranch_scc1 Lw15_done
    s_cmp_lg_u32 s34, 8
    s_cbranch_scc1 Lw15_0
Lw15_done:
    s_barrier
    buffer_load_dwordx2 v[100:101], v9, s[44:47], s20 offen offset:0 sc1
    buffer_load_dwordx2 v[102:103], v9, s[44:47], s20 offen offset:2048 sc1
    s_add_u32 s20, s20, 4096
    buffer_load_dwordx2 v[104:105], v9, s[44:47], s20 offen offset:0 sc1
    buffer_load_dwordx2 v[106:107], v9, s[44:47], s20 offen offset:2048 sc1
    s_add_u32 s20, s20, 4096
    buffer_load_dwordx2 v[108:109], v14, s[44:47], s20 offen offset:0 sc1
    v_mov_b32 v125, v5
    buffer_load_dwordx4 v[64:67], v125, s[44:47], s12 offen offset:0 sc1
    buffer_load_dwordx4 v[68:71], v125, s[44:47], s12 offen offset:2048 sc1
    s_add_u32 s12, s12, 4096
    buffer_load_dwordx4 v[72:75], v125, s[44:47], s12 offen offset:0 sc1
    v_mov_b32 v1, v7
    v_mul_u32_u24 v14, 1184, v15
    v_lshl_add_u32 v14, v12, 4, v14
    v_add_u32 v5, 75776, v3
    v_add_u32 v6, 112640, v3
    s_lshl_b32 s20, s3, 12
    v_add_u32 v7, s20, v5
    s_lshr_b32 s20, s3, 1
    s_lshl_b32 s20, s20, 12
    s_and_b32 s21, s3, 1
    s_lshl_b32 s21, s21, 3
    s_add_u32 s20, s20, s21
    s_add_u32 s20, s20, 16384
    v_add_u32 v9, s20, v5
    s_lshl_b32 s20, s3, 12
    s_add_u32 s20, s20, 40960
    v_add_u32 v10, s20, v5
    s_mul_i32 s26, s5, 2359296
    s_add_u32 s26, s26, 21446656
    s_mul_i32 s27, s4, 73728
    s_add_u32 s26, s26, s27
    s_lshl_b32 s27, s3, 11
    s_add_u32 s28, s26, s27
    s_lshr_b32 s27, s3, 1
    s_lshl_b32 s27, s27, 10
    s_add_u32 s29, s26, s27
    s_and_b32 s27, s3, 1
    s_lshl_b32 s27, s27, 3
    s_add_u32 s29, s29, s27
    s_add_u32 s29, s29, 8192
    s_waitcnt vmcnt(6)
    v_add_f32 v100, v100, v102
    v_add_f32 v101, v101, v103
    s_waitcnt vmcnt(5)
    v_add_f32 v100, v100, v104
    v_add_f32 v101, v101, v105
    s_waitcnt vmcnt(4)
    v_add_f32 v100, v100, v106
    v_add_f32 v101, v101, v107
    s_waitcnt vmcnt(3)
    v_add_f32 v100, v100, v108
    v_add_f32 v101, v101, v109
    buffer_load_dwordx4 v[76:79], v125, s[44:47], s12 offen offset:2048 sc1
    s_add_u32 s12, s12, 4096
    buffer_load_dwordx4 v[80:83], v125, s[44:47], s12 offen offset:0 sc1
    buffer_load_dwordx4 v[84:87], v125, s[44:47], s12 offen offset:2048 sc1
    s_add_u32 s12, s12, 4096
    v_add_f32_dpp v100, v100, v100 quad_perm:[1,0,3,2] row_mask:0xf bank_mask:0xf
    v_add_f32_dpp v101, v101, v101 quad_perm:[1,0,3,2] row_mask:0xf bank_mask:0xf
    s_nop 0
    v_add_f32_dpp v100, v100, v100 quad_perm:[2,3,0,1] row_mask:0xf bank_mask:0xf
    v_add_f32_dpp v101, v101, v101 quad_perm:[2,3,0,1] row_mask:0xf bank_mask:0xf
    s_nop 0
    v_add_f32_dpp v100, v100, v100 row_half_mirror row_mask:0xf bank_mask:0xf
    v_add_f32_dpp v101, v101, v101 row_half_mirror row_mask:0xf bank_mask:0xf
    v_mul_f32 v102, s60, v100
    v_mul_f32 v101, s60, v101
    v_fma_f32 v101, -v102, v102, v101
    v_max_f32 v101, 0, v101
    v_add_f32 v101, s61, v101
    v_rsq_f32 v126, v101
    s_nop 0
    v_mul_f32 v127, v102, v126
    v_sub_f32 v127, 0, v127
    s_waitcnt vmcnt(5)
    v_lshlrev_b32 v110, 16, v64
    v_and_b32 v111, 0xffff0000, v64
    v_lshlrev_b32 v112, 16, v65
    v_and_b32 v113, 0xffff0000, v65
    v_lshlrev_b32 v114, 16, v66
    v_and_b32 v115, 0xffff0000, v66
    v_lshlrev_b32 v116, 16, v67
    v_and_b32 v117, 0xffff0000, v67
    v_fma_f32 v110, v110, v126, v127
    v_fma_f32 v111, v111, v126, v127
    v_fma_f32 v112, v112, v126, v127
    v_fma_f32 v113, v113, v126, v127
    v_fma_f32 v114, v114, v126, v127
    v_fma_f32 v115, v115, v126, v127
    v_fma_f32 v116, v116, v126, v127
    v_fma_f32 v117, v117, v126, v127
    v_cvt_pk_bf16_f32 v64, v110, v111
    v_cvt_pk_bf16_f32 v65, v112, v113
    v_cvt_pk_bf16_f32 v66, v114, v115
    v_cvt_pk_bf16_f32 v67, v116, v117
    ds_write_b128 v1, v[64:67] offset:0
    s_waitcnt vmcnt(4)
    v_lshlrev_b32 v110, 16, v68
    v_and_b32 v111, 0xffff0000, v68
    v_lshlrev_b32 v112, 16, v69
    v_and_b32 v113, 0xffff0000, v69
    v_lshlrev_b32 v114, 16, v70
    v_and_b32 v115, 0xffff0000, v70
    v_lshlrev_b32 v116, 16, v71
    v_and_b32 v117, 0xffff0000, v71
    v_fma_f32 v110, v110, v126, v127
    v_fma_f32 v111, v111, v126, v127
    v_fma_f32 v112, v112, v126, v127
    v_fma_f32 v113, v113, v126, v127
    v_fma_f32 v114, v114, v126, v127
    v_fma_f32 v115, v115, v126, v127
    v_fma_f32 v116, v116, v126, v127
    v_fma_f32 v117, v117, v126, v127
    v_cvt_pk_bf16_f32 v68, v110, v111
    v_cvt_pk_bf16_f32 v69, v112, v113
    v_cvt_pk_bf16_f32 v70, v114, v115
    v_cvt_pk_bf16_f32 v71, v116, v117
    ds_write_b128 v1, v[68:71] offset:128
    s_waitcnt vmcnt(3)
    v_lshlrev_b32 v110, 16, v72
    v_and_b32 v111, 0xffff0000, v72
    v_lshlrev_b32 v112, 16, v73
    v_and_b32 v113, 0xffff0000, v73
    v_lshlrev_b32 v114, 16, v74
    v_and_b32 v115, 0xffff0000, v74
    v_lshlrev_b32 v116, 16, v75
    v_and_b32 v117, 0xffff0000, v75
    v_fma_f32 v110, v110, v126, v127
    v_fma_f32 v111, v111, v126, v127
    v_fma_f32 v112, v112, v126, v127
    v_fma_f32 v113, v113, v126, v127
    v_fma_f32 v114, v114, v126, v127
    v_fma_f32 v115, v115, v126, v127
    v_fma_f32 v116, v116, v126, v127
    v_fma_f32 v117, v117, v126, v127
    v_cvt_pk_bf16_f32 v72, v110, v111
    v_cvt_pk_bf16_f32 v73, v112, v113
    v_cvt_pk_bf16_f32 v74, v114, v115
    v_cvt_pk_bf16_f32 v75, v116, v117
    ds_write_b128 v1, v[72:75] offset:256
    buffer_load_dwordx4 v[88:91], v125, s[44:47], s12 offen offset:0 sc1
    buffer_load_dwordx4 v[92:95], v125, s[44:47], s12 offen offset:2048 sc1
    s_add_u32 s12, s12, 4096
    buffer_load_dwordx4 v[96:99], v125, s[44:47], s12 offen offset:0 sc1
    s_waitcnt lgkmcnt(0)
    s_barrier
    ds_read_b128 v[128:131], v14 offset:0
    ds_read_b128 v[132:135], v14 offset:18944
    ds_read_b128 v[136:139], v14 offset:37888
    ds_read_b128 v[140:143], v14 offset:56832
    s_waitcnt lgkmcnt(3)
    v_mfma_f32_16x16x32_bf16 v[16:19], a[0:3], v[128:131], 0
    s_waitcnt vmcnt(5)
    v_lshlrev_b32 v110, 16, v76
    s_waitcnt lgkmcnt(2)
    v_mfma_f32_16x16x32_bf16 v[20:23], a[0:3], v[132:135], 0
    ds_read_b128 v[144:147], v14 offset:64
    v_and_b32 v111, 0xffff0000, v76
    s_waitcnt lgkmcnt(2)
    v_mfma_f32_16x16x32_bf16 v[24:27], a[0:3], v[136:139], 0
    ds_read_b128 v[148:151], v14 offset:19008
    v_lshlrev_b32 v112, 16, v77
    s_waitcnt lgkmcnt(2)
    v_mfma_f32_16x16x32_bf16 v[28:31], a[0:3], v[140:143], 0
    ds_read_b128 v[152:155], v14 offset:37952
    v_and_b32 v113, 0xffff0000, v77
    s_add_u32 s24, s14, 258048
    buffer_load_dwordx4 a[0:3], v4, s[44:47], s24 offen offset:1024
    v_mfma_f32_16x16x32_bf16 v[32:35], a[4:7], v[128:131], 0
    ds_read_b128 v[156:159], v14 offset:56896
    v_lshlrev_b32 v114, 16, v78
    v_mfma_f32_16x16x32_bf16 v[36:39], a[4:7], v[132:135], 0
    v_and_b32 v115, 0xffff0000, v78
    v_mfma_f32_16x16x32_bf16 v[40:43], a[4:7], v[136:139], 0
    v_lshlrev_b32 v116, 16, v79
    v_mfma_f32_16x16x32_bf16 v[44:47], a[4:7], v[140:143], 0
    v_and_b32 v117, 0xffff0000, v79
    buffer_load_dwordx4 a[4:7], v8, s[44:47], s24 offen offset:0
    v_mfma_f32_16x16x32_bf16 v[48:51], a[8:11], v[128:131], 0
    v_fma_f32 v110, v110, v126, v127
    v_mfma_f32_16x16x32_bf16 v[52:55], a[8:11], v[132:135], 0
    v_fma_f32 v111, v111, v126, v127
    v_mfma_f32_16x16x32_bf16 v[56:59], a[8:11], v[136:139], 0
    v_fma_f32 v112, v112, v126, v127
    v_mfma_f32_16x16x32_bf16 v[60:63], a[8:11], v[140:143], 0
    v_fma_f32 v113, v113, v126, v127
    s_add_u32 s24, s14, 294912
    buffer_load_dwordx4 a[8:11], v4, s[44:47], s24 offen offset:0
    s_waitcnt lgkmcnt(3)
    v_mfma_f32_16x16x32_bf16 v[16:19], a[12:15], v[144:147], v[16:19]
    v_fma_f32 v114, v114, v126, v127
    s_waitcnt lgkmcnt(2)
    v_mfma_f32_16x16x32_bf16 v[20:23], a[12:15], v[148:151], v[20:23]
    ds_read_b128 v[128:131], v14 offset:128
    v_fma_f32 v115, v115, v126, v127
    s_waitcnt lgkmcnt(2)
    v_mfma_f32_16x16x32_bf16 v[24:27], a[12:15], v[152:155], v[24:27]
    ds_read_b128 v[132:135], v14 offset:19072
    v_fma_f32 v116, v116, v126, v127
    s_waitcnt lgkmcnt(2)
    v_mfma_f32_16x16x32_bf16 v[28:31], a[12:15], v[156:159], v[28:31]
    ds_read_b128 v[136:139], v14 offset:38016
    v_fma_f32 v117, v117, v126, v127
    buffer_load_dwordx4 a[12:15], v4, s[44:47], s24 offen offset:1024
    v_mfma_f32_16x16x32_bf16 v[32:35], a[16:19], v[144:147], v[32:35]
    ds_read_b128 v[140:143], v14 offset:56960
    v_cvt_pk_bf16_f32 v76, v110, v111
    v_mfma_f32_16x16x32_bf16 v[36:39], a[16:19], v[148:151], v[36:39]
    v_cvt_pk_bf16_f32 v77, v112, v113
    v_mfma_f32_16x16x32_bf16 v[40:43], a[16:19], v[152:155], v[40:43]
    v_cvt_pk_bf16_f32 v78, v114, v115
    v_mfma_f32_16x16x32_bf16 v[44:47], a[16:19], v[156:159], v[44:47]
    v_cvt_pk_bf16_f32 v79, v116, v117
    ds_write_b128 v1, v[76:79] offset:384
    buffer_load_dwordx4 a[16:19], v8, s[44:47], s24 offen offset:0
    v_mfma_f32_16x16x32_bf16 v[48:51], a[20:23], v[144:147], v[48:51]
    s_waitcnt vmcnt(9)
    v_lshlrev_b32 v110, 16, v80
    v_mfma_f32_16x16x32_bf16 v[52:55], a[20:23], v[148:151], v[52:55]
    v_and_b32 v111, 0xffff0000, v80
    v_mfma_f32_16x16x32_bf16 v[56:59], a[20:23], v[152:155], v[56:59]
    v_lshlrev_b32 v112, 16, v81
    v_mfma_f32_16x16x32_bf16 v[60:63], a[20:23], v[156:159], v[60:63]
    v_and_b32 v113, 0xffff0000, v81
    s_add_u32 s24, s14, 331776
    buffer_load_dwordx4 a[20:23], v4, s[44:47], s24 offen offset:0
    s_waitcnt lgkmcnt(4)
    v_mfma_f32_16x16x32_bf16 v[16:19], a[24:27], v[128:131], v[16:19]
    v_lshlrev_b32 v114, 16, v82
    s_waitcnt lgkmcnt(3)
    v_mfma_f32_16x16x32_bf16 v[20:23], a[24:27], v[132:135], v[20:23]
    ds_read_b128 v[144:147], v14 offset:192
    v_and_b32 v115, 0xffff0000, v82
    s_waitcnt lgkmcnt(3)
    v_mfma_f32_16x16x32_bf16 v[24:27], a[24:27], v[136:139], v[24:27]
    ds_read_b128 v[148:151], v14 offset:19136
    v_lshlrev_b32 v116, 16, v83
    s_waitcnt lgkmcnt(3)
    v_mfma_f32_16x16x32_bf16 v[28:31], a[24:27], v[140:143], v[28:31]
    ds_read_b128 v[152:155], v14 offset:38080
    v_and_b32 v117, 0xffff0000, v83
    buffer_load_dwordx4 a[24:27], v4, s[44:47], s24 offen offset:1024
    v_mfma_f32_16x16x32_bf16 v[32:35], a[28:31], v[128:131], v[32:35]
    ds_read_b128 v[156:159], v14 offset:57024
    v_fma_f32 v110, v110, v126, v127
    v_mfma_f32_16x16x32_bf16 v[36:39], a[28:31], v[132:135], v[36:39]
    v_fma_f32 v111, v111, v126, v127
    v_mfma_f32_16x16x32_bf16 v[40:43], a[28:31], v[136:139], v[40:43]
    v_fma_f32 v112, v112, v126, v127
    v_mfma_f32_16x16x32_bf16 v[44:47], a[28:31], v[140:143], v[44:47]
    v_fma_f32 v113, v113, v126, v127
    buffer_load_dwordx4 a[28:31], v8, s[44:47], s24 offen offset:0
    v_mfma_f32_16x16x32_bf16 v[48:51], a[32:35], v[128:131], v[48:51]
    v_fma_f32 v114, v114, v126, v127
    v_mfma_f32_16x16x32_bf16 v[52:55], a[32:35], v[132:135], v[52:55]
    v_fma_f32 v115, v115, v126, v127
    v_mfma_f32_16x16x32_bf16 v[56:59], a[32:35], v[136:139], v[56:59]
    v_fma_f32 v116, v116, v126, v127
    v_mfma_f32_16x16x32_bf16 v[60:63], a[32:35], v[140:143], v[60:63]
    v_fma_f32 v117, v117, v126, v127
    s_add_u32 s24, s14, 368640
    buffer_load_dwordx4 a[32:35], v4, s[44:47], s24 offen offset:0
    s_waitcnt lgkmcnt(3)
    v_mfma_f32_16x16x32_bf16 v[16:19], a[36:39], v[144:147], v[16:19]
    v_cvt_pk_bf16_f32 v80, v110, v111
    s_waitcnt lgkmcnt(2)
    v_mfma_f32_16x16x32_bf16 v[20:23], a[36:39], v[148:151], v[20:23]
    ds_read_b128 v[128:131], v14 offset:256
    v_cvt_pk_bf16_f32 v81, v112, v113
    s_waitcnt lgkmcnt(2)
    v_mfma_f32_16x16x32_bf16 v[24:27], a[36:39], v[152:155], v[24:27]
    ds_read_b128 v[132:135], v14 offset:19200
    v_cvt_pk_bf16_f32 v82, v114, v115
    s_waitcnt lgkmcnt(2)
    v_mfma_f32_16x16x32_bf16 v[28:31], a[36:39], v[156:159], v[28:31]
    ds_read_b128 v[136:139], v14 offset:38144
    v_cvt_pk_bf16_f32 v83, v116, v117
    ds_write_b128 v1, v[80:83] offset:512
    buffer_load_dwordx4 a[36:39], v4, s[44:47], s24 offen offset:1024
    v_mfma_f32_16x16x32_bf16 v[32:35], a[40:43], v[144:147], v[32:35]
    ds_read_b128 v[140:143], v14 offset:57088
    s_waitcnt vmcnt(13)
    v_lshlrev_b32 v110, 16, v84
    v_mfma_f32_16x16x32_bf16 v[36:39], a[40:43], v[148:151], v[36:39]
    v_and_b32 v111, 0xffff0000, v84
    v_mfma_f32_16x16x32_bf16 v[40:43], a[40:43], v[152:155], v[40:43]
    v_lshlrev_b32 v112, 16, v85
    v_mfma_f32_16x16x32_bf16 v[44:47], a[40:43], v[156:159], v[44:47]
    v_and_b32 v113, 0xffff0000, v85
    buffer_load_dwordx4 a[40:43], v8, s[44:47], s24 offen offset:0
    v_mfma_f32_16x16x32_bf16 v[48:51], a[44:47], v[144:147], v[48:51]
    v_lshlrev_b32 v114, 16, v86
    v_mfma_f32_16x16x32_bf16 v[52:55], a[44:47], v[148:151], v[52:55]
    v_and_b32 v115, 0xffff0000, v86
    v_mfma_f32_16x16x32_bf16 v[56:59], a[44:47], v[152:155], v[56:59]
    v_lshlrev_b32 v116, 16, v87
    v_mfma_f32_16x16x32_bf16 v[60:63], a[44:47], v[156:159], v[60:63]
    v_and_b32 v117, 0xffff0000, v87
    s_add_u32 s24, s14, 405504
    buffer_load_dwordx4 a[44:47], v4, s[44:47], s24 offen offset:0
    s_waitcnt lgkmcnt(4)
    v_mfma_f32_16x16x32_bf16 v[16:19], a[48:51], v[128:131], v[16:19]
    v_fma_f32 v110, v110, v126, v127
    s_waitcnt lgkmcnt(3)
    v_mfma_f32_16x16x32_bf16 v[20:23], a[48:51], v[132:135], v[20:23]
    ds_read_b128 v[144:147], v14 offset:320
    v_fma_f32 v111, v111, v126, v127
    s_waitcnt lgkmcnt(3)
    v_mfma_f32_16x16x32_bf16 v[24:27], a[48:51], v[136:139], v[24:27]
    ds_read_b128 v[148:151], v14 offset:19264
    v_fma_f32 v112, v112, v126, v127
    s_waitcnt lgkmcnt(2)
    v_mfma_f32_16x16x32_bf16 v[28:31], a[48:51], v[140:143], v[28:31]
    ds_read_b128 v[152:155], v14 offset:38208
    v_fma_f32 v113, v113, v126, v127
    buffer_load_dwordx4 a[48:51], v4, s[44:47], s24 offen offset:1024
    v_mfma_f32_16x16x32_bf16 v[32:35], a[52:55], v[128:131], v[32:35]
    ds_read_b128 v[156:159], v14 offset:57152
    v_fma_f32 v114, v114, v126, v127
    v_mfma_f32_16x16x32_bf16 v[36:39], a[52:55], v[132:135], v[36:39]
    v_fma_f32 v115, v115, v126, v127
    v_mfma_f32_16x16x32_bf16 v[40:43], a[52:55], v[136:139], v[40:43]
    v_fma_f32 v116, v116, v126, v127
    v_mfma_f32_16x16x32_bf16 v[44:47], a[52:55], v[140:143], v[44:47]
    v_fma_f32 v117, v117, v126, v127
    buffer_load_dwordx4 a[52:55], v8, s[44:47], s24 offen offset:0
    v_mfma_f32_16x16x32_bf16 v[48:51], a[56:59], v[128:131], v[48:51]
    v_cvt_pk_bf16_f32 v84, v110, v111
    v_mfma_f32_16x16x32_bf16 v[52:55], a[56:59], v[132:135], v[52:55]
    v_cvt_pk_bf16_f32 v85, v112, v113
    v_mfma_f32_16x16x32_bf16 v[56:59], a[56:59], v[136:139], v[56:59]
    v_cvt_pk_bf16_f32 v86, v114, v115
    v_mfma_f32_16x16x32_bf16 v[60:63], a[56:59], v[140:143], v[60:63]
    v_cvt_pk_bf16_f32 v87, v116, v117
    ds_write_b128 v1, v[84:87] offset:640
    s_add_u32 s24, s14, 442368
    buffer_load_dwordx4 a[56:59], v4, s[44:47], s24 offen offset:0
    s_waitcnt lgkmcnt(4)
    v_mfma_f32_16x16x32_bf16 v[16:19], a[60:63], v[144:147], v[16:19]
    s_waitcnt lgkmcnt(3)
    v_mfma_f32_16x16x32_bf16 v[20:23], a[60:63], v[148:151], v[20:23]
    s_waitcnt lgkmcnt(2)
    v_mfma_f32_16x16x32_bf16 v[24:27], a[60:63], v[152:155], v[24:27]
    s_waitcnt lgkmcnt(1)
    v_mfma_f32_16x16x32_bf16 v[28:31], a[60:63], v[156:159], v[28:31]
    buffer_load_dwordx4 a[60:63], v4, s[44:47], s24 offen offset:1024
    v_mfma_f32_16x16x32_bf16 v[32:35], a[64:67], v[144:147], v[32:35]
    v_mfma_f32_16x16x32_bf16 v[36:39], a[64:67], v[148:151], v[36:39]
    v_mfma_f32_16x16x32_bf16 v[40:43], a[64:67], v[152:155], v[40:43]
    v_mfma_f32_16x16x32_bf16 v[44:47], a[64:67], v[156:159], v[44:47]
    buffer_load_dwordx4 a[64:67], v8, s[44:47], s24 offen offset:0
    v_mfma_f32_16x16x32_bf16 v[48:51], a[68:71], v[144:147], v[48:51]
    v_mfma_f32_16x16x32_bf16 v[52:55], a[68:71], v[148:151], v[52:55]
    v_mfma_f32_16x16x32_bf16 v[56:59], a[68:71], v[152:155], v[56:59]
    v_mfma_f32_16x16x32_bf16 v[60:63], a[68:71], v[156:159], v[60:63]
    s_add_u32 s24, s14, 479232
    buffer_load_dwordx4 a[68:71], v4, s[44:47], s24 offen offset:0
    s_waitcnt lgkmcnt(0)
    s_barrier
    ds_read_b128 v[128:131], v14 offset:384
    ds_read_b128 v[132:135], v14 offset:19328
    ds_read_b128 v[136:139], v14 offset:38272
    ds_read_b128 v[140:143], v14 offset:57216
    s_waitcnt lgkmcnt(3)
    v_mfma_f32_16x16x32_bf16 v[16:19], a[72:75], v[128:131], v[16:19]
    s_waitcnt vmcnt(20)
    v_lshlrev_b32 v110, 16, v88
    s_waitcnt lgkmcnt(2)
    v_mfma_f32_16x16x32_bf16 v[20:23], a[72:75], v[132:135], v[20:23]
    ds_read_b128 v[144:147], v14 offset:448
    v_and_b32 v111, 0xffff0000, v88
    s_waitcnt lgkmcnt(2)
    v_mfma_f32_16x16x32_bf16 v[24:27], a[72:75], v[136:139], v[24:27]
    ds_read_b128 v[148:151], v14 offset:19392
    v_lshlrev_b32 v112, 16, v89
    s_waitcnt lgkmcnt(2)
    v_mfma_f32_16x16x32_bf16 v[28:31], a[72:75], v[140:143], v[28:31]
    ds_read_b128 v[152:155], v14 offset:38336
    v_and_b32 v113, 0xffff0000, v89
    buffer_load_dwordx4 a[72:75], v4, s[44:47], s24 offen offset:1024
    v_mfma_f32_16x16x32_bf16 v[32:35], a[76:79], v[128:131], v[32:35]
    ds_read_b128 v[156:159], v14 offset:57280
    v_lshlrev_b32 v114, 16, v90
    v_mfma_f32_16x16x32_bf16 v[36:39], a[76:79], v[132:135], v[36:39]
    v_and_b32 v115, 0xffff0000, v90
    v_mfma_f32_16x16x32_bf16 v[40:43], a[76:79], v[136:139], v[40:43]
    v_lshlrev_b32 v116, 16, v91
    v_mfma_f32_16x16x32_bf16 v[44:47], a[76:79], v[140:143], v[44:47]
    v_and_b32 v117, 0xffff0000, v91
    buffer_load_dwordx4 a[76:79], v8, s[44:47], s24 offen offset:0
    v_mfma_f32_16x16x32_bf16 v[48:51], a[80:83], v[128:131], v[48:51]
    v_fma_f32 v110, v110, v126, v127
    v_mfma_f32_16x16x32_bf16 v[52:55], a[80:83], v[132:135], v[52:55]
    v_fma_f32 v111, v111, v126, v127
    v_mfma_f32_16x16x32_bf16 v[56:59], a[80:83], v[136:139], v[56:59]
    v_fma_f32 v112, v112, v126, v127
    v_mfma_f32_16x16x32_bf16 v[60:63], a[80:83], v[140:143], v[60:63]
    v_fma_f32 v113, v113, v126, v127
    s_add_u32 s24, s14, 516096
    buffer_load_dwordx4 a[80:83], v4, s[44:47], s24 offen offset:0
    s_waitcnt lgkmcnt(3)
    v_mfma_f32_16x16x32_bf16 v[16:19], a[84:87], v[144:147], v[16:19]
    v_fma_f32 v114, v114, v126, v127
    s_waitcnt lgkmcnt(2)
    v_mfma_f32_16x16x32_bf16 v[20:23], a[84:87], v[148:151], v[20:23]
    ds_read_b128 v[128:131], v14 offset:512
    v_fma_f32 v115, v115, v126, v127
    s_waitcnt lgkmcnt(2)
    v_mfma_f32_16x16x32_bf16 v[24:27], a[84:87], v[152:155], v[24:27]
    ds_read_b128 v[132:135], v14 offset:19456
    v_fma_f32 v116, v116, v126, v127
    s_waitcnt lgkmcnt(2)
    v_mfma_f32_16x16x32_bf16 v[28:31], a[84:87], v[156:159], v[28:31]
    ds_read_b128 v[136:139], v14 offset:38400
    v_fma_f32 v117, v117, v126, v127
    buffer_load_dwordx4 a[84:87], v4, s[44:47], s24 offen offset:1024
    s_waitcnt vmcnt(21)
    v_mfma_f32_16x16x32_bf16 v[32:35], a[0:3], v[144:147], v[32:35]
    ds_read_b128 v[140:143], v14 offset:57344
    v_cvt_pk_bf16_f32 v88, v110, v111
    v_mfma_f32_16x16x32_bf16 v[36:39], a[0:3], v[148:151], v[36:39]
    v_cvt_pk_bf16_f32 v89, v112, v113
    v_mfma_f32_16x16x32_bf16 v[40:43], a[0:3], v[152:155], v[40:43]
    v_cvt_pk_bf16_f32 v90, v114, v115
    v_mfma_f32_16x16x32_bf16 v[44:47], a[0:3], v[156:159], v[44:47]
    v_cvt_pk_bf16_f32 v91, v116, v117
    ds_write_b128 v1, v[88:91] offset:768
    buffer_load_dwordx4 a[0:3], v8, s[44:47], s24 offen offset:0
    s_waitcnt vmcnt(21)
    v_mfma_f32_16x16x32_bf16 v[48:51], a[4:7], v[144:147], v[48:51]
    v_lshlrev_b32 v110, 16, v92
    v_mfma_f32_16x16x32_bf16 v[52:55], a[4:7], v[148:151], v[52:55]
    v_and_b32 v111, 0xffff0000, v92
    v_mfma_f32_16x16x32_bf16 v[56:59], a[4:7], v[152:155], v[56:59]
    v_lshlrev_b32 v112, 16, v93
    v_mfma_f32_16x16x32_bf16 v[60:63], a[4:7], v[156:159], v[60:63]
    v_and_b32 v113, 0xffff0000, v93
    s_add_u32 s24, s14, 552960
    buffer_load_dwordx4 a[4:7], v4, s[44:47], s24 offen offset:0
    s_waitcnt vmcnt(21) lgkmcnt(4)
    v_mfma_f32_16x16x32_bf16 v[16:19], a[8:11], v[128:131], v[16:19]
    v_lshlrev_b32 v114, 16, v94
    s_waitcnt lgkmcnt(3)
    v_mfma_f32_16x16x32_bf16 v[20:23], a[8:11], v[132:135], v[20:23]
    ds_read_b128 v[144:147], v14 offset:576
    v_and_b32 v115, 0xffff0000, v94
    s_waitcnt lgkmcnt(3)
    v_mfma_f32_16x16x32_bf16 v[24:27], a[8:11], v[136:139], v[24:27]
    ds_read_b128 v[148:151], v14 offset:19520
    v_lshlrev_b32 v116, 16, v95
    s_waitcnt lgkmcnt(3)
    v_mfma_f32_16x16x32_bf16 v[28:31], a[8:11], v[140:143], v[28:31]
    ds_read_b128 v[152:155], v14 offset:38464
    v_and_b32 v117, 0xffff0000, v95
    buffer_load_dwordx4 a[8:11], v4, s[44:47], s24 offen offset:1024
    s_waitcnt vmcnt(21)
    v_mfma_f32_16x16x32_bf16 v[32:35], a[12:15], v[128:131], v[32:35]
    ds_read_b128 v[156:159], v14 offset:57408
    v_fma_f32 v110, v110, v126, v127
    v_mfma_f32_16x16x32_bf16 v[36:39], a[12:15], v[132:135], v[36:39]
    v_fma_f32 v111, v111, v126, v127
    v_mfma_f32_16x16x32_bf16 v[40:43], a[12:15], v[136:139], v[40:43]
    v_fma_f32 v112, v112, v126, v127
    v_mfma_f32_16x16x32_bf16 v[44:47], a[12:15], v[140:143], v[44:47]
    v_fma_f32 v113, v113, v126, v127
    buffer_load_dwordx4 a[12:15], v8, s[44:47], s24 offen offset:0
    s_waitcnt vmcnt(21)
    v_mfma_f32_16x16x32_bf16 v[48:51], a[16:19], v[128:131], v[48:51]
    v_fma_f32 v114, v114, v126, v127
    v_mfma_f32_16x16x32_bf16 v[52:55], a[16:19], v[132:135], v[52:55]
    v_fma_f32 v115, v115, v126, v127
    v_mfma_f32_16x16x32_bf16 v[56:59], a[16:19], v[136:139], v[56:59]
    v_fma_f32 v116, v116, v126, v127
    v_mfma_f32_16x16x32_bf16 v[60:63], a[16:19], v[140:143], v[60:63]
    v_fma_f32 v117, v117, v126, v127
    s_add_u32 s24, s14, 589824
    buffer_load_dwordx4 a[16:19], v4, s[44:47], s24 offen offset:0
    s_waitcnt vmcnt(21) lgkmcnt(3)
    v_mfma_f32_16x16x32_bf16 v[16:19], a[20:23], v[144:147], v[16:19]
    v_cvt_pk_bf16_f32 v92, v110, v111
    s_waitcnt lgkmcnt(2)
    v_mfma_f32_16x16x32_bf16 v[20:23], a[20:23], v[148:151], v[20:23]
    ds_read_b128 v[128:131], v14 offset:640
    v_cvt_pk_bf16_f32 v93, v112, v113
    s_waitcnt lgkmcnt(2)
    v_mfma_f32_16x16x32_bf16 v[24:27], a[20:23], v[152:155], v[24:27]
    ds_read_b128 v[132:135], v14 offset:19584
    v_cvt_pk_bf16_f32 v94, v114, v115
    s_waitcnt lgkmcnt(2)
    v_mfma_f32_16x16x32_bf16 v[28:31], a[20:23], v[156:159], v[28:31]
    ds_read_b128 v[136:139], v14 offset:38528
    v_cvt_pk_bf16_f32 v95, v116, v117
    ds_write_b128 v1, v[92:95] offset:896
    buffer_load_dwordx4 a[20:23], v4, s[44:47], s24 offen offset:1024
    s_waitcnt vmcnt(21)
    v_mfma_f32_16x16x32_bf16 v[32:35], a[24:27], v[144:147], v[32:35]
    ds_read_b128 v[140:143], v14 offset:57472
    v_lshlrev_b32 v110, 16, v96
    v_mfma_f32_16x16x32_bf16 v[36:39], a[24:27], v[148:151], v[36:39]
    v_and_b32 v111, 0xffff0000, v96
    v_mfma_f32_16x16x32_bf16 v[40:43], a[24:27], v[152:155], v[40:43]
    v_lshlrev_b32 v112, 16, v97
    v_mfma_f32_16x16x32_bf16 v[44:47], a[24:27], v[156:159], v[44:47]
    v_and_b32 v113, 0xffff0000, v97
    buffer_load_dwordx4 a[24:27], v8, s[44:47], s24 offen offset:0
    s_waitcnt vmcnt(21)
    v_mfma_f32_16x16x32_bf16 v[48:51], a[28:31], v[144:147], v[48:51]
    v_lshlrev_b32 v114, 16, v98
    v_mfma_f32_16x16x32_bf16 v[52:55], a[28:31], v[148:151], v[52:55]
    v_and_b32 v115, 0xffff0000, v98
    v_mfma_f32_16x16x32_bf16 v[56:59], a[28:31], v[152:155], v[56:59]
    v_lshlrev_b32 v116, 16, v99
    v_mfma_f32_16x16x32_bf16 v[60:63], a[28:31], v[156:159], v[60:63]
    v_and_b32 v117, 0xffff0000, v99
    s_add_u32 s24, s14, 626688
    buffer_load_dwordx4 a[28:31], v4, s[44:47], s24 offen offset:0
    s_waitcnt vmcnt(21) lgkmcnt(4)
    v_mfma_f32_16x16x32_bf16 v[16:19], a[32:35], v[128:131], v[16:19]
    v_fma_f32 v110, v110, v126, v127
    s_waitcnt lgkmcnt(3)
    v_mfma_f32_16x16x32_bf16 v[20:23], a[32:35], v[132:135], v[20:23]
    ds_read_b128 v[144:147], v14 offset:704
    v_fma_f32 v111, v111, v126, v127
    s_waitcnt lgkmcnt(3)
    v_mfma_f32_16x16x32_bf16 v[24:27], a[32:35], v[136:139], v[24:27]
    ds_read_b128 v[148:151], v14 offset:19648
    v_fma_f32 v112, v112, v126, v127
    s_waitcnt lgkmcnt(2)
    v_mfma_f32_16x16x32_bf16 v[28:31], a[32:35], v[140:143], v[28:31]
    ds_read_b128 v[152:155], v14 offset:38592
    v_fma_f32 v113, v113, v126, v127
    buffer_load_dwordx4 a[32:35], v4, s[44:47], s24 offen offset:1024
    s_waitcnt vmcnt(21)
    v_mfma_f32_16x16x32_bf16 v[32:35], a[36:39], v[128:131], v[32:35]
    ds_read_b128 v[156:159], v14 offset:57536
    v_fma_f32 v114, v114, v126, v127
    v_mfma_f32_16x16x32_bf16 v[36:39], a[36:39], v[132:135], v[36:39]
    v_fma_f32 v115, v115, v126, v127
    v_mfma_f32_16x16x32_bf16 v[40:43], a[36:39], v[136:139], v[40:43]
    v_fma_f32 v116, v116, v126, v127
    v_mfma_f32_16x16x32_bf16 v[44:47], a[36:39], v[140:143], v[44:47]
    v_fma_f32 v117, v117, v126, v127
    buffer_load_dwordx4 a[36:39], v8, s[44:47], s24 offen offset:0
    s_waitcnt vmcnt(21)
    v_mfma_f32_16x16x32_bf16 v[48:51], a[40:43], v[128:131], v[48:51]
    v_cvt_pk_bf16_f32 v96, v110, v111
    v_mfma_f32_16x16x32_bf16 v[52:55], a[40:43], v[132:135], v[52:55]
    v_cvt_pk_bf16_f32 v97, v112, v113
    v_mfma_f32_16x16x32_bf16 v[56:59], a[40:43], v[136:139], v[56:59]
    v_cvt_pk_bf16_f32 v98, v114, v115
    v_mfma_f32_16x16x32_bf16 v[60:63], a[40:43], v[140:143], v[60:63]
    v_cvt_pk_bf16_f32 v99, v116, v117
    ds_write_b128 v1, v[96:99] offset:1024
    s_add_u32 s24, s14, 0
    buffer_load_dwordx4 a[40:43], v13, s[44:47], s24 offen offset:0
    s_waitcnt vmcnt(21) lgkmcnt(4)
    v_mfma_f32_16x16x32_bf16 v[16:19], a[44:47], v[144:147], v[16:19]
    s_waitcnt lgkmcnt(3)
    v_mfma_f32_16x16x32_bf16 v[20:23], a[44:47], v[148:151], v[20:23]
    s_waitcnt lgkmcnt(2)
    v_mfma_f32_16x16x32_bf16 v[24:27], a[44:47], v[152:155], v[24:27]
    s_waitcnt lgkmcnt(1)
    v_mfma_f32_16x16x32_bf16 v[28:31], a[44:47], v[156:159], v[28:31]
    buffer_load_dwordx4 a[44:47], v13, s[44:47], s24 offen offset:1024
    s_waitcnt vmcnt(21)
    v_mfma_f32_16x16x32_bf16 v[32:35], a[48:51], v[144:147], v[32:35]
    v_mfma_f32_16x16x32_bf16 v[36:39], a[48:51], v[148:151], v[36:39]
    v_mfma_f32_16x16x32_bf16 v[40:43], a[48:51], v[152:155], v[40:43]
    v_mfma_f32_16x16x32_bf16 v[44:47], a[48:51], v[156:159], v[44:47]
    s_add_u32 s24, s14, 36864
    buffer_load_dwordx4 a[48:51], v13, s[44:47], s24 offen offset:0
    s_waitcnt vmcnt(21)
    v_mfma_f32_16x16x32_bf16 v[48:51], a[52:55], v[144:147], v[48:51]
    v_mfma_f32_16x16x32_bf16 v[52:55], a[52:55], v[148:151], v[52:55]
    v_mfma_f32_16x16x32_bf16 v[56:59], a[52:55], v[152:155], v[56:59]
    v_mfma_f32_16x16x32_bf16 v[60:63], a[52:55], v[156:159], v[60:63]
    buffer_load_dwordx4 a[52:55], v13, s[44:47], s24 offen offset:1024
    s_waitcnt lgkmcnt(0)
    s_barrier
    ds_read_b128 v[128:131], v14 offset:768
    ds_read_b128 v[132:135], v14 offset:19712
    ds_read_b128 v[136:139], v14 offset:38656
    ds_read_b128 v[140:143], v14 offset:57600
    s_waitcnt vmcnt(21) lgkmcnt(3)
    v_mfma_f32_16x16x32_bf16 v[16:19], a[56:59], v[128:131], v[16:19]
    s_waitcnt lgkmcnt(2)
    v_mfma_f32_16x16x32_bf16 v[20:23], a[56:59], v[132:135], v[20:23]
    ds_read_b128 v[144:147], v14 offset:832
    s_waitcnt lgkmcnt(2)
    v_mfma_f32_16x16x32_bf16 v[24:27], a[56:59], v[136:139], v[24:27]
    ds_read_b128 v[148:151], v14 offset:19776
    s_waitcnt lgkmcnt(2)
    v_mfma_f32_16x16x32_bf16 v[28:31], a[56:59], v[140:143], v[28:31]
    ds_read_b128 v[152:155], v14 offset:38720
    s_add_u32 s24, s14, 73728
    buffer_load_dwordx4 a[56:59], v13, s[44:47], s24 offen offset:0
    s_waitcnt vmcnt(21)
    v_mfma_f32_16x16x32_bf16 v[32:35], a[60:63], v[128:131], v[32:35]
    ds_read_b128 v[156:159], v14 offset:57664
    v_mfma_f32_16x16x32_bf16 v[36:39], a[60:63], v[132:135], v[36:39]
    v_mfma_f32_16x16x32_bf16 v[40:43], a[60:63], v[136:139], v[40:43]
    v_mfma_f32_16x16x32_bf16 v[44:47], a[60:63], v[140:143], v[44:47]
    buffer_load_dwordx4 a[60:63], v13, s[44:47], s24 offen offset:1024
    s_waitcnt vmcnt(21)
    v_mfma_f32_16x16x32_bf16 v[48:51], a[64:67], v[128:131], v[48:51]
    v_mfma_f32_16x16x32_bf16 v[52:55], a[64:67], v[132:135], v[52:55]
    v_mfma_f32_16x16x32_bf16 v[56:59], a[64:67], v[136:139], v[56:59]
    v_mfma_f32_16x16x32_bf16 v[60:63], a[64:67], v[140:143], v[60:63]
    s_add_u32 s24, s14, 110592
    buffer_load_dwordx4 a[64:67], v13, s[44:47], s24 offen offset:0
    s_waitcnt vmcnt(21) lgkmcnt(3)
    v_mfma_f32_16x16x32_bf16 v[16:19], a[68:71], v[144:147], v[16:19]
    s_waitcnt lgkmcnt(2)
    v_mfma_f32_16x16x32_bf16 v[20:23], a[68:71], v[148:151], v[20:23]
    ds_read_b128 v[128:131], v14 offset:896
    s_waitcnt lgkmcnt(2)
    v_mfma_f32_16x16x32_bf16 v[24:27], a[68:71], v[152:155], v[24:27]
    ds_read_b128 v[132:135], v14 offset:19840
    s_waitcnt lgkmcnt(2)
    v_mfma_f32_16x16x32_bf16 v[28:31], a[68:71], v[156:159], v[28:31]
    ds_read_b128 v[136:139], v14 offset:38784
    buffer_load_dwordx4 a[68:71], v13, s[44:47], s24 offen offset:1024
    s_waitcnt vmcnt(21)
    v_mfma_f32_16x16x32_bf16 v[32:35], a[72:75], v[144:147], v[32:35]
    ds_read_b128 v[140:143], v14 offset:57728
    v_mfma_f32_16x16x32_bf16 v[36:39], a[72:75], v[148:151], v[36:39]
    v_mfma_f32_16x16x32_bf16 v[40:43], a[72:75], v[152:155], v[40:43]
    v_mfma_f32_16x16x32_bf16 v[44:47], a[72:75], v[156:159], v[44:47]
    s_add_u32 s24, s14, 147456
    buffer_load_dwordx4 a[72:75], v13, s[44:47], s24 offen offset:0
    s_waitcnt vmcnt(21)
    v_mfma_f32_16x16x32_bf16 v[48:51], a[76:79], v[144:147], v[48:51]
    v_mfma_f32_16x16x32_bf16 v[52:55], a[76:79], v[148:151], v[52:55]
    v_mfma_f32_16x16x32_bf16 v[56:59], a[76:79], v[152:155], v[56:59]
    v_mfma_f32_16x16x32_bf16 v[60:63], a[76:79], v[156:159], v[60:63]
    buffer_load_dwordx4 a[76:79], v13, s[44:47], s24 offen offset:1024
    s_waitcnt vmcnt(21) lgkmcnt(3)
    v_mfma_f32_16x16x32_bf16 v[16:19], a[80:83], v[128:131], v[16:19]
    s_waitcnt lgkmcnt(2)
    v_mfma_f32_16x16x32_bf16 v[20:23], a[80:83], v[132:135], v[20:23]
    ds_read_b128 v[144:147], v14 offset:960
    s_waitcnt lgkmcnt(2)
    v_mfma_f32_16x16x32_bf16 v[24:27], a[80:83], v[136:139], v[24:27]
    ds_read_b128 v[148:151], v14 offset:19904
    s_waitcnt lgkmcnt(2)
    v_mfma_f32_16x16x32_bf16 v[28:31], a[80:83], v[140:143], v[28:31]
    ds_read_b128 v[152:155], v14 offset:38848
    s_add_u32 s24, s14, 184320
    buffer_load_dwordx4 a[80:83], v13, s[44:47], s24 offen offset:0
    s_waitcnt vmcnt(21)
    v_mfma_f32_16x16x32_bf16 v[32:35], a[84:87], v[128:131], v[32:35]
    ds_read_b128 v[156:159], v14 offset:57792
    v_mfma_f32_16x16x32_bf16 v[36:39], a[84:87], v[132:135], v[36:39]
    v_mfma_f32_16x16x32_bf16 v[40:43], a[84:87], v[136:139], v[40:43]
    v_mfma_f32_16x16x32_bf16 v[44:47], a[84:87], v[140:143], v[44:47]
    buffer_load_dwordx4 a[84:87], v13, s[44:47], s24 offen offset:1024
    s_waitcnt vmcnt(21)
    v_mfma_f32_16x16x32_bf16 v[48:51], a[0:3], v[128:131], v[48:51]
    v_mfma_f32_16x16x32_bf16 v[52:55], a[0:3], v[132:135], v[52:55]
    v_mfma_f32_16x16x32_bf16 v[56:59], a[0:3], v[136:139], v[56:59]
    v_mfma_f32_16x16x32_bf16 v[60:63], a[0:3], v[140:143], v[60:63]
    s_add_u32 s24, s14, 221184
    buffer_load_dwordx4 a[0:3], v13, s[44:47], s24 offen offset:0
    s_waitcnt vmcnt(21) lgkmcnt(3)
    v_mfma_f32_16x16x32_bf16 v[16:19], a[4:7], v[144:147], v[16:19]
    s_waitcnt lgkmcnt(2)
    v_mfma_f32_16x16x32_bf16 v[20:23], a[4:7], v[148:151], v[20:23]
    ds_read_b128 v[128:131], v14 offset:1024
    s_waitcnt lgkmcnt(2)
    v_mfma_f32_16x16x32_bf16 v[24:27], a[4:7], v[152:155], v[24:27]
    ds_read_b128 v[132:135], v14 offset:19968
    s_waitcnt lgkmcnt(2)
    v_mfma_f32_16x16x32_bf16 v[28:31], a[4:7], v[156:159], v[28:31]
    ds_read_b128 v[136:139], v14 offset:38912
    buffer_load_dwordx4 a[4:7], v13, s[44:47], s24 offen offset:1024
    s_waitcnt vmcnt(21)
    v_mfma_f32_16x16x32_bf16 v[32:35], a[8:11], v[144:147], v[32:35]
    ds_read_b128 v[140:143], v14 offset:57856
    v_mfma_f32_16x16x32_bf16 v[36:39], a[8:11], v[148:151], v[36:39]
    v_mfma_f32_16x16x32_bf16 v[40:43], a[8:11], v[152:155], v[40:43]
    v_mfma_f32_16x16x32_bf16 v[44:47], a[8:11], v[156:159], v[44:47]
    s_add_u32 s24, s14, 258048
    buffer_load_dwordx4 a[8:11], v13, s[44:47], s24 offen offset:0
    s_waitcnt vmcnt(21)
    v_mfma_f32_16x16x32_bf16 v[48:51], a[12:15], v[144:147], v[48:51]
    v_mfma_f32_16x16x32_bf16 v[52:55], a[12:15], v[148:151], v[52:55]
    v_mfma_f32_16x16x32_bf16 v[56:59], a[12:15], v[152:155], v[56:59]
    v_mfma_f32_16x16x32_bf16 v[60:63], a[12:15], v[156:159], v[60:63]
    buffer_load_dwordx4 a[12:15], v13, s[44:47], s24 offen offset:1024
    s_waitcnt vmcnt(21) lgkmcnt(3)
    v_mfma_f32_16x16x32_bf16 v[16:19], a[16:19], v[128:131], v[16:19]
    s_waitcnt lgkmcnt(2)
    v_mfma_f32_16x16x32_bf16 v[20:23], a[16:19], v[132:135], v[20:23]
    ds_read_b128 v[144:147], v14 offset:1088
    s_waitcnt lgkmcnt(2)
    v_mfma_f32_16x16x32_bf16 v[24:27], a[16:19], v[136:139], v[24:27]
    ds_read_b128 v[148:151], v14 offset:20032
    s_waitcnt lgkmcnt(2)
    v_mfma_f32_16x16x32_bf16 v[28:31], a[16:19], v[140:143], v[28:31]
    ds_read_b128 v[152:155], v14 offset:38976
    s_add_u32 s24, s14, 294912
    buffer_load_dwordx4 a[16:19], v13, s[44:47], s24 offen offset:0
    s_waitcnt vmcnt(21)
    v_mfma_f32_16x16x32_bf16 v[32:35], a[20:23], v[128:131], v[32:35]
    ds_read_b128 v[156:159], v14 offset:57920
    v_mfma_f32_16x16x32_bf16 v[36:39], a[20:23], v[132:135], v[36:39]
    v_mfma_f32_16x16x32_bf16 v[40:43], a[20:23], v[136:139], v[40:43]
    v_mfma_f32_16x16x32_bf16 v[44:47], a[20:23], v[140:143], v[44:47]
    buffer_load_dwordx4 a[20:23], v13, s[44:47], s24 offen offset:1024
    s_waitcnt vmcnt(21)
    v_mfma_f32_16x16x32_bf16 v[48:51], a[24:27], v[128:131], v[48:51]
    v_mfma_f32_16x16x32_bf16 v[52:55], a[24:27], v[132:135], v[52:55]
    v_mfma_f32_16x16x32_bf16 v[56:59], a[24:27], v[136:139], v[56:59]
    v_mfma_f32_16x16x32_bf16 v[60:63], a[24:27], v[140:143], v[60:63]
    s_add_u32 s24, s14, 331776
    buffer_load_dwordx4 a[24:27], v13, s[44:47], s24 offen offset:0
    s_waitcnt vmcnt(21) lgkmcnt(3)
    v_mfma_f32_16x16x32_bf16 v[16:19], a[28:31], v[144:147], v[16:19]
    s_waitcnt lgkmcnt(2)
    v_mfma_f32_16x16x32_bf16 v[20:23], a[28:31], v[148:151], v[20:23]
    s_waitcnt lgkmcnt(1)
    v_mfma_f32_16x16x32_bf16 v[24:27], a[28:31], v[152:155], v[24:27]
    s_waitcnt lgkmcnt(0)
    v_mfma_f32_16x16x32_bf16 v[28:31], a[28:31], v[156:159], v[28:31]
    buffer_load_dwordx4 a[28:31], v13, s[44:47], s24 offen offset:1024
    s_waitcnt vmcnt(21)
    v_mfma_f32_16x16x32_bf16 v[32:35], a[32:35], v[144:147], v[32:35]
    v_mfma_f32_16x16x32_bf16 v[36:39], a[32:35], v[148:151], v[36:39]
    v_mfma_f32_16x16x32_bf16 v[40:43], a[32:35], v[152:155], v[40:43]
    v_mfma_f32_16x16x32_bf16 v[44:47], a[32:35], v[156:159], v[44:47]
    s_add_u32 s24, s14, 368640
    buffer_load_dwordx4 a[32:35], v13, s[44:47], s24 offen offset:0
    s_waitcnt vmcnt(21)
    v_mfma_f32_16x16x32_bf16 v[48:51], a[36:39], v[144:147], v[48:51]
    v_mfma_f32_16x16x32_bf16 v[52:55], a[36:39], v[148:151], v[52:55]
    v_mfma_f32_16x16x32_bf16 v[56:59], a[36:39], v[152:155], v[56:59]
    v_mfma_f32_16x16x32_bf16 v[60:63], a[36:39], v[156:159], v[60:63]
    buffer_load_dwordx4 a[36:39], v13, s[44:47], s24 offen offset:1024
    ds_read_b128 v[128:131], v14 offset:0
    ds_read_b128 v[132:135], v14 offset:18944
    ds_read_b128 v[136:139], v14 offset:37888
    ds_read_b128 v[140:143], v14 offset:56832
    s_waitcnt vmcnt(21) lgkmcnt(3)
    v_mfma_f32_16x16x32_bf16 v[64:67], a[40:43], v[128:131], 0
    v_mul_f32 v160, v16, v16
    v_mul_f32 v161, v17, v17
    v_mul_f32 v162, v18, v18
    s_waitcnt lgkmcnt(2)
    v_mfma_f32_16x16x32_bf16 v[68:71], a[40:43], v[132:135], 0
    ds_read_b128 v[144:147], v14 offset:64
    v_mul_f32 v163, v19, v19
    v_mul_f32 v164, v32, v32
    v_mul_f32 v165, v33, v33
    s_waitcnt lgkmcnt(2)
    v_mfma_f32_16x16x32_bf16 v[72:75], a[40:43], v[136:139], 0
    ds_read_b128 v[148:151], v14 offset:19008
    v_mul_f32 v166, v34, v34
    v_mul_f32 v167, v35, v35
    v_fma_f32 v160, v160, v11, s62
    s_waitcnt lgkmcnt(2)
    v_mfma_f32_16x16x32_bf16 v[76:79], a[40:43], v[140:143], 0
    ds_read_b128 v[152:155], v14 offset:37952
    v_fma_f32 v161, v161, v11, s62
    v_fma_f32 v162, v162, v11, s62
    v_fma_f32 v163, v163, v11, s62
    s_add_u32 s24, s14, 405504
    buffer_load_dwordx4 a[40:43], v13, s[44:47], s24 offen offset:0
    s_waitcnt vmcnt(21)
    v_mfma_f32_16x16x32_bf16 v[80:83], a[44:47], v[128:131], 0
    ds_read_b128 v[156:159], v14 offset:56896
    v_fma_f32 v164, v164, v11, s62
    v_fma_f32 v165, v165, v11, s62
    v_fma_f32 v166, v166, v11, s62
    v_mfma_f32_16x16x32_bf16 v[84:87], a[44:47], v[132:135], 0
    v_fma_f32 v167, v167, v11, s62
    v_mul_f32 v160, v160, v16
    v_mul_f32 v161, v161, v17
    v_mfma_f32_16x16x32_bf16 v[88:91], a[44:47], v[136:139], 0
    v_mul_f32 v162, v162, v18
    v_mul_f32 v163, v163, v19
    v_mul_f32 v164, v164, v32
    v_mfma_f32_16x16x32_bf16 v[92:95], a[44:47], v[140:143], 0
    v_mul_f32 v165, v165, v33
    v_mul_f32 v166, v166, v34
    v_mul_f32 v167, v167, v35
    buffer_load_dwordx4 a[44:47], v13, s[44:47], s24 offen offset:1024
    s_waitcnt vmcnt(21) lgkmcnt(3)
    v_mfma_f32_16x16x32_bf16 v[64:67], a[48:51], v[144:147], v[64:67]
    v_exp_f32 v160, v160
    v_exp_f32 v161, v161
    v_exp_f32 v162, v162
    s_waitcnt lgkmcnt(2)
    v_mfma_f32_16x16x32_bf16 v[68:71], a[48:51], v[148:151], v[68:71]
    ds_read_b128 v[128:131], v14 offset:128
    v_exp_f32 v163, v163
    v_exp_f32 v164, v164
    v_exp_f32 v165, v165
    s_waitcnt lgkmcnt(2)
    v_mfma_f32_16x16x32_bf16 v[72:75], a[48:51], v[152:155], v[72:75]
    ds_read_b128 v[132:135], v14 offset:19072
    v_exp_f32 v166, v166
    v_exp_f32 v167, v167
    v_add_f32 v160, 1.0, v160
    s_waitcnt lgkmcnt(2)
    v_mfma_f32_16x16x32_bf16 v[76:79], a[48:51], v[156:159], v[76:79]
    ds_read_b128 v[136:139], v14 offset:38016
    v_add_f32 v161, 1.0, v161
    v_add_f32 v162, 1.0, v162
    v_add_f32 v163, 1.0, v163
    s_add_u32 s24, s14, 442368
    buffer_load_dwordx4 a[48:51], v13, s[44:47], s24 offen offset:0
    s_waitcnt vmcnt(21)
    v_mfma_f32_16x16x32_bf16 v[80:83], a[52:55], v[144:147], v[80:83]
    ds_read_b128 v[140:143], v14 offset:56960
    v_add_f32 v164, 1.0, v164
    v_add_f32 v165, 1.0, v165
    v_add_f32 v166, 1.0, v166
    v_mfma_f32_16x16x32_bf16 v[84:87], a[52:55], v[148:151], v[84:87]
    v_add_f32 v167, 1.0, v167
    v_rcp_f32 v160, v160
    v_rcp_f32 v161, v161
    v_mfma_f32_16x16x32_bf16 v[88:91], a[52:55], v[152:155], v[88:91]
    v_rcp_f32 v162, v162
    v_rcp_f32 v163, v163
    v_rcp_f32 v164, v164
    v_rcp_f32 v165, v165
    v_mfma_f32_16x16x32_bf16 v[92:95], a[52:55], v[156:159], v[92:95]
    v_rcp_f32 v166, v166
    v_rcp_f32 v167, v167
    v_mul_f32 v160, v160, v16
    buffer_load_dwordx4 a[52:55], v13, s[44:47], s24 offen offset:1024
    s_waitcnt vmcnt(21) lgkmcnt(3)
    v_mfma_f32_16x16x32_bf16 v[64:67], a[56:59], v[128:131], v[64:67]
    v_mul_f32 v161, v161, v17
    v_mul_f32 v162, v162, v18
    v_mul_f32 v163, v163, v19
    s_waitcnt lgkmcnt(2)
    v_mfma_f32_16x16x32_bf16 v[68:71], a[56:59], v[132:135], v[68:71]
    ds_read_b128 v[144:147], v14 offset:192
    v_mul_f32 v164, v164, v32
    v_mul_f32 v165, v165, v33
    v_mul_f32 v166, v166, v34
    s_waitcnt lgkmcnt(2)
    v_mfma_f32_16x16x32_bf16 v[72:75], a[56:59], v[136:139], v[72:75]
    ds_read_b128 v[148:151], v14 offset:19136
    v_mul_f32 v167, v167, v35
    v_cvt_pk_bf16_f32 v16, v160, v161
    v_cvt_pk_bf16_f32 v17, v162, v163
    s_waitcnt lgkmcnt(2)
    v_mfma_f32_16x16x32_bf16 v[76:79], a[56:59], v[140:143], v[76:79]
    ds_read_b128 v[152:155], v14 offset:38080
    v_cvt_pk_bf16_f32 v18, v164, v165
    v_cvt_pk_bf16_f32 v19, v166, v167
    ds_write_b128 v7, v[16:19] offset:0
    s_add_u32 s24, s14, 479232
    buffer_load_dwordx4 a[56:59], v13, s[44:47], s24 offen offset:0
    s_waitcnt vmcnt(21)
    v_mfma_f32_16x16x32_bf16 v[80:83], a[60:63], v[128:131], v[80:83]
    ds_read_b128 v[156:159], v14 offset:57024
    v_mul_f32 v160, v20, v20
    v_mul_f32 v161, v21, v21
    v_mul_f32 v162, v22, v22
    v_mfma_f32_16x16x32_bf16 v[84:87], a[60:63], v[132:135], v[84:87]
    v_mul_f32 v163, v23, v23
    v_mul_f32 v164, v36, v36
    v_mul_f32 v165, v37, v37
    v_mfma_f32_16x16x32_bf16 v[88:91], a[60:63], v[136:139], v[88:91]
    v_mul_f32 v166, v38, v38
    v_mul_f32 v167, v39, v39
    v_fma_f32 v160, v160, v11, s62
    v_mfma_f32_16x16x32_bf16 v[92:95], a[60:63], v[140:143], v[92:95]
    v_fma_f32 v161, v161, v11, s62
    v_fma_f32 v162, v162, v11, s62
    v_fma_f32 v163, v163, v11, s62
    buffer_load_dwordx4 a[60:63], v13, s[44:47], s24 offen offset:1024
    s_waitcnt vmcnt(21) lgkmcnt(4)
    v_mfma_f32_16x16x32_bf16 v[64:67], a[64:67], v[144:147], v[64:67]
    v_fma_f32 v164, v164, v11, s62
    v_fma_f32 v165, v165, v11, s62
    v_fma_f32 v166, v166, v11, s62
    s_waitcnt lgkmcnt(3)
    v_mfma_f32_16x16x32_bf16 v[68:71], a[64:67], v[148:151], v[68:71]
    ds_read_b128 v[128:131], v14 offset:256
    v_fma_f32 v167, v167, v11, s62
    v_mul_f32 v160, v160, v20
    v_mul_f32 v161, v161, v21
    s_waitcnt lgkmcnt(3)
    v_mfma_f32_16x16x32_bf16 v[72:75], a[64:67], v[152:155], v[72:75]
    ds_read_b128 v[132:135], v14 offset:19200
    v_mul_f32 v162, v162, v22
    v_mul_f32 v163, v163, v23
    v_mul_f32 v164, v164, v36
    s_waitcnt lgkmcnt(2)
    v_mfma_f32_16x16x32_bf16 v[76:79], a[64:67], v[156:159], v[76:79]
    ds_read_b128 v[136:139], v14 offset:38144
    v_mul_f32 v165, v165, v37
    v_mul_f32 v166, v166, v38
    v_mul_f32 v167, v167, v39
    s_add_u32 s24, s14, 516096
    buffer_load_dwordx4 a[64:67], v13, s[44:47], s24 offen offset:0
    s_waitcnt vmcnt(21)
    v_mfma_f32_16x16x32_bf16 v[80:83], a[68:71], v[144:147], v[80:83]
    ds_read_b128 v[140:143], v14 offset:57088
    v_exp_f32 v160, v160
    v_exp_f32 v161, v161
    v_exp_f32 v162, v162
    v_mfma_f32_16x16x32_bf16 v[84:87], a[68:71], v[148:151], v[84:87]
    v_exp_f32 v163, v163
    v_exp_f32 v164, v164
    v_exp_f32 v165, v165
    v_exp_f32 v166, v166
    v_mfma_f32_16x16x32_bf16 v[88:91], a[68:71], v[152:155], v[88:91]
    v_exp_f32 v167, v167
    v_add_f32 v160, 1.0, v160
    v_add_f32 v161, 1.0, v161
    v_mfma_f32_16x16x32_bf16 v[92:95], a[68:71], v[156:159], v[92:95]
    v_add_f32 v162, 1.0, v162
    v_add_f32 v163, 1.0, v163
    v_add_f32 v164, 1.0, v164
    buffer_load_dwordx4 a[68:71], v13, s[44:47], s24 offen offset:1024
    s_waitcnt vmcnt(21) lgkmcnt(3)
    v_mfma_f32_16x16x32_bf16 v[64:67], a[72:75], v[128:131], v[64:67]
    v_add_f32 v165, 1.0, v165
    v_add_f32 v166, 1.0, v166
    v_add_f32 v167, 1.0, v167
    s_waitcnt lgkmcnt(2)
    v_mfma_f32_16x16x32_bf16 v[68:71], a[72:75], v[132:135], v[68:71]
    ds_read_b128 v[144:147], v14 offset:320
    v_rcp_f32 v160, v160
    v_rcp_f32 v161, v161
    v_rcp_f32 v162, v162
    s_waitcnt lgkmcnt(2)
    v_mfma_f32_16x16x32_bf16 v[72:75], a[72:75], v[136:139], v[72:75]
    ds_read_b128 v[148:151], v14 offset:19264
    v_rcp_f32 v163, v163
    v_rcp_f32 v164, v164
    v_rcp_f32 v165, v165
    s_waitcnt lgkmcnt(2)
    v_mfma_f32_16x16x32_bf16 v[76:79], a[72:75], v[140:143], v[76:79]
    ds_read_b128 v[152:155], v14 offset:38208
    v_rcp_f32 v166, v166
    v_rcp_f32 v167, v167
    v_mul_f32 v160, v160, v20
    s_add_u32 s24, s14, 552960
    buffer_load_dwordx4 a[72:75], v13, s[44:47], s24 offen offset:0
    s_waitcnt vmcnt(21)
    v_mfma_f32_16x16x32_bf16 v[80:83], a[76:79], v[128:131], v[80:83]
    ds_read_b128 v[156:159], v14 offset:57152
    v_mul_f32 v161, v161, v21
    v_mul_f32 v162, v162, v22
    v_mul_f32 v163, v163, v23
    v_mfma_f32_16x16x32_bf16 v[84:87], a[76:79], v[132:135], v[84:87]
    v_mul_f32 v164, v164, v36
    v_mul_f32 v165, v165, v37
    v_mul_f32 v166, v166, v38
    v_mfma_f32_16x16x32_bf16 v[88:91], a[76:79], v[136:139], v[88:91]
    v_mul_f32 v167, v167, v39
    v_cvt_pk_bf16_f32 v20, v160, v161
    v_cvt_pk_bf16_f32 v21, v162, v163
    v_mfma_f32_16x16x32_bf16 v[92:95], a[76:79], v[140:143], v[92:95]
    v_cvt_pk_bf16_f32 v22, v164, v165
    v_cvt_pk_bf16_f32 v23, v166, v167
    ds_write_b128 v7, v[20:23] offset:1024
    buffer_load_dwordx4 a[76:79], v13, s[44:47], s24 offen offset:1024
    s_waitcnt vmcnt(21) lgkmcnt(4)
    v_mfma_f32_16x16x32_bf16 v[64:67], a[80:83], v[144:147], v[64:67]
    v_mul_f32 v160, v24, v24
    v_mul_f32 v161, v25, v25
    v_mul_f32 v162, v26, v26
    s_waitcnt lgkmcnt(3)
    v_mfma_f32_16x16x32_bf16 v[68:71], a[80:83], v[148:151], v[68:71]
    ds_read_b128 v[128:131], v14 offset:384
    v_mul_f32 v163, v27, v27
    v_mul_f32 v164, v40, v40
    v_mul_f32 v165, v41, v41
    s_waitcnt lgkmcnt(3)
    v_mfma_f32_16x16x32_bf16 v[72:75], a[80:83], v[152:155], v[72:75]
    ds_read_b128 v[132:135], v14 offset:19328
    v_mul_f32 v166, v42, v42
    v_mul_f32 v167, v43, v43
    v_fma_f32 v160, v160, v11, s62
    s_waitcnt lgkmcnt(3)
    v_mfma_f32_16x16x32_bf16 v[76:79], a[80:83], v[156:159], v[76:79]
    ds_read_b128 v[136:139], v14 offset:38272
    v_fma_f32 v161, v161, v11, s62
    v_fma_f32 v162, v162, v11, s62
    v_fma_f32 v163, v163, v11, s62
    s_add_u32 s24, s14, 589824
    buffer_load_dwordx4 a[80:83], v13, s[44:47], s24 offen offset:0
    s_waitcnt vmcnt(21)
    v_mfma_f32_16x16x32_bf16 v[80:83], a[84:87], v[144:147], v[80:83]
    ds_read_b128 v[140:143], v14 offset:57216
    v_fma_f32 v164, v164, v11, s62
    v_fma_f32 v165, v165, v11, s62
    v_fma_f32 v166, v166, v11, s62
    v_fma_f32 v167, v167, v11, s62
    v_mfma_f32_16x16x32_bf16 v[84:87], a[84:87], v[148:151], v[84:87]
    v_mul_f32 v160, v160, v24
    v_mul_f32 v161, v161, v25
    v_mul_f32 v162, v162, v26
    v_mfma_f32_16x16x32_bf16 v[88:91], a[84:87], v[152:155], v[88:91]
    v_mul_f32 v163, v163, v27
    v_mul_f32 v164, v164, v40
    v_mul_f32 v165, v165, v41
    v_mfma_f32_16x16x32_bf16 v[92:95], a[84:87], v[156:159], v[92:95]
    v_mul_f32 v166, v166, v42
    v_mul_f32 v167, v167, v43
    v_exp_f32 v160, v160
    buffer_load_dwordx4 a[84:87], v13, s[44:47], s24 offen offset:1024
    s_waitcnt vmcnt(21) lgkmcnt(3)
    v_mfma_f32_16x16x32_bf16 v[64:67], a[0:3], v[128:131], v[64:67]
    v_exp_f32 v161, v161
    v_exp_f32 v162, v162
    v_exp_f32 v163, v163
    s_waitcnt lgkmcnt(2)
    v_mfma_f32_16x16x32_bf16 v[68:71], a[0:3], v[132:135], v[68:71]
    ds_read_b128 v[144:147], v14 offset:448
    v_exp_f32 v164, v164
    v_exp_f32 v165, v165
    v_exp_f32 v166, v166
    s_waitcnt lgkmcnt(2)
    v_mfma_f32_16x16x32_bf16 v[72:75], a[0:3], v[136:139], v[72:75]
    ds_read_b128 v[148:151], v14 offset:19392
    v_exp_f32 v167, v167
    v_add_f32 v160, 1.0, v160
    v_add_f32 v161, 1.0, v161
    s_waitcnt lgkmcnt(2)
    v_mfma_f32_16x16x32_bf16 v[76:79], a[0:3], v[140:143], v[76:79]
    ds_read_b128 v[152:155], v14 offset:38336
    v_add_f32 v162, 1.0, v162
    v_add_f32 v163, 1.0, v163
    v_add_f32 v164, 1.0, v164
    s_add_u32 s24, s14, 626688
    buffer_load_dwordx4 a[0:3], v13, s[44:47], s24 offen offset:0
    s_waitcnt vmcnt(21)
    v_mfma_f32_16x16x32_bf16 v[80:83], a[4:7], v[128:131], v[80:83]
    ds_read_b128 v[156:159], v14 offset:57280
    v_add_f32 v165, 1.0, v165
    v_add_f32 v166, 1.0, v166
    v_add_f32 v167, 1.0, v167
    v_mfma_f32_16x16x32_bf16 v[84:87], a[4:7], v[132:135], v[84:87]
    v_rcp_f32 v160, v160
    v_rcp_f32 v161, v161
    v_rcp_f32 v162, v162
    v_mfma_f32_16x16x32_bf16 v[88:91], a[4:7], v[136:139], v[88:91]
    v_rcp_f32 v163, v163
    v_rcp_f32 v164, v164
    v_rcp_f32 v165, v165
    v_mfma_f32_16x16x32_bf16 v[92:95], a[4:7], v[140:143], v[92:95]
    v_rcp_f32 v166, v166
    v_rcp_f32 v167, v167
    v_mul_f32 v160, v160, v24
    buffer_load_dwordx4 a[4:7], v13, s[44:47], s24 offen offset:1024
    s_waitcnt vmcnt(21) lgkmcnt(3)
    v_mfma_f32_16x16x32_bf16 v[64:67], a[8:11], v[144:147], v[64:67]
    v_mul_f32 v161, v161, v25
    v_mul_f32 v162, v162, v26
    v_mul_f32 v163, v163, v27
    s_waitcnt lgkmcnt(2)
    v_mfma_f32_16x16x32_bf16 v[68:71], a[8:11], v[148:151], v[68:71]
    ds_read_b128 v[128:131], v14 offset:512
    v_mul_f32 v164, v164, v40
    v_mul_f32 v165, v165, v41
    v_mul_f32 v166, v166, v42
    s_waitcnt lgkmcnt(2)
    v_mfma_f32_16x16x32_bf16 v[72:75], a[8:11], v[152:155], v[72:75]
    ds_read_b128 v[132:135], v14 offset:19456
    v_mul_f32 v167, v167, v43
    v_cvt_pk_bf16_f32 v24, v160, v161
    v_cvt_pk_bf16_f32 v25, v162, v163
    s_waitcnt lgkmcnt(2)
    v_mfma_f32_16x16x32_bf16 v[76:79], a[8:11], v[156:159], v[76:79]
    ds_read_b128 v[136:139], v14 offset:38400
    v_cvt_pk_bf16_f32 v26, v164, v165
    v_cvt_pk_bf16_f32 v27, v166, v167
    ds_write_b128 v7, v[24:27] offset:2048
    v_mul_f32 v160, v28, v28
    s_add_u32 s24, s15, 0
    buffer_load_dwordx4 a[8:11], v2, s[44:47], s24 offen offset:0
    s_waitcnt vmcnt(21)
    v_mfma_f32_16x16x32_bf16 v[80:83], a[12:15], v[144:147], v[80:83]
    ds_read_b128 v[140:143], v14 offset:57344
    v_mul_f32 v161, v29, v29
    v_mul_f32 v162, v30, v30
    v_mul_f32 v163, v31, v31
    v_mfma_f32_16x16x32_bf16 v[84:87], a[12:15], v[148:151], v[84:87]
    v_mul_f32 v164, v44, v44
    v_mul_f32 v165, v45, v45
    v_mul_f32 v166, v46, v46
    v_mfma_f32_16x16x32_bf16 v[88:91], a[12:15], v[152:155], v[88:91]
    v_mul_f32 v167, v47, v47
    v_fma_f32 v160, v160, v11, s62
    v_fma_f32 v161, v161, v11, s62
    v_mfma_f32_16x16x32_bf16 v[92:95], a[12:15], v[156:159], v[92:95]
    v_fma_f32 v162, v162, v11, s62
    v_fma_f32 v163, v163, v11, s62
    v_fma_f32 v164, v164, v11, s62
    buffer_load_dwordx4 a[12:15], v2, s[44:47], s24 offen offset:1024
    s_waitcnt vmcnt(21) lgkmcnt(4)
    v_mfma_f32_16x16x32_bf16 v[64:67], a[16:19], v[128:131], v[64:67]
    v_fma_f32 v165, v165, v11, s62
    v_fma_f32 v166, v166, v11, s62
    v_fma_f32 v167, v167, v11, s62
    s_waitcnt lgkmcnt(3)
    v_mfma_f32_16x16x32_bf16 v[68:71], a[16:19], v[132:135], v[68:71]
    ds_read_b128 v[144:147], v14 offset:576
    v_mul_f32 v160, v160, v28
    v_mul_f32 v161, v161, v29
    v_mul_f32 v162, v162, v30
    s_waitcnt lgkmcnt(3)
    v_mfma_f32_16x16x32_bf16 v[72:75], a[16:19], v[136:139], v[72:75]
    ds_read_b128 v[148:151], v14 offset:19520
    v_mul_f32 v163, v163, v31
    v_mul_f32 v164, v164, v44
    v_mul_f32 v165, v165, v45
    s_waitcnt lgkmcnt(2)
    v_mfma_f32_16x16x32_bf16 v[76:79], a[16:19], v[140:143], v[76:79]
    ds_read_b128 v[152:155], v14 offset:38464
    v_mul_f32 v166, v166, v46
    v_mul_f32 v167, v167, v47
    v_exp_f32 v160, v160
    buffer_load_dwordx4 a[16:19], v0, s[44:47], s24 offen offset:0
    s_waitcnt vmcnt(21)
    v_mfma_f32_16x16x32_bf16 v[80:83], a[20:23], v[128:131], v[80:83]
    ds_read_b128 v[156:159], v14 offset:57408
    v_exp_f32 v161, v161
    v_exp_f32 v162, v162
    v_exp_f32 v163, v163
    v_mfma_f32_16x16x32_bf16 v[84:87], a[20:23], v[132:135], v[84:87]
    v_exp_f32 v164, v164
    v_exp_f32 v165, v165
    v_exp_f32 v166, v166
    v_mfma_f32_16x16x32_bf16 v[88:91], a[20:23], v[136:139], v[88:91]
    v_exp_f32 v167, v167
    v_add_f32 v160, 1.0, v160
    v_add_f32 v161, 1.0, v161
    v_mfma_f32_16x16x32_bf16 v[92:95], a[20:23], v[140:143], v[92:95]
    v_add_f32 v162, 1.0, v162
    v_add_f32 v163, 1.0, v163
    v_add_f32 v164, 1.0, v164
    buffer_load_dwordx4 a[20:23], v2, s[44:47], s24 offen offset:2048
    s_waitcnt vmcnt(21) lgkmcnt(3)
    v_mfma_f32_16x16x32_bf16 v[64:67], a[24:27], v[144:147], v[64:67]
    v_add_f32 v165, 1.0, v165
    v_add_f32 v166, 1.0, v166
    v_add_f32 v167, 1.0, v167
    s_waitcnt lgkmcnt(2)
    v_mfma_f32_16x16x32_bf16 v[68:71], a[24:27], v[148:151], v[68:71]
    ds_read_b128 v[128:131], v14 offset:640
    v_rcp_f32 v160, v160
    v_rcp_f32 v161, v161
    v_rcp_f32 v162, v162
    s_waitcnt lgkmcnt(2)
    v_mfma_f32_16x16x32_bf16 v[72:75], a[24:27], v[152:155], v[72:75]
    ds_read_b128 v[132:135], v14 offset:19584
    v_rcp_f32 v163, v163
    v_rcp_f32 v164, v164
    v_rcp_f32 v165, v165
    v_rcp_f32 v166, v166
    s_waitcnt lgkmcnt(2)
    v_mfma_f32_16x16x32_bf16 v[76:79], a[24:27], v[156:159], v[76:79]
    ds_read_b128 v[136:139], v14 offset:38528
    v_rcp_f32 v167, v167
    v_mul_f32 v160, v160, v28
    v_mul_f32 v161, v161, v29
    buffer_load_dwordx4 a[24:27], v2, s[44:47], s24 offen offset:3072
    s_waitcnt vmcnt(21)
    v_mfma_f32_16x16x32_bf16 v[80:83], a[28:31], v[144:147], v[80:83]
    ds_read_b128 v[140:143], v14 offset:57472
    v_mul_f32 v162, v162, v30
    v_mul_f32 v163, v163, v31
    v_mul_f32 v164, v164, v44
    v_mfma_f32_16x16x32_bf16 v[84:87], a[28:31], v[148:151], v[84:87]
    v_mul_f32 v165, v165, v45
    v_mul_f32 v166, v166, v46
    v_mul_f32 v167, v167, v47
    v_mfma_f32_16x16x32_bf16 v[88:91], a[28:31], v[152:155], v[88:91]
    v_cvt_pk_bf16_f32 v28, v160, v161
    v_cvt_pk_bf16_f32 v29, v162, v163
    v_cvt_pk_bf16_f32 v30, v164, v165
    v_mfma_f32_16x16x32_bf16 v[92:95], a[28:31], v[156:159], v[92:95]
    v_cvt_pk_bf16_f32 v31, v166, v167
    ds_write_b128 v7, v[28:31] offset:3072
    v_mul_f32 v160, v48, v48
    s_add_u32 s24, s15, 36864
    buffer_load_dwordx4 a[28:31], v2, s[44:47], s24 offen offset:0
    s_waitcnt vmcnt(21) lgkmcnt(4)
    v_mfma_f32_16x16x32_bf16 v[64:67], a[32:35], v[128:131], v[64:67]
    v_mul_f32 v161, v49, v49
    v_mul_f32 v162, v50, v50
    v_mul_f32 v163, v51, v51
    s_waitcnt lgkmcnt(3)
    v_mfma_f32_16x16x32_bf16 v[68:71], a[32:35], v[132:135], v[68:71]
    ds_read_b128 v[144:147], v14 offset:704
    v_mul_f32 v164, v52, v52
    v_mul_f32 v165, v53, v53
    v_mul_f32 v166, v54, v54
    s_waitcnt lgkmcnt(3)
    v_mfma_f32_16x16x32_bf16 v[72:75], a[32:35], v[136:139], v[72:75]
    ds_read_b128 v[148:151], v14 offset:19648
    v_mul_f32 v167, v55, v55
    v_fma_f32 v160, v160, v11, s62
    v_fma_f32 v161, v161, v11, s62
    s_waitcnt lgkmcnt(3)
    v_mfma_f32_16x16x32_bf16 v[76:79], a[32:35], v[140:143], v[76:79]
    ds_read_b128 v[152:155], v14 offset:38592
    v_fma_f32 v162, v162, v11, s62
    v_fma_f32 v163, v163, v11, s62
    v_fma_f32 v164, v164, v11, s62
    buffer_load_dwordx4 a[32:35], v2, s[44:47], s24 offen offset:1024
    s_waitcnt vmcnt(21)
    v_mfma_f32_16x16x32_bf16 v[80:83], a[36:39], v[128:131], v[80:83]
    ds_read_b128 v[156:159], v14 offset:57536
    v_fma_f32 v165, v165, v11, s62
    v_fma_f32 v166, v166, v11, s62
    v_fma_f32 v167, v167, v11, s62
    v_mfma_f32_16x16x32_bf16 v[84:87], a[36:39], v[132:135], v[84:87]
    v_mul_f32 v160, v160, v48
    v_mul_f32 v161, v161, v49
    v_mul_f32 v162, v162, v50
    v_mfma_f32_16x16x32_bf16 v[88:91], a[36:39], v[136:139], v[88:91]
    v_mul_f32 v163, v163, v51
    v_mul_f32 v164, v164, v52
    v_mul_f32 v165, v165, v53
    v_mfma_f32_16x16x32_bf16 v[92:95], a[36:39], v[140:143], v[92:95]
    v_mul_f32 v166, v166, v54
    v_mul_f32 v167, v167, v55
    v_exp_f32 v160, v160
    buffer_load_dwordx4 a[36:39], v0, s[44:47], s24 offen offset:0
    s_waitcnt vmcnt(21) lgkmcnt(3)
    v_mfma_f32_16x16x32_bf16 v[64:67], a[40:43], v[144:147], v[64:67]
    v_exp_f32 v161, v161
    v_exp_f32 v162, v162
    v_exp_f32 v163, v163
    s_waitcnt lgkmcnt(2)
    v_mfma_f32_16x16x32_bf16 v[68:71], a[40:43], v[148:151], v[68:71]
    ds_read_b128 v[128:131], v14 offset:768
    v_exp_f32 v164, v164
    v_exp_f32 v165, v165
    v_exp_f32 v166, v166
    v_exp_f32 v167, v167
    s_waitcnt lgkmcnt(2)
    v_mfma_f32_16x16x32_bf16 v[72:75], a[40:43], v[152:155], v[72:75]
    ds_read_b128 v[132:135], v14 offset:19712
    v_add_f32 v160, 1.0, v160
    v_add_f32 v161, 1.0, v161
    v_add_f32 v162, 1.0, v162
    s_waitcnt lgkmcnt(2)
    v_mfma_f32_16x16x32_bf16 v[76:79], a[40:43], v[156:159], v[76:79]
    ds_read_b128 v[136:139], v14 offset:38656
    v_add_f32 v163, 1.0, v163
    v_add_f32 v164, 1.0, v164
    v_add_f32 v165, 1.0, v165
    buffer_load_dwordx4 a[40:43], v2, s[44:47], s24 offen offset:2048
    s_waitcnt vmcnt(21)
    v_mfma_f32_16x16x32_bf16 v[80:83], a[44:47], v[144:147], v[80:83]
    ds_read_b128 v[140:143], v14 offset:57600
    v_add_f32 v166, 1.0, v166
    v_add_f32 v167, 1.0, v167
    v_rcp_f32 v160, v160
    v_mfma_f32_16x16x32_bf16 v[84:87], a[44:47], v[148:151], v[84:87]
    v_rcp_f32 v161, v161
    v_rcp_f32 v162, v162
    v_rcp_f32 v163, v163
    v_mfma_f32_16x16x32_bf16 v[88:91], a[44:47], v[152:155], v[88:91]
    v_rcp_f32 v164, v164
    v_rcp_f32 v165, v165
    v_rcp_f32 v166, v166
    v_mfma_f32_16x16x32_bf16 v[92:95], a[44:47], v[156:159], v[92:95]
    v_rcp_f32 v167, v167
    v_mul_f32 v160, v160, v48
    v_mul_f32 v161, v161, v49
    buffer_load_dwordx4 a[44:47], v2, s[44:47], s24 offen offset:3072
    s_waitcnt vmcnt(21) lgkmcnt(3)
    v_mfma_f32_16x16x32_bf16 v[64:67], a[48:51], v[128:131], v[64:67]
    v_mul_f32 v162, v162, v50
    v_mul_f32 v163, v163, v51
    v_mul_f32 v164, v164, v52
    s_waitcnt lgkmcnt(2)
    v_mfma_f32_16x16x32_bf16 v[68:71], a[48:51], v[132:135], v[68:71]
    ds_read_b128 v[144:147], v14 offset:832
    v_mul_f32 v165, v165, v53
    v_mul_f32 v166, v166, v54
    v_mul_f32 v167, v167, v55
    s_waitcnt lgkmcnt(2)
    v_mfma_f32_16x16x32_bf16 v[72:75], a[48:51], v[136:139], v[72:75]
    ds_read_b128 v[148:151], v14 offset:19776
    v_cvt_pk_bf16_f32 v48, v160, v161
    v_cvt_pk_bf16_f32 v49, v162, v163
    v_cvt_pk_bf16_f32 v50, v164, v165
    s_waitcnt lgkmcnt(2)
    v_mfma_f32_16x16x32_bf16 v[76:79], a[48:51], v[140:143], v[76:79]
    ds_read_b128 v[152:155], v14 offset:38720
    v_cvt_pk_bf16_f32 v51, v166, v167
    ds_write_b64 v9, v[48:49] offset:0
    ds_write_b64 v9, v[50:51] offset:1024
    s_add_u32 s24, s15, 73728
    buffer_load_dwordx4 a[48:51], v2, s[44:47], s24 offen offset:0
    s_waitcnt vmcnt(21)
    v_mfma_f32_16x16x32_bf16 v[80:83], a[52:55], v[128:131], v[80:83]
    ds_read_b128 v[156:159], v14 offset:57664
    v_mul_f32 v160, v56, v56
    v_mul_f32 v161, v57, v57
    v_mul_f32 v162, v58, v58
    v_mfma_f32_16x16x32_bf16 v[84:87], a[52:55], v[132:135], v[84:87]
    v_mul_f32 v163, v59, v59
    v_mul_f32 v164, v60, v60
    v_mul_f32 v165, v61, v61
    v_mfma_f32_16x16x32_bf16 v[88:91], a[52:55], v[136:139], v[88:91]
    v_mul_f32 v166, v62, v62
    v_mul_f32 v167, v63, v63
    v_fma_f32 v160, v160, v11, s62
    v_mfma_f32_16x16x32_bf16 v[92:95], a[52:55], v[140:143], v[92:95]
    v_fma_f32 v161, v161, v11, s62
    v_fma_f32 v162, v162, v11, s62
    v_fma_f32 v163, v163, v11, s62
    buffer_load_dwordx4 a[52:55], v2, s[44:47], s24 offen offset:1024
    s_waitcnt vmcnt(21) lgkmcnt(5)
    v_mfma_f32_16x16x32_bf16 v[64:67], a[56:59], v[144:147], v[64:67]
    v_fma_f32 v164, v164, v11, s62
    v_fma_f32 v165, v165, v11, s62
    v_fma_f32 v166, v166, v11, s62
    v_fma_f32 v167, v167, v11, s62
    s_waitcnt lgkmcnt(4)
    v_mfma_f32_16x16x32_bf16 v[68:71], a[56:59], v[148:151], v[68:71]
    ds_read_b128 v[128:131], v14 offset:896
    v_mul_f32 v160, v160, v56
    v_mul_f32 v161, v161, v57
    v_mul_f32 v162, v162, v58
    s_waitcnt lgkmcnt(4)
    v_mfma_f32_16x16x32_bf16 v[72:75], a[56:59], v[152:155], v[72:75]
    ds_read_b128 v[132:135], v14 offset:19840
    v_mul_f32 v163, v163, v59
    v_mul_f32 v164, v164, v60
    v_mul_f32 v165, v165, v61
    s_waitcnt lgkmcnt(2)
    v_mfma_f32_16x16x32_bf16 v[76:79], a[56:59], v[156:159], v[76:79]
    ds_read_b128 v[136:139], v14 offset:38784
    v_mul_f32 v166, v166, v62
    v_mul_f32 v167, v167, v63
    v_exp_f32 v160, v160
    buffer_load_dwordx4 a[56:59], v0, s[44:47], s24 offen offset:0
    s_waitcnt vmcnt(21)
    v_mfma_f32_16x16x32_bf16 v[80:83], a[60:63], v[144:147], v[80:83]
    ds_read_b128 v[140:143], v14 offset:57728
    v_exp_f32 v161, v161
    v_exp_f32 v162, v162
    v_exp_f32 v163, v163
    v_mfma_f32_16x16x32_bf16 v[84:87], a[60:63], v[148:151], v[84:87]
    v_exp_f32 v164, v164
    v_exp_f32 v165, v165
    v_exp_f32 v166, v166
    v_mfma_f32_16x16x32_bf16 v[88:91], a[60:63], v[152:155], v[88:91]
    v_exp_f32 v167, v167
    v_add_f32 v160, 1.0, v160
    v_add_f32 v161, 1.0, v161
    v_mfma_f32_16x16x32_bf16 v[92:95], a[60:63], v[156:159], v[92:95]
    v_add_f32 v162, 1.0, v162
    v_add_f32 v163, 1.0, v163
    v_add_f32 v164, 1.0, v164
    buffer_load_dwordx4 a[60:63], v2, s[44:47], s24 offen offset:2048
    s_waitcnt vmcnt(21) lgkmcnt(3)
    v_mfma_f32_16x16x32_bf16 v[64:67], a[64:67], v[128:131], v[64:67]
    v_add_f32 v165, 1.0, v165
    v_add_f32 v166, 1.0, v166
    v_add_f32 v167, 1.0, v167
    s_waitcnt lgkmcnt(2)
    v_mfma_f32_16x16x32_bf16 v[68:71], a[64:67], v[132:135], v[68:71]
    ds_read_b128 v[144:147], v14 offset:960
    v_rcp_f32 v160, v160
    v_rcp_f32 v161, v161
    v_rcp_f32 v162, v162
    s_waitcnt lgkmcnt(2)
    v_mfma_f32_16x16x32_bf16 v[72:75], a[64:67], v[136:139], v[72:75]
    ds_read_b128 v[148:151], v14 offset:19904
    v_rcp_f32 v163, v163
    v_rcp_f32 v164, v164
    v_rcp_f32 v165, v165
    s_waitcnt lgkmcnt(2)
    v_mfma_f32_16x16x32_bf16 v[76:79], a[64:67], v[140:143], v[76:79]
    ds_read_b128 v[152:155], v14 offset:38848
    v_rcp_f32 v166, v166
    v_rcp_f32 v167, v167
    v_mul_f32 v160, v160, v56
    buffer_load_dwordx4 a[64:67], v2, s[44:47], s24 offen offset:3072
    s_waitcnt vmcnt(21)
    v_mfma_f32_16x16x32_bf16 v[80:83], a[68:71], v[128:131], v[80:83]
    ds_read_b128 v[156:159], v14 offset:57792
    v_mul_f32 v161, v161, v57
    v_mul_f32 v162, v162, v58
    v_mul_f32 v163, v163, v59
    v_mfma_f32_16x16x32_bf16 v[84:87], a[68:71], v[132:135], v[84:87]
    v_mul_f32 v164, v164, v60
    v_mul_f32 v165, v165, v61
    v_mul_f32 v166, v166, v62
    v_mfma_f32_16x16x32_bf16 v[88:91], a[68:71], v[136:139], v[88:91]
    v_mul_f32 v167, v167, v63
    v_cvt_pk_bf16_f32 v56, v160, v161
    v_cvt_pk_bf16_f32 v57, v162, v163
    v_mfma_f32_16x16x32_bf16 v[92:95], a[68:71], v[140:143], v[92:95]
    v_cvt_pk_bf16_f32 v58, v164, v165
    v_cvt_pk_bf16_f32 v59, v166, v167
    ds_write_b64 v9, v[56:57] offset:2048
    ds_write_b64 v9, v[58:59] offset:3072
    s_add_u32 s24, s15, 110592
    buffer_load_dwordx4 a[68:71], v2, s[44:47], s24 offen offset:0
    s_waitcnt vmcnt(21) lgkmcnt(5)
    v_mfma_f32_16x16x32_bf16 v[64:67], a[72:75], v[144:147], v[64:67]
    s_waitcnt lgkmcnt(4)
    v_mfma_f32_16x16x32_bf16 v[68:71], a[72:75], v[148:151], v[68:71]
    ds_read_b128 v[128:131], v14 offset:1024
    s_waitcnt lgkmcnt(4)
    v_mfma_f32_16x16x32_bf16 v[72:75], a[72:75], v[152:155], v[72:75]
    ds_read_b128 v[132:135], v14 offset:19968
    s_waitcnt lgkmcnt(4)
    v_mfma_f32_16x16x32_bf16 v[76:79], a[72:75], v[156:159], v[76:79]
    ds_read_b128 v[136:139], v14 offset:38912
    buffer_load_dwordx4 a[72:75], v2, s[44:47], s24 offen offset:1024
    s_waitcnt vmcnt(21)
    v_mfma_f32_16x16x32_bf16 v[80:83], a[76:79], v[144:147], v[80:83]
    ds_read_b128 v[140:143], v14 offset:57856
    v_mfma_f32_16x16x32_bf16 v[84:87], a[76:79], v[148:151], v[84:87]
    v_mfma_f32_16x16x32_bf16 v[88:91], a[76:79], v[152:155], v[88:91]
    v_mfma_f32_16x16x32_bf16 v[92:95], a[76:79], v[156:159], v[92:95]
    buffer_load_dwordx4 a[76:79], v0, s[44:47], s24 offen offset:0
    s_waitcnt vmcnt(21) lgkmcnt(3)
    v_mfma_f32_16x16x32_bf16 v[64:67], a[80:83], v[128:131], v[64:67]
    s_waitcnt lgkmcnt(2)
    v_mfma_f32_16x16x32_bf16 v[68:71], a[80:83], v[132:135], v[68:71]
    ds_read_b128 v[144:147], v14 offset:1088
    s_waitcnt lgkmcnt(2)
    v_mfma_f32_16x16x32_bf16 v[72:75], a[80:83], v[136:139], v[72:75]
    ds_read_b128 v[148:151], v14 offset:20032
    s_waitcnt lgkmcnt(2)
    v_mfma_f32_16x16x32_bf16 v[76:79], a[80:83], v[140:143], v[76:79]
    ds_read_b128 v[152:155], v14 offset:38976
    buffer_load_dwordx4 a[80:83], v2, s[44:47], s24 offen offset:2048
    s_waitcnt vmcnt(21)
    v_mfma_f32_16x16x32_bf16 v[80:83], a[84:87], v[128:131], v[80:83]
    ds_read_b128 v[156:159], v14 offset:57920
    v_mfma_f32_16x16x32_bf16 v[84:87], a[84:87], v[132:135], v[84:87]
    v_mfma_f32_16x16x32_bf16 v[88:91], a[84:87], v[136:139], v[88:91]
    v_mfma_f32_16x16x32_bf16 v[92:95], a[84:87], v[140:143], v[92:95]
    buffer_load_dwordx4 a[84:87], v2, s[44:47], s24 offen offset:3072
    s_waitcnt vmcnt(21) lgkmcnt(3)
    v_mfma_f32_16x16x32_bf16 v[64:67], a[0:3], v[144:147], v[64:67]
    s_waitcnt lgkmcnt(2)
    v_mfma_f32_16x16x32_bf16 v[68:71], a[0:3], v[148:151], v[68:71]
    s_waitcnt lgkmcnt(1)
    v_mfma_f32_16x16x32_bf16 v[72:75], a[0:3], v[152:155], v[72:75]
    s_waitcnt lgkmcnt(0)
    v_mfma_f32_16x16x32_bf16 v[76:79], a[0:3], v[156:159], v[76:79]
    s_add_u32 s24, s15, 147456
    buffer_load_dwordx4 a[0:3], v2, s[44:47], s24 offen offset:0
    s_waitcnt vmcnt(21)
    v_mfma_f32_16x16x32_bf16 v[80:83], a[4:7], v[144:147], v[80:83]
    v_mfma_f32_16x16x32_bf16 v[84:87], a[4:7], v[148:151], v[84:87]
    v_mfma_f32_16x16x32_bf16 v[88:91], a[4:7], v[152:155], v[88:91]
    v_mfma_f32_16x16x32_bf16 v[92:95], a[4:7], v[156:159], v[92:95]
    buffer_load_dwordx4 a[4:7], v2, s[44:47], s24 offen offset:1024
    s_waitcnt lgkmcnt(0)
    s_barrier
    ds_read_b128 v[128:131], v5 offset:0
    ds_read_b128 v[132:135], v5 offset:1024
    ds_read_b128 v[136:139], v5 offset:2048
    ds_read_b128 v[140:143], v5 offset:3072
    s_waitcnt vmcnt(21) lgkmcnt(3)
    v_mfma_f32_16x16x32_bf16 v[16:19], a[8:11], v[128:131], 0
    v_mul_f32 v160, v64, v64
    s_waitcnt lgkmcnt(2)
    v_mfma_f32_16x16x32_bf16 v[20:23], a[8:11], v[132:135], 0
    ds_read_b128 v[144:147], v5 offset:4096
    v_mul_f32 v161, v65, v65
    v_mul_f32 v162, v66, v66
    s_waitcnt lgkmcnt(2)
    v_mfma_f32_16x16x32_bf16 v[24:27], a[8:11], v[136:139], 0
    ds_read_b128 v[148:151], v5 offset:5120
    v_mul_f32 v163, v67, v67
    s_waitcnt lgkmcnt(2)
    v_mfma_f32_16x16x32_bf16 v[28:31], a[8:11], v[140:143], 0
    ds_read_b128 v[152:155], v5 offset:6144
    v_mul_f32 v164, v80, v80
    v_mul_f32 v165, v81, v81
    buffer_load_dwordx4 a[8:11], v0, s[44:47], s24 offen offset:0
    s_waitcnt vmcnt(21)
    v_mfma_f32_16x16x32_bf16 v[32:35], a[12:15], v[128:131], 0
    ds_read_b128 v[156:159], v5 offset:7168
    v_mul_f32 v166, v82, v82
    v_mfma_f32_16x16x32_bf16 v[36:39], a[12:15], v[132:135], 0
    v_mul_f32 v167, v83, v83
    v_fma_f32 v160, v160, v11, s62
    v_mfma_f32_16x16x32_bf16 v[40:43], a[12:15], v[136:139], 0
    v_fma_f32 v161, v161, v11, s62
    v_mfma_f32_16x16x32_bf16 v[44:47], a[12:15], v[140:143], 0
    v_fma_f32 v162, v162, v11, s62
    v_fma_f32 v163, v163, v11, s62
    buffer_load_dwordx4 a[12:15], v2, s[44:47], s24 offen offset:2048
    s_waitcnt vmcnt(21)
    v_mfma_f32_16x16x32_bf16 v[48:51], a[16:19], v[128:131], 0
    v_fma_f32 v164, v164, v11, s62
    v_mfma_f32_16x16x32_bf16 v[52:55], a[16:19], v[132:135], 0
    v_fma_f32 v165, v165, v11, s62
    v_fma_f32 v166, v166, v11, s62
    v_mfma_f32_16x16x32_bf16 v[56:59], a[16:19], v[136:139], 0
    v_fma_f32 v167, v167, v11, s62
    v_mfma_f32_16x16x32_bf16 v[60:63], a[16:19], v[140:143], 0
    v_mul_f32 v160, v160, v64
    v_mul_f32 v161, v161, v65
    buffer_load_dwordx4 a[16:19], v2, s[44:47], s24 offen offset:3072
    s_waitcnt vmcnt(21)
    v_mfma_f32_16x16x32_bf16 v[96:99], a[20:23], v[128:131], 0
    v_mul_f32 v162, v162, v66
    v_mfma_f32_16x16x32_bf16 v[100:103], a[20:23], v[132:135], 0
    v_mul_f32 v163, v163, v67
    v_mul_f32 v164, v164, v80
    v_mfma_f32_16x16x32_bf16 v[104:107], a[20:23], v[136:139], 0
    v_mul_f32 v165, v165, v81
    v_mfma_f32_16x16x32_bf16 v[108:111], a[20:23], v[140:143], 0
    v_mul_f32 v166, v166, v82
    v_mul_f32 v167, v167, v83
    s_add_u32 s24, s15, 184320
    buffer_load_dwordx4 a[20:23], v2, s[44:47], s24 offen offset:0
    s_waitcnt vmcnt(21)
    v_mfma_f32_16x16x32_bf16 v[112:115], a[24:27], v[128:131], 0
    v_exp_f32 v160, v160
    v_mfma_f32_16x16x32_bf16 v[116:119], a[24:27], v[132:135], 0
    v_exp_f32 v161, v161
    v_exp_f32 v162, v162
    v_mfma_f32_16x16x32_bf16 v[120:123], a[24:27], v[136:139], 0
    v_exp_f32 v163, v163
    v_mfma_f32_16x16x32_bf16 v[124:127], a[24:27], v[140:143], 0
    v_exp_f32 v164, v164
    v_exp_f32 v165, v165
    buffer_load_dwordx4 a[24:27], v2, s[44:47], s24 offen offset:1024
    s_waitcnt vmcnt(21) lgkmcnt(3)
    v_mfma_f32_16x16x32_bf16 v[16:19], a[28:31], v[144:147], v[16:19]
    v_exp_f32 v166, v166
    v_exp_f32 v167, v167
    s_waitcnt lgkmcnt(2)
    v_mfma_f32_16x16x32_bf16 v[20:23], a[28:31], v[148:151], v[20:23]
    ds_read_b128 v[128:131], v5 offset:8192
    v_add_f32 v160, 1.0, v160
    s_waitcnt lgkmcnt(2)
    v_mfma_f32_16x16x32_bf16 v[24:27], a[28:31], v[152:155], v[24:27]
    ds_read_b128 v[132:135], v5 offset:9216
    v_add_f32 v161, 1.0, v161
    v_add_f32 v162, 1.0, v162
    s_waitcnt lgkmcnt(2)
    v_mfma_f32_16x16x32_bf16 v[28:31], a[28:31], v[156:159], v[28:31]
    ds_read_b128 v[136:139], v5 offset:10240
    v_add_f32 v163, 1.0, v163
    buffer_load_dwordx4 a[28:31], v0, s[44:47], s24 offen offset:0
    s_waitcnt vmcnt(21)
    v_mfma_f32_16x16x32_bf16 v[32:35], a[32:35], v[144:147], v[32:35]
    ds_read_b128 v[140:143], v5 offset:11264
    v_add_f32 v164, 1.0, v164
    v_add_f32 v165, 1.0, v165
    v_mfma_f32_16x16x32_bf16 v[36:39], a[32:35], v[148:151], v[36:39]
    v_add_f32 v166, 1.0, v166
    v_mfma_f32_16x16x32_bf16 v[40:43], a[32:35], v[152:155], v[40:43]
    v_add_f32 v167, 1.0, v167
    v_rcp_f32 v160, v160
    v_mfma_f32_16x16x32_bf16 v[44:47], a[32:35], v[156:159], v[44:47]
    v_rcp_f32 v161, v161
    buffer_load_dwordx4 a[32:35], v2, s[44:47], s24 offen offset:2048
    s_waitcnt vmcnt(21)
    v_mfma_f32_16x16x32_bf16 v[48:51], a[36:39], v[144:147], v[48:51]
    v_rcp_f32 v162, v162
    v_rcp_f32 v163, v163
    v_mfma_f32_16x16x32_bf16 v[52:55], a[36:39], v[148:151], v[52:55]
    v_rcp_f32 v164, v164
    v_mfma_f32_16x16x32_bf16 v[56:59], a[36:39], v[152:155], v[56:59]
    v_rcp_f32 v165, v165
    v_rcp_f32 v166, v166
    v_mfma_f32_16x16x32_bf16 v[60:63], a[36:39], v[156:159], v[60:63]
    v_rcp_f32 v167, v167
    buffer_load_dwordx4 a[36:39], v2, s[44:47], s24 offen offset:3072
    s_waitcnt vmcnt(21)
    v_mfma_f32_16x16x32_bf16 v[96:99], a[40:43], v[144:147], v[96:99]
    v_mul_f32 v160, v160, v64
    v_mul_f32 v161, v161, v65
    v_mfma_f32_16x16x32_bf16 v[100:103], a[40:43], v[148:151], v[100:103]
    v_mul_f32 v162, v162, v66
    v_mfma_f32_16x16x32_bf16 v[104:107], a[40:43], v[152:155], v[104:107]
    v_mul_f32 v163, v163, v67
    v_mul_f32 v164, v164, v80
    v_mfma_f32_16x16x32_bf16 v[108:111], a[40:43], v[156:159], v[108:111]
    v_mul_f32 v165, v165, v81
    s_add_u32 s24, s15, 221184
    buffer_load_dwordx4 a[40:43], v2, s[44:47], s24 offen offset:0
    s_waitcnt vmcnt(21)
    v_mfma_f32_16x16x32_bf16 v[112:115], a[44:47], v[144:147], v[112:115]
    v_mul_f32 v166, v166, v82
    v_mul_f32 v167, v167, v83
    v_mfma_f32_16x16x32_bf16 v[116:119], a[44:47], v[148:151], v[116:119]
    v_cvt_pk_bf16_f32 v64, v160, v161
    v_mfma_f32_16x16x32_bf16 v[120:123], a[44:47], v[152:155], v[120:123]
    v_cvt_pk_bf16_f32 v65, v162, v163
    v_cvt_pk_bf16_f32 v66, v164, v165
    v_mfma_f32_16x16x32_bf16 v[124:127], a[44:47], v[156:159], v[124:127]
    v_cvt_pk_bf16_f32 v67, v166, v167
    buffer_load_dwordx4 a[44:47], v2, s[44:47], s24 offen offset:1024
    s_waitcnt vmcnt(21) lgkmcnt(3)
    v_mfma_f32_16x16x32_bf16 v[16:19], a[48:51], v[128:131], v[16:19]
    ds_write_b128 v10, v[64:67] offset:0
    v_mul_f32 v160, v68, v68
    s_waitcnt lgkmcnt(3)
    v_mfma_f32_16x16x32_bf16 v[20:23], a[48:51], v[132:135], v[20:23]
    ds_read_b128 v[144:147], v5 offset:12288
    v_mul_f32 v161, v69, v69
    v_mul_f32 v162, v70, v70
    s_waitcnt lgkmcnt(3)
    v_mfma_f32_16x16x32_bf16 v[24:27], a[48:51], v[136:139], v[24:27]
    ds_read_b128 v[148:151], v5 offset:13312
    v_mul_f32 v163, v71, v71
    s_waitcnt lgkmcnt(3)
    v_mfma_f32_16x16x32_bf16 v[28:31], a[48:51], v[140:143], v[28:31]
    ds_read_b128 v[152:155], v5 offset:14336
    v_mul_f32 v164, v84, v84
    v_mul_f32 v165, v85, v85
    buffer_load_dwordx4 a[48:51], v0, s[44:47], s24 offen offset:0
    s_waitcnt vmcnt(21)
    v_mfma_f32_16x16x32_bf16 v[32:35], a[52:55], v[128:131], v[32:35]
    ds_read_b128 v[156:159], v5 offset:15360
    v_mul_f32 v166, v86, v86
    v_mfma_f32_16x16x32_bf16 v[36:39], a[52:55], v[132:135], v[36:39]
    v_mul_f32 v167, v87, v87
    v_fma_f32 v160, v160, v11, s62
    v_mfma_f32_16x16x32_bf16 v[40:43], a[52:55], v[136:139], v[40:43]
    v_fma_f32 v161, v161, v11, s62
    v_mfma_f32_16x16x32_bf16 v[44:47], a[52:55], v[140:143], v[44:47]
    v_fma_f32 v162, v162, v11, s62
    v_fma_f32 v163, v163, v11, s62
    buffer_load_dwordx4 a[52:55], v2, s[44:47], s24 offen offset:2048
    s_waitcnt vmcnt(21)
    v_mfma_f32_16x16x32_bf16 v[48:51], a[56:59], v[128:131], v[48:51]
    v_fma_f32 v164, v164, v11, s62
    v_mfma_f32_16x16x32_bf16 v[52:55], a[56:59], v[132:135], v[52:55]
    v_fma_f32 v165, v165, v11, s62
    v_fma_f32 v166, v166, v11, s62
    v_mfma_f32_16x16x32_bf16 v[56:59], a[56:59], v[136:139], v[56:59]
    v_fma_f32 v167, v167, v11, s62
    v_mfma_f32_16x16x32_bf16 v[60:63], a[56:59], v[140:143], v[60:63]
    v_mul_f32 v160, v160, v68
    v_mul_f32 v161, v161, v69
    buffer_load_dwordx4 a[56:59], v2, s[44:47], s24 offen offset:3072
    s_waitcnt vmcnt(21)
    v_mfma_f32_16x16x32_bf16 v[96:99], a[60:63], v[128:131], v[96:99]
    v_mul_f32 v162, v162, v70
    v_mfma_f32_16x16x32_bf16 v[100:103], a[60:63], v[132:135], v[100:103]
    v_mul_f32 v163, v163, v71
    v_mul_f32 v164, v164, v84
    v_mfma_f32_16x16x32_bf16 v[104:107], a[60:63], v[136:139], v[104:107]
    v_mul_f32 v165, v165, v85
    v_mfma_f32_16x16x32_bf16 v[108:111], a[60:63], v[140:143], v[108:111]
    v_mul_f32 v166, v166, v86
    v_mul_f32 v167, v167, v87
    s_add_u32 s24, s15, 258048
    buffer_load_dwordx4 a[60:63], v2, s[44:47], s24 offen offset:0
    s_waitcnt vmcnt(21)
    v_mfma_f32_16x16x32_bf16 v[112:115], a[64:67], v[128:131], v[112:115]
    v_exp_f32 v160, v160
    v_mfma_f32_16x16x32_bf16 v[116:119], a[64:67], v[132:135], v[116:119]
    v_exp_f32 v161, v161
    v_exp_f32 v162, v162
    v_mfma_f32_16x16x32_bf16 v[120:123], a[64:67], v[136:139], v[120:123]
    v_exp_f32 v163, v163
    v_mfma_f32_16x16x32_bf16 v[124:127], a[64:67], v[140:143], v[124:127]
    v_exp_f32 v164, v164
    v_exp_f32 v165, v165
    buffer_load_dwordx4 a[64:67], v2, s[44:47], s24 offen offset:1024
    s_waitcnt vmcnt(21) lgkmcnt(3)
    v_mfma_f32_16x16x32_bf16 v[16:19], a[68:71], v[144:147], v[16:19]
    v_exp_f32 v166, v166
    v_exp_f32 v167, v167
    s_waitcnt lgkmcnt(2)
    v_mfma_f32_16x16x32_bf16 v[20:23], a[68:71], v[148:151], v[20:23]
    ds_read_b128 v[128:131], v5 offset:16384
    v_add_f32 v160, 1.0, v160
    s_waitcnt lgkmcnt(2)
    v_mfma_f32_16x16x32_bf16 v[24:27], a[68:71], v[152:155], v[24:27]
    ds_read_b128 v[132:135], v5 offset:17408
    v_add_f32 v161, 1.0, v161
    v_add_f32 v162, 1.0, v162
    s_waitcnt lgkmcnt(2)
    v_mfma_f32_16x16x32_bf16 v[28:31], a[68:71], v[156:159], v[28:31]
    ds_read_b128 v[136:139], v5 offset:18432
    v_add_f32 v163, 1.0, v163
    buffer_load_dwordx4 a[68:71], v0, s[44:47], s24 offen offset:0
    s_waitcnt vmcnt(21)
    v_mfma_f32_16x16x32_bf16 v[32:35], a[72:75], v[144:147], v[32:35]
    ds_read_b128 v[140:143], v5 offset:19456
    v_add_f32 v164, 1.0, v164
    v_add_f32 v165, 1.0, v165
    v_mfma_f32_16x16x32_bf16 v[36:39], a[72:75], v[148:151], v[36:39]
    v_add_f32 v166, 1.0, v166
    v_mfma_f32_16x16x32_bf16 v[40:43], a[72:75], v[152:155], v[40:43]
    v_add_f32 v167, 1.0, v167
    v_rcp_f32 v160, v160
    v_mfma_f32_16x16x32_bf16 v[44:47], a[72:75], v[156:159], v[44:47]
    v_rcp_f32 v161, v161
    buffer_load_dwordx4 a[72:75], v2, s[44:47], s24 offen offset:2048
    s_waitcnt vmcnt(21)
    v_mfma_f32_16x16x32_bf16 v[48:51], a[76:79], v[144:147], v[48:51]
    v_rcp_f32 v162, v162
    v_rcp_f32 v163, v163
    v_mfma_f32_16x16x32_bf16 v[52:55], a[76:79], v[148:151], v[52:55]
    v_rcp_f32 v164, v164
    v_mfma_f32_16x16x32_bf16 v[56:59], a[76:79], v[152:155], v[56:59]
    v_rcp_f32 v165, v165
    v_rcp_f32 v166, v166
    v_mfma_f32_16x16x32_bf16 v[60:63], a[76:79], v[156:159], v[60:63]
    v_rcp_f32 v167, v167
    buffer_load_dwordx4 a[76:79], v2, s[44:47], s24 offen offset:3072
    s_waitcnt vmcnt(21)
    v_mfma_f32_16x16x32_bf16 v[96:99], a[80:83], v[144:147], v[96:99]
    v_mul_f32 v160, v160, v68
    v_mul_f32 v161, v161, v69
    v_mfma_f32_16x16x32_bf16 v[100:103], a[80:83], v[148:151], v[100:103]
    v_mul_f32 v162, v162, v70
    v_mfma_f32_16x16x32_bf16 v[104:107], a[80:83], v[152:155], v[104:107]
    v_mul_f32 v163, v163, v71
    v_mul_f32 v164, v164, v84
    v_mfma_f32_16x16x32_bf16 v[108:111], a[80:83], v[156:159], v[108:111]
    v_mul_f32 v165, v165, v85
    s_add_u32 s24, s15, 294912
    buffer_load_dwordx4 a[80:83], v2, s[44:47], s24 offen offset:0
    s_waitcnt vmcnt(21)
    v_mfma_f32_16x16x32_bf16 v[112:115], a[84:87], v[144:147], v[112:115]
    v_mul_f32 v166, v166, v86
    v_mul_f32 v167, v167, v87
    v_mfma_f32_16x16x32_bf16 v[116:119], a[84:87], v[148:151], v[116:119]
    v_cvt_pk_bf16_f32 v68, v160, v161
    v_mfma_f32_16x16x32_bf16 v[120:123], a[84:87], v[152:155], v[120:123]
    v_cvt_pk_bf16_f32 v69, v162, v163
    v_cvt_pk_bf16_f32 v70, v164, v165
    v_mfma_f32_16x16x32_bf16 v[124:127], a[84:87], v[156:159], v[124:127]
    v_cvt_pk_bf16_f32 v71, v166, v167
    buffer_load_dwordx4 a[84:87], v2, s[44:47], s24 offen offset:1024
    s_waitcnt vmcnt(21) lgkmcnt(3)
    v_mfma_f32_16x16x32_bf16 v[16:19], a[0:3], v[128:131], v[16:19]
    ds_write_b128 v10, v[68:71] offset:1024
    v_mul_f32 v160, v72, v72
    s_waitcnt lgkmcnt(3)
    v_mfma_f32_16x16x32_bf16 v[20:23], a[0:3], v[132:135], v[20:23]
    ds_read_b128 v[144:147], v5 offset:20480
    v_mul_f32 v161, v73, v73
    v_mul_f32 v162, v74, v74
    s_waitcnt lgkmcnt(3)
    v_mfma_f32_16x16x32_bf16 v[24:27], a[0:3], v[136:139], v[24:27]
    ds_read_b128 v[148:151], v5 offset:21504
    v_mul_f32 v163, v75, v75
    s_waitcnt lgkmcnt(3)
    v_mfma_f32_16x16x32_bf16 v[28:31], a[0:3], v[140:143], v[28:31]
    ds_read_b128 v[152:155], v5 offset:22528
    v_mul_f32 v164, v88, v88
    v_mul_f32 v165, v89, v89
    buffer_load_dwordx4 a[0:3], v0, s[44:47], s24 offen offset:0
    s_waitcnt vmcnt(21)
    v_mfma_f32_16x16x32_bf16 v[32:35], a[4:7], v[128:131], v[32:35]
    ds_read_b128 v[156:159], v5 offset:23552
    v_mul_f32 v166, v90, v90
    v_mfma_f32_16x16x32_bf16 v[36:39], a[4:7], v[132:135], v[36:39]
    v_mul_f32 v167, v91, v91
    v_fma_f32 v160, v160, v11, s62
    v_mfma_f32_16x16x32_bf16 v[40:43], a[4:7], v[136:139], v[40:43]
    v_fma_f32 v161, v161, v11, s62
    v_mfma_f32_16x16x32_bf16 v[44:47], a[4:7], v[140:143], v[44:47]
    v_fma_f32 v162, v162, v11, s62
    v_fma_f32 v163, v163, v11, s62
    buffer_load_dwordx4 a[4:7], v2, s[44:47], s24 offen offset:2048
    s_waitcnt vmcnt(21)
    v_mfma_f32_16x16x32_bf16 v[48:51], a[8:11], v[128:131], v[48:51]
    v_fma_f32 v164, v164, v11, s62
    v_mfma_f32_16x16x32_bf16 v[52:55], a[8:11], v[132:135], v[52:55]
    v_fma_f32 v165, v165, v11, s62
    v_fma_f32 v166, v166, v11, s62
    v_mfma_f32_16x16x32_bf16 v[56:59], a[8:11], v[136:139], v[56:59]
    v_fma_f32 v167, v167, v11, s62
    v_mfma_f32_16x16x32_bf16 v[60:63], a[8:11], v[140:143], v[60:63]
    v_mul_f32 v160, v160, v72
    v_mul_f32 v161, v161, v73
    buffer_load_dwordx4 a[8:11], v2, s[44:47], s24 offen offset:3072
    s_waitcnt vmcnt(21)
    v_mfma_f32_16x16x32_bf16 v[96:99], a[12:15], v[128:131], v[96:99]
    v_mul_f32 v162, v162, v74
    v_mfma_f32_16x16x32_bf16 v[100:103], a[12:15], v[132:135], v[100:103]
    v_mul_f32 v163, v163, v75
    v_mul_f32 v164, v164, v88
    v_mfma_f32_16x16x32_bf16 v[104:107], a[12:15], v[136:139], v[104:107]
    v_mul_f32 v165, v165, v89
    v_mfma_f32_16x16x32_bf16 v[108:111], a[12:15], v[140:143], v[108:111]
    v_mul_f32 v166, v166, v90
    v_mul_f32 v167, v167, v91
    s_add_u32 s24, s15, 331776
    buffer_load_dwordx4 a[12:15], v2, s[44:47], s24 offen offset:0
    s_waitcnt vmcnt(21)
    v_mfma_f32_16x16x32_bf16 v[112:115], a[16:19], v[128:131], v[112:115]
    v_exp_f32 v160, v160
    v_mfma_f32_16x16x32_bf16 v[116:119], a[16:19], v[132:135], v[116:119]
    v_exp_f32 v161, v161
    v_exp_f32 v162, v162
    v_mfma_f32_16x16x32_bf16 v[120:123], a[16:19], v[136:139], v[120:123]
    v_exp_f32 v163, v163
    v_mfma_f32_16x16x32_bf16 v[124:127], a[16:19], v[140:143], v[124:127]
    v_exp_f32 v164, v164
    v_exp_f32 v165, v165
    buffer_load_dwordx4 a[16:19], v2, s[44:47], s24 offen offset:1024
    s_waitcnt vmcnt(21) lgkmcnt(3)
    v_mfma_f32_16x16x32_bf16 v[16:19], a[20:23], v[144:147], v[16:19]
    v_exp_f32 v166, v166
    v_exp_f32 v167, v167
    s_waitcnt lgkmcnt(2)
    v_mfma_f32_16x16x32_bf16 v[20:23], a[20:23], v[148:151], v[20:23]
    ds_read_b128 v[128:131], v5 offset:24576
    v_add_f32 v160, 1.0, v160
    s_waitcnt lgkmcnt(2)
    v_mfma_f32_16x16x32_bf16 v[24:27], a[20:23], v[152:155], v[24:27]
    ds_read_b128 v[132:135], v5 offset:25600
    v_add_f32 v161, 1.0, v161
    v_add_f32 v162, 1.0, v162
    s_waitcnt lgkmcnt(2)
    v_mfma_f32_16x16x32_bf16 v[28:31], a[20:23], v[156:159], v[28:31]
    ds_read_b128 v[136:139], v5 offset:26624
    v_add_f32 v163, 1.0, v163
    buffer_load_dwordx4 a[20:23], v0, s[44:47], s24 offen offset:0
    s_waitcnt vmcnt(21)
    v_mfma_f32_16x16x32_bf16 v[32:35], a[24:27], v[144:147], v[32:35]
    ds_read_b128 v[140:143], v5 offset:27648
    v_add_f32 v164, 1.0, v164
    v_add_f32 v165, 1.0, v165
    v_mfma_f32_16x16x32_bf16 v[36:39], a[24:27], v[148:151], v[36:39]
    v_add_f32 v166, 1.0, v166
    v_mfma_f32_16x16x32_bf16 v[40:43], a[24:27], v[152:155], v[40:43]
    v_add_f32 v167, 1.0, v167
    v_rcp_f32 v160, v160
    v_mfma_f32_16x16x32_bf16 v[44:47], a[24:27], v[156:159], v[44:47]
    v_rcp_f32 v161, v161
    buffer_load_dwordx4 a[24:27], v2, s[44:47], s24 offen offset:2048
    s_waitcnt vmcnt(21)
    v_mfma_f32_16x16x32_bf16 v[48:51], a[28:31], v[144:147], v[48:51]
    v_rcp_f32 v162, v162
    v_rcp_f32 v163, v163
    v_mfma_f32_16x16x32_bf16 v[52:55], a[28:31], v[148:151], v[52:55]
    v_rcp_f32 v164, v164
    v_mfma_f32_16x16x32_bf16 v[56:59], a[28:31], v[152:155], v[56:59]
    v_rcp_f32 v165, v165
    v_rcp_f32 v166, v166
    v_mfma_f32_16x16x32_bf16 v[60:63], a[28:31], v[156:159], v[60:63]
    v_rcp_f32 v167, v167
    buffer_load_dwordx4 a[28:31], v2, s[44:47], s24 offen offset:3072
    s_waitcnt vmcnt(21)
    v_mfma_f32_16x16x32_bf16 v[96:99], a[32:35], v[144:147], v[96:99]
    v_mul_f32 v160, v160, v72
    v_mul_f32 v161, v161, v73
    v_mfma_f32_16x16x32_bf16 v[100:103], a[32:35], v[148:151], v[100:103]
    v_mul_f32 v162, v162, v74
    v_mfma_f32_16x16x32_bf16 v[104:107], a[32:35], v[152:155], v[104:107]
    v_mul_f32 v163, v163, v75
    v_mul_f32 v164, v164, v88
    v_mfma_f32_16x16x32_bf16 v[108:111], a[32:35], v[156:159], v[108:111]
    v_mul_f32 v165, v165, v89
    s_add_u32 s24, s15, 368640
    buffer_load_dwordx4 a[32:35], v2, s[44:47], s24 offen offset:0
    s_waitcnt vmcnt(21)
    v_mfma_f32_16x16x32_bf16 v[112:115], a[36:39], v[144:147], v[112:115]
    v_mul_f32 v166, v166, v90
    v_mul_f32 v167, v167, v91
    v_mfma_f32_16x16x32_bf16 v[116:119], a[36:39], v[148:151], v[116:119]
    v_cvt_pk_bf16_f32 v72, v160, v161
    v_mfma_f32_16x16x32_bf16 v[120:123], a[36:39], v[152:155], v[120:123]
    v_cvt_pk_bf16_f32 v73, v162, v163
    v_cvt_pk_bf16_f32 v74, v164, v165
    v_mfma_f32_16x16x32_bf16 v[124:127], a[36:39], v[156:159], v[124:127]
    v_cvt_pk_bf16_f32 v75, v166, v167
    buffer_load_dwordx4 a[36:39], v2, s[44:47], s24 offen offset:1024
    s_waitcnt vmcnt(21) lgkmcnt(3)
    v_mfma_f32_16x16x32_bf16 v[16:19], a[40:43], v[128:131], v[16:19]
    ds_write_b128 v10, v[72:75] offset:2048
    v_mul_f32 v160, v76, v76
    s_waitcnt lgkmcnt(3)
    v_mfma_f32_16x16x32_bf16 v[20:23], a[40:43], v[132:135], v[20:23]
    ds_read_b128 v[144:147], v5 offset:28672
    v_mul_f32 v161, v77, v77
    v_mul_f32 v162, v78, v78
    s_waitcnt lgkmcnt(3)
    v_mfma_f32_16x16x32_bf16 v[24:27], a[40:43], v[136:139], v[24:27]
    ds_read_b128 v[148:151], v5 offset:29696
    v_mul_f32 v163, v79, v79
    s_waitcnt lgkmcnt(3)
    v_mfma_f32_16x16x32_bf16 v[28:31], a[40:43], v[140:143], v[28:31]
    ds_read_b128 v[152:155], v5 offset:30720
    v_mul_f32 v164, v92, v92
    v_mul_f32 v165, v93, v93
    buffer_load_dwordx4 a[40:43], v0, s[44:47], s24 offen offset:0
    s_waitcnt vmcnt(21)
    v_mfma_f32_16x16x32_bf16 v[32:35], a[44:47], v[128:131], v[32:35]
    ds_read_b128 v[156:159], v5 offset:31744
    v_mul_f32 v166, v94, v94
    v_mfma_f32_16x16x32_bf16 v[36:39], a[44:47], v[132:135], v[36:39]
    v_mul_f32 v167, v95, v95
    v_fma_f32 v160, v160, v11, s62
    v_mfma_f32_16x16x32_bf16 v[40:43], a[44:47], v[136:139], v[40:43]
    v_fma_f32 v161, v161, v11, s62
    v_mfma_f32_16x16x32_bf16 v[44:47], a[44:47], v[140:143], v[44:47]
    v_fma_f32 v162, v162, v11, s62
    v_fma_f32 v163, v163, v11, s62
    s_add_u32 s24, s15, 405504
    buffer_load_dwordx4 a[44:47], v2, s[44:47], s24 offen offset:0
    s_waitcnt vmcnt(21)
    v_mfma_f32_16x16x32_bf16 v[48:51], a[48:51], v[128:131], v[48:51]
    v_fma_f32 v164, v164, v11, s62
    v_mfma_f32_16x16x32_bf16 v[52:55], a[48:51], v[132:135], v[52:55]
    v_fma_f32 v165, v165, v11, s62
    v_fma_f32 v166, v166, v11, s62
    v_mfma_f32_16x16x32_bf16 v[56:59], a[48:51], v[136:139], v[56:59]
    v_fma_f32 v167, v167, v11, s62
    v_mfma_f32_16x16x32_bf16 v[60:63], a[48:51], v[140:143], v[60:63]
    v_mul_f32 v160, v160, v76
    v_mul_f32 v161, v161, v77
    buffer_load_dwordx4 a[48:51], v2, s[44:47], s24 offen offset:1024
    s_waitcnt vmcnt(21)
    v_mfma_f32_16x16x32_bf16 v[96:99], a[52:55], v[128:131], v[96:99]
    v_mul_f32 v162, v162, v78
    v_mfma_f32_16x16x32_bf16 v[100:103], a[52:55], v[132:135], v[100:103]
    v_mul_f32 v163, v163, v79
    v_mul_f32 v164, v164, v92
    v_mfma_f32_16x16x32_bf16 v[104:107], a[52:55], v[136:139], v[104:107]
    v_mul_f32 v165, v165, v93
    v_mfma_f32_16x16x32_bf16 v[108:111], a[52:55], v[140:143], v[108:111]
    v_mul_f32 v166, v166, v94
    v_mul_f32 v167, v167, v95
    buffer_load_dwordx4 a[52:55], v0, s[44:47], s24 offen offset:0
    s_waitcnt vmcnt(21)
    v_mfma_f32_16x16x32_bf16 v[112:115], a[56:59], v[128:131], v[112:115]
    v_exp_f32 v160, v160
    v_mfma_f32_16x16x32_bf16 v[116:119], a[56:59], v[132:135], v[116:119]
    v_exp_f32 v161, v161
    v_exp_f32 v162, v162
    v_mfma_f32_16x16x32_bf16 v[120:123], a[56:59], v[136:139], v[120:123]
    v_exp_f32 v163, v163
    v_mfma_f32_16x16x32_bf16 v[124:127], a[56:59], v[140:143], v[124:127]
    v_exp_f32 v164, v164
    v_exp_f32 v165, v165
    s_add_u32 s24, s15, 442368
    buffer_load_dwordx4 a[56:59], v2, s[44:47], s24 offen offset:0
    s_waitcnt vmcnt(21) lgkmcnt(3)
    v_mfma_f32_16x16x32_bf16 v[16:19], a[60:63], v[144:147], v[16:19]
    v_exp_f32 v166, v166
    v_exp_f32 v167, v167
    s_waitcnt lgkmcnt(2)
    v_mfma_f32_16x16x32_bf16 v[20:23], a[60:63], v[148:151], v[20:23]
    ds_read_b128 v[128:131], v5 offset:32768
    v_add_f32 v160, 1.0, v160
    s_waitcnt lgkmcnt(2)
    v_mfma_f32_16x16x32_bf16 v[24:27], a[60:63], v[152:155], v[24:27]
    ds_read_b128 v[132:135], v5 offset:33792
    v_add_f32 v161, 1.0, v161
    v_add_f32 v162, 1.0, v162
    s_waitcnt lgkmcnt(2)
    v_mfma_f32_16x16x32_bf16 v[28:31], a[60:63], v[156:159], v[28:31]
    ds_read_b128 v[136:139], v5 offset:34816
    v_add_f32 v163, 1.0, v163
    buffer_load_dwordx4 a[60:63], v2, s[44:47], s24 offen offset:1024
    s_waitcnt vmcnt(21)
    v_mfma_f32_16x16x32_bf16 v[32:35], a[64:67], v[144:147], v[32:35]
    ds_read_b128 v[140:143], v5 offset:35840
    v_add_f32 v164, 1.0, v164
    v_add_f32 v165, 1.0, v165
    v_mfma_f32_16x16x32_bf16 v[36:39], a[64:67], v[148:151], v[36:39]
    v_add_f32 v166, 1.0, v166
    v_mfma_f32_16x16x32_bf16 v[40:43], a[64:67], v[152:155], v[40:43]
    v_add_f32 v167, 1.0, v167
    v_rcp_f32 v160, v160
    v_mfma_f32_16x16x32_bf16 v[44:47], a[64:67], v[156:159], v[44:47]
    v_rcp_f32 v161, v161
    buffer_load_dwordx4 a[64:67], v0, s[44:47], s24 offen offset:0
    s_waitcnt vmcnt(21)
    v_mfma_f32_16x16x32_bf16 v[48:51], a[68:71], v[144:147], v[48:51]
    v_rcp_f32 v162, v162
    v_rcp_f32 v163, v163
    v_mfma_f32_16x16x32_bf16 v[52:55], a[68:71], v[148:151], v[52:55]
    v_rcp_f32 v164, v164
    v_mfma_f32_16x16x32_bf16 v[56:59], a[68:71], v[152:155], v[56:59]
    v_rcp_f32 v165, v165
    v_rcp_f32 v166, v166
    v_mfma_f32_16x16x32_bf16 v[60:63], a[68:71], v[156:159], v[60:63]
    v_rcp_f32 v167, v167
    s_add_u32 s24, s15, 479232
    buffer_load_dwordx4 a[68:71], v2, s[44:47], s24 offen offset:0
    s_waitcnt vmcnt(21)
    v_mfma_f32_16x16x32_bf16 v[96:99], a[72:75], v[144:147], v[96:99]
    v_mul_f32 v160, v160, v76
    v_mul_f32 v161, v161, v77
    v_mfma_f32_16x16x32_bf16 v[100:103], a[72:75], v[148:151], v[100:103]
    v_mul_f32 v162, v162, v78
    v_mfma_f32_16x16x32_bf16 v[104:107], a[72:75], v[152:155], v[104:107]
    v_mul_f32 v163, v163, v79
    v_mul_f32 v164, v164, v92
    v_mfma_f32_16x16x32_bf16 v[108:111], a[72:75], v[156:159], v[108:111]
    v_mul_f32 v165, v165, v93
    buffer_load_dwordx4 a[72:75], v2, s[44:47], s24 offen offset:1024
    s_waitcnt vmcnt(21)
    v_mfma_f32_16x16x32_bf16 v[112:115], a[76:79], v[144:147], v[112:115]
    v_mul_f32 v166, v166, v94
    v_mul_f32 v167, v167, v95
    v_mfma_f32_16x16x32_bf16 v[116:119], a[76:79], v[148:151], v[116:119]
    v_cvt_pk_bf16_f32 v76, v160, v161
    v_mfma_f32_16x16x32_bf16 v[120:123], a[76:79], v[152:155], v[120:123]
    v_cvt_pk_bf16_f32 v77, v162, v163
    v_cvt_pk_bf16_f32 v78, v164, v165
    v_mfma_f32_16x16x32_bf16 v[124:127], a[76:79], v[156:159], v[124:127]
    v_cvt_pk_bf16_f32 v79, v166, v167
    buffer_load_dwordx4 a[76:79], v0, s[44:47], s24 offen offset:0
    s_waitcnt vmcnt(21) lgkmcnt(3)
    v_mfma_f32_16x16x32_bf16 v[16:19], a[80:83], v[128:131], v[16:19]
    ds_write_b128 v10, v[76:79] offset:3072
    s_waitcnt lgkmcnt(3)
    v_mfma_f32_16x16x32_bf16 v[20:23], a[80:83], v[132:135], v[20:23]
    ds_read_b128 v[144:147], v6 offset:0
    s_waitcnt lgkmcnt(3)
    v_mfma_f32_16x16x32_bf16 v[24:27], a[80:83], v[136:139], v[24:27]
    ds_read_b128 v[148:151], v6 offset:1024
    s_waitcnt lgkmcnt(3)
    v_mfma_f32_16x16x32_bf16 v[28:31], a[80:83], v[140:143], v[28:31]
    ds_read_b128 v[152:155], v6 offset:2048
    s_add_u32 s24, s15, 516096
    buffer_load_dwordx4 a[80:83], v2, s[44:47], s24 offen offset:0
    s_waitcnt vmcnt(21)
    v_mfma_f32_16x16x32_bf16 v[32:35], a[84:87], v[128:131], v[32:35]
    ds_read_b128 v[156:159], v6 offset:3072
    v_mfma_f32_16x16x32_bf16 v[36:39], a[84:87], v[132:135], v[36:39]
    v_mfma_f32_16x16x32_bf16 v[40:43], a[84:87], v[136:139], v[40:43]
    v_mfma_f32_16x16x32_bf16 v[44:47], a[84:87], v[140:143], v[44:47]
    buffer_load_dwordx4 a[84:87], v2, s[44:47], s24 offen offset:1024
    s_waitcnt vmcnt(21)
    v_mfma_f32_16x16x32_bf16 v[48:51], a[0:3], v[128:131], v[48:51]
    v_mfma_f32_16x16x32_bf16 v[52:55], a[0:3], v[132:135], v[52:55]
    v_mfma_f32_16x16x32_bf16 v[56:59], a[0:3], v[136:139], v[56:59]
    v_mfma_f32_16x16x32_bf16 v[60:63], a[0:3], v[140:143], v[60:63]
    buffer_load_dwordx4 a[0:3], v0, s[44:47], s24 offen offset:0
    s_waitcnt vmcnt(21)
    v_mfma_f32_16x16x32_bf16 v[96:99], a[4:7], v[128:131], v[96:99]
    v_mfma_f32_16x16x32_bf16 v[100:103], a[4:7], v[132:135], v[100:103]
    v_mfma_f32_16x16x32_bf16 v[104:107], a[4:7], v[136:139], v[104:107]
    v_mfma_f32_16x16x32_bf16 v[108:111], a[4:7], v[140:143], v[108:111]
    s_add_u32 s24, s15, 552960
    buffer_load_dwordx4 a[4:7], v2, s[44:47], s24 offen offset:0
    s_waitcnt vmcnt(21)
    v_mfma_f32_16x16x32_bf16 v[112:115], a[8:11], v[128:131], v[112:115]
    v_mfma_f32_16x16x32_bf16 v[116:119], a[8:11], v[132:135], v[116:119]
    v_mfma_f32_16x16x32_bf16 v[120:123], a[8:11], v[136:139], v[120:123]
    v_mfma_f32_16x16x32_bf16 v[124:127], a[8:11], v[140:143], v[124:127]
    buffer_load_dwordx4 a[8:11], v2, s[44:47], s24 offen offset:1024
    s_waitcnt vmcnt(21) lgkmcnt(3)
    v_mfma_f32_16x16x32_bf16 v[16:19], a[12:15], v[144:147], v[16:19]
    s_waitcnt lgkmcnt(2)
    v_mfma_f32_16x16x32_bf16 v[20:23], a[12:15], v[148:151], v[20:23]
    s_waitcnt lgkmcnt(1)
    v_mfma_f32_16x16x32_bf16 v[24:27], a[12:15], v[152:155], v[24:27]
    s_waitcnt lgkmcnt(0)
    v_mfma_f32_16x16x32_bf16 v[28:31], a[12:15], v[156:159], v[28:31]
    buffer_load_dwordx4 a[12:15], v0, s[44:47], s24 offen offset:0
    s_waitcnt vmcnt(21)
    v_mfma_f32_16x16x32_bf16 v[32:35], a[16:19], v[144:147], v[32:35]
    v_mfma_f32_16x16x32_bf16 v[36:39], a[16:19], v[148:151], v[36:39]
    v_mfma_f32_16x16x32_bf16 v[40:43], a[16:19], v[152:155], v[40:43]
    v_mfma_f32_16x16x32_bf16 v[44:47], a[16:19], v[156:159], v[44:47]
    s_add_u32 s24, s15, 589824
    buffer_load_dwordx4 a[16:19], v2, s[44:47], s24 offen offset:0
    s_waitcnt vmcnt(21)
    v_mfma_f32_16x16x32_bf16 v[48:51], a[20:23], v[144:147], v[48:51]
    v_mfma_f32_16x16x32_bf16 v[52:55], a[20:23], v[148:151], v[52:55]
    v_mfma_f32_16x16x32_bf16 v[56:59], a[20:23], v[152:155], v[56:59]
    v_mfma_f32_16x16x32_bf16 v[60:63], a[20:23], v[156:159], v[60:63]
    buffer_load_dwordx4 a[20:23], v2, s[44:47], s24 offen offset:1024
    s_waitcnt vmcnt(21)
    v_mfma_f32_16x16x32_bf16 v[96:99], a[24:27], v[144:147], v[96:99]
    v_mfma_f32_16x16x32_bf16 v[100:103], a[24:27], v[148:151], v[100:103]
    v_mfma_f32_16x16x32_bf16 v[104:107], a[24:27], v[152:155], v[104:107]
    v_mfma_f32_16x16x32_bf16 v[108:111], a[24:27], v[156:159], v[108:111]
    buffer_load_dwordx4 a[24:27], v0, s[44:47], s24 offen offset:0
    s_waitcnt vmcnt(21)
    v_mfma_f32_16x16x32_bf16 v[112:115], a[28:31], v[144:147], v[112:115]
    v_mfma_f32_16x16x32_bf16 v[116:119], a[28:31], v[148:151], v[116:119]
    v_mfma_f32_16x16x32_bf16 v[120:123], a[28:31], v[152:155], v[120:123]
    v_mfma_f32_16x16x32_bf16 v[124:127], a[28:31], v[156:159], v[124:127]
    s_add_u32 s24, s15, 626688
    buffer_load_dwordx4 a[28:31], v2, s[44:47], s24 offen offset:0
    s_waitcnt lgkmcnt(0)
    s_barrier
    ds_read_b128 v[128:131], v6 offset:4096
    ds_read_b128 v[132:135], v6 offset:5120
    ds_read_b128 v[136:139], v6 offset:6144
    ds_read_b128 v[140:143], v6 offset:7168
    s_waitcnt vmcnt(21) lgkmcnt(3)
    v_mfma_f32_16x16x32_bf16 v[16:19], a[32:35], v[128:131], v[16:19]
    s_waitcnt lgkmcnt(2)
    v_mfma_f32_16x16x32_bf16 v[20:23], a[32:35], v[132:135], v[20:23]
    ds_read_b128 v[144:147], v6 offset:8192
    s_waitcnt lgkmcnt(2)
    v_mfma_f32_16x16x32_bf16 v[24:27], a[32:35], v[136:139], v[24:27]
    ds_read_b128 v[148:151], v6 offset:9216
    s_waitcnt lgkmcnt(2)
    v_mfma_f32_16x16x32_bf16 v[28:31], a[32:35], v[140:143], v[28:31]
    ds_read_b128 v[152:155], v6 offset:10240
    buffer_load_dwordx4 a[32:35], v2, s[44:47], s24 offen offset:1024
    s_waitcnt vmcnt(21)
    v_mfma_f32_16x16x32_bf16 v[32:35], a[36:39], v[128:131], v[32:35]
    ds_read_b128 v[156:159], v6 offset:11264
    v_mfma_f32_16x16x32_bf16 v[36:39], a[36:39], v[132:135], v[36:39]
    v_mfma_f32_16x16x32_bf16 v[40:43], a[36:39], v[136:139], v[40:43]
    v_mfma_f32_16x16x32_bf16 v[44:47], a[36:39], v[140:143], v[44:47]
    buffer_load_dwordx4 a[36:39], v0, s[44:47], s24 offen offset:0
    s_waitcnt vmcnt(21)
    v_mfma_f32_16x16x32_bf16 v[48:51], a[40:43], v[128:131], v[48:51]
    v_mfma_f32_16x16x32_bf16 v[52:55], a[40:43], v[132:135], v[52:55]
    v_mfma_f32_16x16x32_bf16 v[56:59], a[40:43], v[136:139], v[56:59]
    v_mfma_f32_16x16x32_bf16 v[60:63], a[40:43], v[140:143], v[60:63]
    s_add_u32 s24, s15, 368640
    buffer_load_dwordx4 a[40:43], v2, s[44:47], s24 offen offset:2048
    s_waitcnt vmcnt(21) lgkmcnt(3)
    v_mfma_f32_16x16x32_bf16 v[16:19], a[44:47], v[144:147], v[16:19]
    s_waitcnt lgkmcnt(2)
    v_mfma_f32_16x16x32_bf16 v[20:23], a[44:47], v[148:151], v[20:23]
    ds_read_b128 v[128:131], v6 offset:12288
    s_waitcnt lgkmcnt(2)
    v_mfma_f32_16x16x32_bf16 v[24:27], a[44:47], v[152:155], v[24:27]
    ds_read_b128 v[132:135], v6 offset:13312
    s_waitcnt lgkmcnt(2)
    v_mfma_f32_16x16x32_bf16 v[28:31], a[44:47], v[156:159], v[28:31]
    ds_read_b128 v[136:139], v6 offset:14336
    buffer_load_dwordx4 a[44:47], v2, s[44:47], s24 offen offset:3072
    s_waitcnt vmcnt(21)
    v_mfma_f32_16x16x32_bf16 v[32:35], a[48:51], v[144:147], v[32:35]
    ds_read_b128 v[140:143], v6 offset:15360
    v_mfma_f32_16x16x32_bf16 v[36:39], a[48:51], v[148:151], v[36:39]
    v_mfma_f32_16x16x32_bf16 v[40:43], a[48:51], v[152:155], v[40:43]
    v_mfma_f32_16x16x32_bf16 v[44:47], a[48:51], v[156:159], v[44:47]
    s_add_u32 s24, s15, 405504
    buffer_load_dwordx4 a[48:51], v2, s[44:47], s24 offen offset:2048
    s_waitcnt vmcnt(21)
    v_mfma_f32_16x16x32_bf16 v[48:51], a[52:55], v[144:147], v[48:51]
    v_mfma_f32_16x16x32_bf16 v[52:55], a[52:55], v[148:151], v[52:55]
    v_mfma_f32_16x16x32_bf16 v[56:59], a[52:55], v[152:155], v[56:59]
    v_mfma_f32_16x16x32_bf16 v[60:63], a[52:55], v[156:159], v[60:63]
    buffer_load_dwordx4 a[52:55], v2, s[44:47], s24 offen offset:3072
    s_waitcnt vmcnt(21) lgkmcnt(3)
    v_mfma_f32_16x16x32_bf16 v[16:19], a[56:59], v[128:131], v[16:19]
    s_waitcnt lgkmcnt(2)
    v_mfma_f32_16x16x32_bf16 v[20:23], a[56:59], v[132:135], v[20:23]
    ds_read_b128 v[144:147], v6 offset:16384
    s_waitcnt lgkmcnt(2)
    v_mfma_f32_16x16x32_bf16 v[24:27], a[56:59], v[136:139], v[24:27]
    ds_read_b128 v[148:151], v6 offset:17408
    s_waitcnt lgkmcnt(2)
    v_mfma_f32_16x16x32_bf16 v[28:31], a[56:59], v[140:143], v[28:31]
    ds_read_b128 v[152:155], v6 offset:18432
    s_add_u32 s24, s15, 442368
    buffer_load_dwordx4 a[56:59], v2, s[44:47], s24 offen offset:2048
    s_waitcnt vmcnt(21)
    v_mfma_f32_16x16x32_bf16 v[32:35], a[60:63], v[128:131], v[32:35]
    ds_read_b128 v[156:159], v6 offset:19456
    v_mfma_f32_16x16x32_bf16 v[36:39], a[60:63], v[132:135], v[36:39]
    v_mfma_f32_16x16x32_bf16 v[40:43], a[60:63], v[136:139], v[40:43]
    v_mfma_f32_16x16x32_bf16 v[44:47], a[60:63], v[140:143], v[44:47]
    buffer_load_dwordx4 a[60:63], v2, s[44:47], s24 offen offset:3072
    s_waitcnt vmcnt(21)
    v_mfma_f32_16x16x32_bf16 v[48:51], a[64:67], v[128:131], v[48:51]
    v_mfma_f32_16x16x32_bf16 v[52:55], a[64:67], v[132:135], v[52:55]
    v_mfma_f32_16x16x32_bf16 v[56:59], a[64:67], v[136:139], v[56:59]
    v_mfma_f32_16x16x32_bf16 v[60:63], a[64:67], v[140:143], v[60:63]
    s_add_u32 s24, s15, 479232
    buffer_load_dwordx4 a[64:67], v2, s[44:47], s24 offen offset:2048
    s_waitcnt vmcnt(21) lgkmcnt(3)
    v_mfma_f32_16x16x32_bf16 v[16:19], a[68:71], v[144:147], v[16:19]
    s_waitcnt lgkmcnt(2)
    v_mfma_f32_16x16x32_bf16 v[20:23], a[68:71], v[148:151], v[20:23]
    ds_read_b128 v[128:131], v6 offset:20480
    s_waitcnt lgkmcnt(2)
    v_mfma_f32_16x16x32_bf16 v[24:27], a[68:71], v[152:155], v[24:27]
    ds_read_b128 v[132:135], v6 offset:21504
    s_waitcnt lgkmcnt(2)
    v_mfma_f32_16x16x32_bf16 v[28:31], a[68:71], v[156:159], v[28:31]
    ds_read_b128 v[136:139], v6 offset:22528
    buffer_load_dwordx4 a[68:71], v2, s[44:47], s24 offen offset:3072
    s_waitcnt vmcnt(21)
    v_mfma_f32_16x16x32_bf16 v[32:35], a[72:75], v[144:147], v[32:35]
    ds_read_b128 v[140:143], v6 offset:23552
    v_mfma_f32_16x16x32_bf16 v[36:39], a[72:75], v[148:151], v[36:39]
    v_mfma_f32_16x16x32_bf16 v[40:43], a[72:75], v[152:155], v[40:43]
    v_mfma_f32_16x16x32_bf16 v[44:47], a[72:75], v[156:159], v[44:47]
    s_add_u32 s24, s15, 516096
    buffer_load_dwordx4 a[72:75], v2, s[44:47], s24 offen offset:2048
    s_waitcnt vmcnt(21)
    v_mfma_f32_16x16x32_bf16 v[48:51], a[76:79], v[144:147], v[48:51]
    v_mfma_f32_16x16x32_bf16 v[52:55], a[76:79], v[148:151], v[52:55]
    v_mfma_f32_16x16x32_bf16 v[56:59], a[76:79], v[152:155], v[56:59]
    v_mfma_f32_16x16x32_bf16 v[60:63], a[76:79], v[156:159], v[60:63]
    buffer_load_dwordx4 a[76:79], v2, s[44:47], s24 offen offset:3072
    s_waitcnt vmcnt(21) lgkmcnt(3)
    v_mfma_f32_16x16x32_bf16 v[16:19], a[80:83], v[128:131], v[16:19]
    s_waitcnt lgkmcnt(2)
    v_mfma_f32_16x16x32_bf16 v[20:23], a[80:83], v[132:135], v[20:23]
    ds_read_b128 v[144:147], v6 offset:24576
    s_waitcnt lgkmcnt(2)
    v_mfma_f32_16x16x32_bf16 v[24:27], a[80:83], v[136:139], v[24:27]
    ds_read_b128 v[148:151], v6 offset:25600
    s_waitcnt lgkmcnt(2)
    v_mfma_f32_16x16x32_bf16 v[28:31], a[80:83], v[140:143], v[28:31]
    ds_read_b128 v[152:155], v6 offset:26624
    s_add_u32 s24, s15, 552960
    buffer_load_dwordx4 a[80:83], v2, s[44:47], s24 offen offset:2048
    s_waitcnt vmcnt(21)
    v_mfma_f32_16x16x32_bf16 v[32:35], a[84:87], v[128:131], v[32:35]
    ds_read_b128 v[156:159], v6 offset:27648
    v_mfma_f32_16x16x32_bf16 v[36:39], a[84:87], v[132:135], v[36:39]
    v_mfma_f32_16x16x32_bf16 v[40:43], a[84:87], v[136:139], v[40:43]
    v_mfma_f32_16x16x32_bf16 v[44:47], a[84:87], v[140:143], v[44:47]
    buffer_load_dwordx4 a[84:87], v2, s[44:47], s24 offen offset:3072
    s_waitcnt vmcnt(21)
    v_mfma_f32_16x16x32_bf16 v[48:51], a[0:3], v[128:131], v[48:51]
    v_mfma_f32_16x16x32_bf16 v[52:55], a[0:3], v[132:135], v[52:55]
    v_mfma_f32_16x16x32_bf16 v[56:59], a[0:3], v[136:139], v[56:59]
    v_mfma_f32_16x16x32_bf16 v[60:63], a[0:3], v[140:143], v[60:63]
    s_add_u32 s24, s15, 589824
    buffer_load_dwordx4 a[0:3], v2, s[44:47], s24 offen offset:2048
    s_waitcnt vmcnt(21) lgkmcnt(3)
    v_mfma_f32_16x16x32_bf16 v[16:19], a[4:7], v[144:147], v[16:19]
    s_waitcnt lgkmcnt(2)
    v_mfma_f32_16x16x32_bf16 v[20:23], a[4:7], v[148:151], v[20:23]
    ds_read_b128 v[128:131], v6 offset:28672
    s_waitcnt lgkmcnt(2)
    v_mfma_f32_16x16x32_bf16 v[24:27], a[4:7], v[152:155], v[24:27]
    ds_read_b128 v[132:135], v6 offset:29696
    s_waitcnt lgkmcnt(2)
    v_mfma_f32_16x16x32_bf16 v[28:31], a[4:7], v[156:159], v[28:31]
    ds_read_b128 v[136:139], v6 offset:30720
    buffer_load_dwordx4 a[4:7], v2, s[44:47], s24 offen offset:3072
    s_waitcnt vmcnt(21)
    v_mfma_f32_16x16x32_bf16 v[32:35], a[8:11], v[144:147], v[32:35]
    ds_read_b128 v[140:143], v6 offset:31744
    v_mfma_f32_16x16x32_bf16 v[36:39], a[8:11], v[148:151], v[36:39]
    v_mfma_f32_16x16x32_bf16 v[40:43], a[8:11], v[152:155], v[40:43]
    v_mfma_f32_16x16x32_bf16 v[44:47], a[8:11], v[156:159], v[44:47]
    s_add_u32 s24, s15, 626688
    buffer_load_dwordx4 a[8:11], v2, s[44:47], s24 offen offset:2048
    s_waitcnt vmcnt(21)
    v_mfma_f32_16x16x32_bf16 v[48:51], a[12:15], v[144:147], v[48:51]
    v_mfma_f32_16x16x32_bf16 v[52:55], a[12:15], v[148:151], v[52:55]
    v_mfma_f32_16x16x32_bf16 v[56:59], a[12:15], v[152:155], v[56:59]
    v_mfma_f32_16x16x32_bf16 v[60:63], a[12:15], v[156:159], v[60:63]
    buffer_load_dwordx4 a[12:15], v2, s[44:47], s24 offen offset:3072
    s_waitcnt vmcnt(21) lgkmcnt(3)
    v_mfma_f32_16x16x32_bf16 v[16:19], a[16:19], v[128:131], v[16:19]
    s_waitcnt lgkmcnt(2)
    v_mfma_f32_16x16x32_bf16 v[20:23], a[16:19], v[132:135], v[20:23]
    ds_read_b128 v[144:147], v6 offset:32768
    s_waitcnt lgkmcnt(2)
    v_mfma_f32_16x16x32_bf16 v[24:27], a[16:19], v[136:139], v[24:27]
    ds_read_b128 v[148:151], v6 offset:33792
    s_waitcnt lgkmcnt(2)
    v_mfma_f32_16x16x32_bf16 v[28:31], a[16:19], v[140:143], v[28:31]
    ds_read_b128 v[152:155], v6 offset:34816
    s_waitcnt vmcnt(20)
    v_mfma_f32_16x16x32_bf16 v[32:35], a[20:23], v[128:131], v[32:35]
    ds_read_b128 v[156:159], v6 offset:35840
    v_mfma_f32_16x16x32_bf16 v[36:39], a[20:23], v[132:135], v[36:39]
    v_mfma_f32_16x16x32_bf16 v[40:43], a[20:23], v[136:139], v[40:43]
    v_mfma_f32_16x16x32_bf16 v[44:47], a[20:23], v[140:143], v[44:47]
    s_waitcnt vmcnt(19)
    v_mfma_f32_16x16x32_bf16 v[48:51], a[24:27], v[128:131], v[48:51]
    v_mfma_f32_16x16x32_bf16 v[52:55], a[24:27], v[132:135], v[52:55]
    v_mfma_f32_16x16x32_bf16 v[56:59], a[24:27], v[136:139], v[56:59]
    v_mfma_f32_16x16x32_bf16 v[60:63], a[24:27], v[140:143], v[60:63]
    s_waitcnt vmcnt(18) lgkmcnt(3)
    v_mfma_f32_16x16x32_bf16 v[16:19], a[28:31], v[144:147], v[16:19]
    s_waitcnt lgkmcnt(2)
    v_mfma_f32_16x16x32_bf16 v[20:23], a[28:31], v[148:151], v[20:23]
    s_waitcnt lgkmcnt(1)
    v_mfma_f32_16x16x32_bf16 v[24:27], a[28:31], v[152:155], v[24:27]
    s_waitcnt lgkmcnt(0)
    v_mfma_f32_16x16x32_bf16 v[28:31], a[28:31], v[156:159], v[28:31]
    s_waitcnt vmcnt(17)
    v_mfma_f32_16x16x32_bf16 v[32:35], a[32:35], v[144:147], v[32:35]
    v_mfma_f32_16x16x32_bf16 v[36:39], a[32:35], v[148:151], v[36:39]
    v_mfma_f32_16x16x32_bf16 v[40:43], a[32:35], v[152:155], v[40:43]
    v_mfma_f32_16x16x32_bf16 v[44:47], a[32:35], v[156:159], v[44:47]
    s_waitcnt vmcnt(16)
    v_mfma_f32_16x16x32_bf16 v[48:51], a[36:39], v[144:147], v[48:51]
    v_mfma_f32_16x16x32_bf16 v[52:55], a[36:39], v[148:151], v[52:55]
    v_mfma_f32_16x16x32_bf16 v[56:59], a[36:39], v[152:155], v[56:59]
    v_mfma_f32_16x16x32_bf16 v[60:63], a[36:39], v[156:159], v[60:63]
    s_lshr_b32 s20, s3, 1
    s_lshl_b32 s20, s20, 12
    s_and_b32 s21, s3, 1
    s_lshl_b32 s22, s21, 3
    s_add_u32 s22, s22, s20
    v_add_u32 v9, s22, v3
    s_lshl_b32 s22, s21, 11
    s_add_u32 s22, s22, s20
    v_add_u32 v7, s22, v3
    v_cvt_pk_bf16_f32 v48, v48, v49
    v_cvt_pk_bf16_f32 v49, v50, v51
    ds_write_b64 v9, v[48:49] offset:0
    v_cvt_pk_bf16_f32 v52, v52, v53
    v_cvt_pk_bf16_f32 v53, v54, v55
    ds_write_b64 v9, v[52:53] offset:1024
    v_cvt_pk_bf16_f32 v56, v56, v57
    v_cvt_pk_bf16_f32 v57, v58, v59
    ds_write_b64 v9, v[56:57] offset:2048
    v_cvt_pk_bf16_f32 v60, v60, v61
    v_cvt_pk_bf16_f32 v61, v62, v63
    ds_write_b64 v9, v[60:61] offset:3072
    s_mul_i32 s22, s21, 36856
    s_add_u32 s29, s29, s22
    s_waitcnt lgkmcnt(0)
    s_barrier
    ds_read_b128 v[128:131], v6 offset:4096
    ds_read_b128 v[132:135], v6 offset:5120
    ds_read_b128 v[136:139], v6 offset:6144
    ds_read_b128 v[140:143], v6 offset:7168
    s_waitcnt vmcnt(15) lgkmcnt(3)
    v_mfma_f32_16x16x32_bf16 v[96:99], a[40:43], v[128:131], v[96:99]
    s_waitcnt lgkmcnt(2)
    v_mfma_f32_16x16x32_bf16 v[100:103], a[40:43], v[132:135], v[100:103]
    ds_read_b128 v[144:147], v6 offset:8192
    v_cvt_pk_bf16_f32 v160, v16, v17
    s_waitcnt lgkmcnt(2)
    v_mfma_f32_16x16x32_bf16 v[104:107], a[40:43], v[136:139], v[104:107]
    ds_read_b128 v[148:151], v6 offset:9216
    s_waitcnt lgkmcnt(2)
    v_mfma_f32_16x16x32_bf16 v[108:111], a[40:43], v[140:143], v[108:111]
    ds_read_b128 v[152:155], v6 offset:10240
    v_cvt_pk_bf16_f32 v161, v18, v19
    s_waitcnt vmcnt(14)
    v_mfma_f32_16x16x32_bf16 v[112:115], a[44:47], v[128:131], v[112:115]
    ds_read_b128 v[156:159], v6 offset:11264
    v_cvt_pk_bf16_f32 v162, v32, v33
    v_mfma_f32_16x16x32_bf16 v[116:119], a[44:47], v[132:135], v[116:119]
    v_mfma_f32_16x16x32_bf16 v[120:123], a[44:47], v[136:139], v[120:123]
    v_cvt_pk_bf16_f32 v163, v34, v35
    v_mfma_f32_16x16x32_bf16 v[124:127], a[44:47], v[140:143], v[124:127]
    s_add_u32 s30, s28, 0
    s_waitcnt vmcnt(13) lgkmcnt(3)
    v_mfma_f32_16x16x32_bf16 v[96:99], a[48:51], v[144:147], v[96:99]
    s_waitcnt lgkmcnt(2)
    v_mfma_f32_16x16x32_bf16 v[100:103], a[48:51], v[148:151], v[100:103]
    ds_read_b128 v[128:131], v6 offset:12288
    buffer_store_dwordx4 v[160:163], v3, s[44:47], s30 offen offset:0 sc1
    s_waitcnt lgkmcnt(2)
    v_mfma_f32_16x16x32_bf16 v[104:107], a[48:51], v[152:155], v[104:107]
    ds_read_b128 v[132:135], v6 offset:13312
    s_waitcnt lgkmcnt(2)
    v_mfma_f32_16x16x32_bf16 v[108:111], a[48:51], v[156:159], v[108:111]
    ds_read_b128 v[136:139], v6 offset:14336
    v_cvt_pk_bf16_f32 v164, v20, v21
    s_waitcnt vmcnt(13)
    v_mfma_f32_16x16x32_bf16 v[112:115], a[52:55], v[144:147], v[112:115]
    ds_read_b128 v[140:143], v6 offset:15360
    v_cvt_pk_bf16_f32 v165, v22, v23
    v_mfma_f32_16x16x32_bf16 v[116:119], a[52:55], v[148:151], v[116:119]
    v_mfma_f32_16x16x32_bf16 v[120:123], a[52:55], v[152:155], v[120:123]
    v_cvt_pk_bf16_f32 v166, v36, v37
    v_mfma_f32_16x16x32_bf16 v[124:127], a[52:55], v[156:159], v[124:127]
    v_cvt_pk_bf16_f32 v167, v38, v39
    s_waitcnt vmcnt(12) lgkmcnt(3)
    v_mfma_f32_16x16x32_bf16 v[96:99], a[56:59], v[128:131], v[96:99]
    s_waitcnt lgkmcnt(2)
    v_mfma_f32_16x16x32_bf16 v[100:103], a[56:59], v[132:135], v[100:103]
    ds_read_b128 v[144:147], v6 offset:16384
    s_add_u32 s30, s28, 18432
    s_waitcnt lgkmcnt(2)
    v_mfma_f32_16x16x32_bf16 v[104:107], a[56:59], v[136:139], v[104:107]
    ds_read_b128 v[148:151], v6 offset:17408
    s_waitcnt lgkmcnt(2)
    v_mfma_f32_16x16x32_bf16 v[108:111], a[56:59], v[140:143], v[108:111]
    ds_read_b128 v[152:155], v6 offset:18432
    buffer_store_dwordx4 v[164:167], v3, s[44:47], s30 offen offset:0 sc1
    s_waitcnt vmcnt(12)
    v_mfma_f32_16x16x32_bf16 v[112:115], a[60:63], v[128:131], v[112:115]
    ds_read_b128 v[156:159], v6 offset:19456
    v_cvt_pk_bf16_f32 v160, v24, v25
    v_mfma_f32_16x16x32_bf16 v[116:119], a[60:63], v[132:135], v[116:119]
    v_mfma_f32_16x16x32_bf16 v[120:123], a[60:63], v[136:139], v[120:123]
    v_cvt_pk_bf16_f32 v161, v26, v27
    v_mfma_f32_16x16x32_bf16 v[124:127], a[60:63], v[140:143], v[124:127]
    v_cvt_pk_bf16_f32 v162, v40, v41
    s_waitcnt vmcnt(11) lgkmcnt(3)
    v_mfma_f32_16x16x32_bf16 v[96:99], a[64:67], v[144:147], v[96:99]
    s_waitcnt lgkmcnt(2)
    v_mfma_f32_16x16x32_bf16 v[100:103], a[64:67], v[148:151], v[100:103]
    ds_read_b128 v[128:131], v6 offset:20480
    v_cvt_pk_bf16_f32 v163, v42, v43
    s_waitcnt lgkmcnt(2)
    v_mfma_f32_16x16x32_bf16 v[104:107], a[64:67], v[152:155], v[104:107]
    ds_read_b128 v[132:135], v6 offset:21504
    s_waitcnt lgkmcnt(2)
    v_mfma_f32_16x16x32_bf16 v[108:111], a[64:67], v[156:159], v[108:111]
    ds_read_b128 v[136:139], v6 offset:22528
    s_add_u32 s30, s28, 36864
    s_waitcnt vmcnt(10)
    v_mfma_f32_16x16x32_bf16 v[112:115], a[68:71], v[144:147], v[112:115]
    ds_read_b128 v[140:143], v6 offset:23552
    buffer_store_dwordx4 v[160:163], v3, s[44:47], s30 offen offset:0 sc1
    v_mfma_f32_16x16x32_bf16 v[116:119], a[68:71], v[148:151], v[116:119]
    v_mfma_f32_16x16x32_bf16 v[120:123], a[68:71], v[152:155], v[120:123]
    v_cvt_pk_bf16_f32 v164, v28, v29
    v_mfma_f32_16x16x32_bf16 v[124:127], a[68:71], v[156:159], v[124:127]
    v_cvt_pk_bf16_f32 v165, v30, v31
    s_waitcnt vmcnt(10) lgkmcnt(3)
    v_mfma_f32_16x16x32_bf16 v[96:99], a[72:75], v[128:131], v[96:99]
    s_waitcnt lgkmcnt(2)
    v_mfma_f32_16x16x32_bf16 v[100:103], a[72:75], v[132:135], v[100:103]
    ds_read_b128 v[144:147], v6 offset:24576
    v_cvt_pk_bf16_f32 v166, v44, v45
    s_waitcnt lgkmcnt(2)
    v_mfma_f32_16x16x32_bf16 v[104:107], a[72:75], v[136:139], v[104:107]
    ds_read_b128 v[148:151], v6 offset:25600
    s_waitcnt lgkmcnt(2)
    v_mfma_f32_16x16x32_bf16 v[108:111], a[72:75], v[140:143], v[108:111]
    ds_read_b128 v[152:155], v6 offset:26624
    v_cvt_pk_bf16_f32 v167, v46, v47
    s_waitcnt vmcnt(9)
    v_mfma_f32_16x16x32_bf16 v[112:115], a[76:79], v[128:131], v[112:115]
    ds_read_b128 v[156:159], v6 offset:27648
    s_add_u32 s30, s28, 55296
    v_mfma_f32_16x16x32_bf16 v[116:119], a[76:79], v[132:135], v[116:119]
    v_mfma_f32_16x16x32_bf16 v[120:123], a[76:79], v[136:139], v[120:123]
    buffer_store_dwordx4 v[164:167], v3, s[44:47], s30 offen offset:0 sc1
    v_mfma_f32_16x16x32_bf16 v[124:127], a[76:79], v[140:143], v[124:127]
    ds_read_b128 v[48:51], v7 offset:0
    s_waitcnt vmcnt(9) lgkmcnt(4)
    v_mfma_f32_16x16x32_bf16 v[96:99], a[80:83], v[144:147], v[96:99]
    s_waitcnt lgkmcnt(3)
    v_mfma_f32_16x16x32_bf16 v[100:103], a[80:83], v[148:151], v[100:103]
    ds_read_b128 v[128:131], v6 offset:28672
    ds_read_b128 v[52:55], v7 offset:1024
    s_waitcnt lgkmcnt(4)
    v_mfma_f32_16x16x32_bf16 v[104:107], a[80:83], v[152:155], v[104:107]
    ds_read_b128 v[132:135], v6 offset:29696
    s_waitcnt lgkmcnt(4)
    v_mfma_f32_16x16x32_bf16 v[108:111], a[80:83], v[156:159], v[108:111]
    ds_read_b128 v[136:139], v6 offset:30720
    s_add_u32 s30, s29, 0
    s_waitcnt vmcnt(8)
    v_mfma_f32_16x16x32_bf16 v[112:115], a[84:87], v[144:147], v[112:115]
    ds_read_b128 v[140:143], v6 offset:31744
    s_waitcnt lgkmcnt(5)
    buffer_store_dwordx4 v[48:51], v3, s[44:47], s30 offen sc1
    v_mfma_f32_16x16x32_bf16 v[116:119], a[84:87], v[148:151], v[116:119]
    v_mfma_f32_16x16x32_bf16 v[120:123], a[84:87], v[152:155], v[120:123]
    s_add_u32 s30, s29, 18432
    v_mfma_f32_16x16x32_bf16 v[124:127], a[84:87], v[156:159], v[124:127]
    s_waitcnt lgkmcnt(3)
    buffer_store_dwordx4 v[52:55], v3, s[44:47], s30 offen sc1
    s_waitcnt vmcnt(9)
    v_mfma_f32_16x16x32_bf16 v[96:99], a[0:3], v[128:131], v[96:99]
    s_waitcnt lgkmcnt(2)
    v_mfma_f32_16x16x32_bf16 v[100:103], a[0:3], v[132:135], v[100:103]
    ds_read_b128 v[144:147], v6 offset:32768
    s_waitcnt lgkmcnt(2)
    v_mfma_f32_16x16x32_bf16 v[104:107], a[0:3], v[136:139], v[104:107]
    ds_read_b128 v[148:151], v6 offset:33792
    s_waitcnt lgkmcnt(2)
    v_mfma_f32_16x16x32_bf16 v[108:111], a[0:3], v[140:143], v[108:111]
    ds_read_b128 v[152:155], v6 offset:34816
    s_waitcnt vmcnt(8)
    v_mfma_f32_16x16x32_bf16 v[112:115], a[4:7], v[128:131], v[112:115]
    ds_read_b128 v[156:159], v6 offset:35840
    v_mfma_f32_16x16x32_bf16 v[116:119], a[4:7], v[132:135], v[116:119]
    v_mfma_f32_16x16x32_bf16 v[120:123], a[4:7], v[136:139], v[120:123]
    v_mfma_f32_16x16x32_bf16 v[124:127], a[4:7], v[140:143], v[124:127]
    s_waitcnt vmcnt(7) lgkmcnt(3)
    v_mfma_f32_16x16x32_bf16 v[96:99], a[8:11], v[144:147], v[96:99]
    s_waitcnt lgkmcnt(2)
    v_mfma_f32_16x16x32_bf16 v[100:103], a[8:11], v[148:151], v[100:103]
    s_waitcnt lgkmcnt(1)
    v_mfma_f32_16x16x32_bf16 v[104:107], a[8:11], v[152:155], v[104:107]
    s_waitcnt lgkmcnt(0)
    v_mfma_f32_16x16x32_bf16 v[108:111], a[8:11], v[156:159], v[108:111]
    s_waitcnt vmcnt(6)
    v_mfma_f32_16x16x32_bf16 v[112:115], a[12:15], v[144:147], v[112:115]
    v_mfma_f32_16x16x32_bf16 v[116:119], a[12:15], v[148:151], v[116:119]
    v_mfma_f32_16x16x32_bf16 v[120:123], a[12:15], v[152:155], v[120:123]
    v_mfma_f32_16x16x32_bf16 v[124:127], a[12:15], v[156:159], v[124:127]
    v_cvt_pk_bf16_f32 v160, v96, v97
    v_cvt_pk_bf16_f32 v161, v98, v99
    s_nop 2
    v_cvt_pk_bf16_f32 v162, v112, v113
    v_cvt_pk_bf16_f32 v163, v114, v115
    s_add_u32 s30, s28, 0
    buffer_store_dwordx4 v[160:163], v3, s[44:47], s30 offen offset:1024 sc1
    v_cvt_pk_bf16_f32 v164, v100, v101
    v_cvt_pk_bf16_f32 v165, v102, v103
    v_cvt_pk_bf16_f32 v166, v116, v117
    v_cvt_pk_bf16_f32 v167, v118, v119
    s_add_u32 s30, s28, 18432
    buffer_store_dwordx4 v[164:167], v3, s[44:47], s30 offen offset:1024 sc1
    v_cvt_pk_bf16_f32 v160, v104, v105
    v_cvt_pk_bf16_f32 v161, v106, v107
    v_cvt_pk_bf16_f32 v162, v120, v121
    v_cvt_pk_bf16_f32 v163, v122, v123
    s_add_u32 s30, s28, 36864
    buffer_store_dwordx4 v[160:163], v3, s[44:47], s30 offen offset:1024 sc1
    v_cvt_pk_bf16_f32 v164, v108, v109
    v_cvt_pk_bf16_f32 v165, v110, v111
    v_cvt_pk_bf16_f32 v166, v124, v125
    v_cvt_pk_bf16_f32 v167, v126, v127
    s_add_u32 s30, s28, 55296
    buffer_store_dwordx4 v[164:167], v3, s[44:47], s30 offen offset:1024 sc1
    s_waitcnt vmcnt(0) lgkmcnt(0)
    s_barrier
    s_cmp_lg_u32 s3, 4
    s_cbranch_scc1 Lsig16
    s_mov_b64 exec, 1
    v_mov_b32 v1, 1
    v_mov_b32 v10, 0
    buffer_atomic_add v1, v10, s[44:47], s36 offen sc1
    s_mov_b64 exec, -1
Lsig16:
    s_branch sequential_preLN__ssm_conv_h3__mixer_s_mlp__prompt_kernel_d
sequential_preLN__ssm_conv_h3__mixer_s_mlp__prompt_kernel_cb:
    s_nop 4
    s_lshl_b32 s8, s4, 6
    s_mul_i32 s13, s5, 663552
    s_add_u32 s14, s13, 1327104
    s_add_u32 s15, s13, 6635520
    s_lshl_b32 s20, s3, 11
    s_add_u32 s20, s20, 4096
    v_add_u32 v4, s20, v3
    s_lshl_b32 s20, s3, 12
    s_add_u32 s20, s20, 4096
    v_add_u32 v2, s20, v3
    s_lshl_b32 s20, s3, 11
    s_add_u32 s20, s20, 20480
    v_add_u32 v13, s20, v3
    s_lshl_b32 s9, s3, 3
    v_lshrrev_b32 v5, 7, v3
    v_add_u32 v5, s9, v5
    v_and_b32 v6, 0x70, v3
    v_mul_u32_u24 v7, 1184, v5
    v_add_u32 v7, v7, v6
    v_and_b32 v5, 15, v5
    v_lshlrev_b32 v5, 4, v5
    v_lshl_add_u32 v5, v6, 4, v5
    s_lshr_b32 s12, s3, 1
    s_lshl_b32 s20, s4, 2
    s_add_u32 s12, s12, s20
    s_mul_i32 s12, s12, 18432
    s_add_u32 s12, s12, 16662528
    v_lshrrev_b32 v9, 7, v3
    v_add_u32 v9, s9, v9
    v_and_b32 v9, 31, v9
    v_lshlrev_b32 v9, 3, v9
    v_lshl_add_u32 v9, v6, 4, v9
    v_cmp_gt_u32 vcc, 64, v6
    v_mov_b32 v14, 0x7ff00000
    s_nop 0
    v_cndmask_b32 v14, v14, v9, vcc
    s_lshr_b32 s20, s3, 2
    s_lshl_b32 s21, s4, 1
    s_add_u32 s20, s20, s21
    s_mul_i32 s20, s20, 9216
    s_add_u32 s20, s20, 42483712
    s_cmp_lg_u32 s3, 4
    s_cbranch_scc1 Lw17_done
    v_mov_b32 v10, 0
    s_mov_b32 s35, 0
Lw17_0:
    buffer_load_dword v1, v10, s[44:47], s33 offen sc1
    s_add_u32 s35, s35, 1
    s_waitcnt vmcnt(0)
    v_readfirstlane_b32 s34, v1
    s_cmp_gt_u32 s35, 0x80000
    s_cbranch_scc1 Lw17_done
    s_cmp_lg_u32 s34, 8
    s_cbranch_scc1 Lw17_0
Lw17_done:
    s_barrier
    buffer_load_dwordx2 v[100:101], v9, s[44:47], s20 offen offset:0 sc1
    buffer_load_dwordx2 v[102:103], v9, s[44:47], s20 offen offset:2048 sc1
    s_add_u32 s20, s20, 4096
    buffer_load_dwordx2 v[104:105], v9, s[44:47], s20 offen offset:0 sc1
    buffer_load_dwordx2 v[106:107], v9, s[44:47], s20 offen offset:2048 sc1
    s_add_u32 s20, s20, 4096
    buffer_load_dwordx2 v[108:109], v14, s[44:47], s20 offen offset:0 sc1
    v_mov_b32 v125, v5
    buffer_load_dwordx4 v[64:67], v125, s[44:47], s12 offen offset:0 sc1
    buffer_load_dwordx4 v[68:71], v125, s[44:47], s12 offen offset:2048 sc1
    s_add_u32 s12, s12, 4096
    buffer_load_dwordx4 v[72:75], v125, s[44:47], s12 offen offset:0 sc1
    v_mov_b32 v1, v7
    v_mul_u32_u24 v14, 1184, v15
    v_lshl_add_u32 v14, v12, 4, v14
    v_add_u32 v5, 75776, v3
    v_add_u32 v6, 112640, v3
    s_lshl_b32 s20, s3, 12
    s_add_u32 s20, s20, 8192
    v_add_u32 v7, s20, v5
    s_lshl_b32 s20, s3, 12
    s_add_u32 s20, s20, 40960
    v_add_u32 v10, s20, v5
    s_mul_i32 s26, s5, 2359296
    s_add_u32 s26, s26, 21446656
    s_mul_i32 s27, s4, 73728
    s_add_u32 s26, s26, s27
    s_lshl_b32 s27, s3, 11
    s_add_u32 s28, s26, s27
    s_add_u32 s28, s28, 2048
    s_waitcnt vmcnt(6)
    v_add_f32 v100, v100, v102
    v_add_f32 v101, v101, v103
    s_waitcnt vmcnt(5)
    v_add_f32 v100, v100, v104
    v_add_f32 v101, v101, v105
    s_waitcnt vmcnt(4)
    v_add_f32 v100, v100, v106
    v_add_f32 v101, v101, v107
    s_waitcnt vmcnt(3)
    v_add_f32 v100, v100, v108
    v_add_f32 v101, v101, v109
    buffer_load_dwordx4 v[76:79], v125, s[44:47], s12 offen offset:2048 sc1
    s_add_u32 s12, s12, 4096
    buffer_load_dwordx4 v[80:83], v125, s[44:47], s12 offen offset:0 sc1
    buffer_load_dwordx4 v[84:87], v125, s[44:47], s12 offen offset:2048 sc1
    s_add_u32 s12, s12, 4096
    v_add_f32_dpp v100, v100, v100 quad_perm:[1,0,3,2] row_mask:0xf bank_mask:0xf
    v_add_f32_dpp v101, v101, v101 quad_perm:[1,0,3,2] row_mask:0xf bank_mask:0xf
    s_nop 0
    v_add_f32_dpp v100, v100, v100 quad_perm:[2,3,0,1] row_mask:0xf bank_mask:0xf
    v_add_f32_dpp v101, v101, v101 quad_perm:[2,3,0,1] row_mask:0xf bank_mask:0xf
    s_nop 0
    v_add_f32_dpp v100, v100, v100 row_half_mirror row_mask:0xf bank_mask:0xf
    v_add_f32_dpp v101, v101, v101 row_half_mirror row_mask:0xf bank_mask:0xf
    v_mul_f32 v102, s60, v100
    v_mul_f32 v101, s60, v101
    v_fma_f32 v101, -v102, v102, v101
    v_max_f32 v101, 0, v101
    v_add_f32 v101, s61, v101
    v_rsq_f32 v126, v101
    s_nop 0
    v_mul_f32 v127, v102, v126
    v_sub_f32 v127, 0, v127
    s_waitcnt vmcnt(5)
    v_lshlrev_b32 v110, 16, v64
    v_and_b32 v111, 0xffff0000, v64
    v_lshlrev_b32 v112, 16, v65
    v_and_b32 v113, 0xffff0000, v65
    v_lshlrev_b32 v114, 16, v66
    v_and_b32 v115, 0xffff0000, v66
    v_lshlrev_b32 v116, 16, v67
    v_and_b32 v117, 0xffff0000, v67
    v_fma_f32 v110, v110, v126, v127
    v_fma_f32 v111, v111, v126, v127
    v_fma_f32 v112, v112, v126, v127
    v_fma_f32 v113, v113, v126, v127
    v_fma_f32 v114, v114, v126, v127
    v_fma_f32 v115, v115, v126, v127
    v_fma_f32 v116, v116, v126, v127
    v_fma_f32 v117, v117, v126, v127
    v_cvt_pk_bf16_f32 v64, v110, v111
    v_cvt_pk_bf16_f32 v65, v112, v113
    v_cvt_pk_bf16_f32 v66, v114, v115
    v_cvt_pk_bf16_f32 v67, v116, v117
    ds_write_b128 v1, v[64:67] offset:0
    s_waitcnt vmcnt(4)
    v_lshlrev_b32 v110, 16, v68
    v_and_b32 v111, 0xffff0000, v68
    v_lshlrev_b32 v112, 16, v69
    v_and_b32 v113, 0xffff0000, v69
    v_lshlrev_b32 v114, 16, v70
    v_and_b32 v115, 0xffff0000, v70
    v_lshlrev_b32 v116, 16, v71
    v_and_b32 v117, 0xffff0000, v71
    v_fma_f32 v110, v110, v126, v127
    v_fma_f32 v111, v111, v126, v127
    v_fma_f32 v112, v112, v126, v127
    v_fma_f32 v113, v113, v126, v127
    v_fma_f32 v114, v114, v126, v127
    v_fma_f32 v115, v115, v126, v127
    v_fma_f32 v116, v116, v126, v127
    v_fma_f32 v117, v117, v126, v127
    v_cvt_pk_bf16_f32 v68, v110, v111
    v_cvt_pk_bf16_f32 v69, v112, v113
    v_cvt_pk_bf16_f32 v70, v114, v115
    v_cvt_pk_bf16_f32 v71, v116, v117
    ds_write_b128 v1, v[68:71] offset:128
    s_waitcnt vmcnt(3)
    v_lshlrev_b32 v110, 16, v72
    v_and_b32 v111, 0xffff0000, v72
    v_lshlrev_b32 v112, 16, v73
    v_and_b32 v113, 0xffff0000, v73
    v_lshlrev_b32 v114, 16, v74
    v_and_b32 v115, 0xffff0000, v74
    v_lshlrev_b32 v116, 16, v75
    v_and_b32 v117, 0xffff0000, v75
    v_fma_f32 v110, v110, v126, v127
    v_fma_f32 v111, v111, v126, v127
    v_fma_f32 v112, v112, v126, v127
    v_fma_f32 v113, v113, v126, v127
    v_fma_f32 v114, v114, v126, v127
    v_fma_f32 v115, v115, v126, v127
    v_fma_f32 v116, v116, v126, v127
    v_fma_f32 v117, v117, v126, v127
    v_cvt_pk_bf16_f32 v72, v110, v111
    v_cvt_pk_bf16_f32 v73, v112, v113
    v_cvt_pk_bf16_f32 v74, v114, v115
    v_cvt_pk_bf16_f32 v75, v116, v117
    ds_write_b128 v1, v[72:75] offset:256
    buffer_load_dwordx4 v[88:91], v125, s[44:47], s12 offen offset:0 sc1
    buffer_load_dwordx4 v[92:95], v125, s[44:47], s12 offen offset:2048 sc1
    s_add_u32 s12, s12, 4096
    buffer_load_dwordx4 v[96:99], v125, s[44:47], s12 offen offset:0 sc1
    s_waitcnt lgkmcnt(0)
    s_barrier
    ds_read_b128 v[128:131], v14 offset:0
    ds_read_b128 v[132:135], v14 offset:18944
    ds_read_b128 v[136:139], v14 offset:37888
    ds_read_b128 v[140:143], v14 offset:56832
    s_waitcnt lgkmcnt(3)
    v_mfma_f32_16x16x32_bf16 v[16:19], a[0:3], v[128:131], 0
    s_waitcnt vmcnt(5)
    v_lshlrev_b32 v110, 16, v76
    s_waitcnt lgkmcnt(2)
    v_mfma_f32_16x16x32_bf16 v[20:23], a[0:3], v[132:135], 0
    ds_read_b128 v[144:147], v14 offset:64
    v_and_b32 v111, 0xffff0000, v76
    v_lshlrev_b32 v112, 16, v77
    s_waitcnt lgkmcnt(2)
    v_mfma_f32_16x16x32_bf16 v[24:27], a[0:3], v[136:139], 0
    ds_read_b128 v[148:151], v14 offset:19008
    v_and_b32 v113, 0xffff0000, v77
    v_lshlrev_b32 v114, 16, v78
    s_waitcnt lgkmcnt(2)
    v_mfma_f32_16x16x32_bf16 v[28:31], a[0:3], v[140:143], 0
    ds_read_b128 v[152:155], v14 offset:37952
    v_and_b32 v115, 0xffff0000, v78
    v_lshlrev_b32 v116, 16, v79
    s_add_u32 s24, s14, 405504
    buffer_load_dwordx4 a[0:3], v4, s[44:47], s24 offen offset:0
    v_mfma_f32_16x16x32_bf16 v[32:35], a[4:7], v[128:131], 0
    ds_read_b128 v[156:159], v14 offset:56896
    v_and_b32 v117, 0xffff0000, v79
    v_mfma_f32_16x16x32_bf16 v[36:39], a[4:7], v[132:135], 0
    v_fma_f32 v110, v110, v126, v127
    v_fma_f32 v111, v111, v126, v127
    v_mfma_f32_16x16x32_bf16 v[40:43], a[4:7], v[136:139], 0
    v_fma_f32 v112, v112, v126, v127
    v_fma_f32 v113, v113, v126, v127
    v_mfma_f32_16x16x32_bf16 v[44:47], a[4:7], v[140:143], 0
    v_fma_f32 v114, v114, v126, v127
    v_fma_f32 v115, v115, v126, v127
    buffer_load_dwordx4 a[4:7], v4, s[44:47], s24 offen offset:1024
    s_waitcnt lgkmcnt(3)
    v_mfma_f32_16x16x32_bf16 v[16:19], a[8:11], v[144:147], v[16:19]
    v_fma_f32 v116, v116, v126, v127
    s_waitcnt lgkmcnt(2)
    v_mfma_f32_16x16x32_bf16 v[20:23], a[8:11], v[148:151], v[20:23]
    ds_read_b128 v[128:131], v14 offset:128
    v_fma_f32 v117, v117, v126, v127
    v_cvt_pk_bf16_f32 v76, v110, v111
    s_waitcnt lgkmcnt(2)
    v_mfma_f32_16x16x32_bf16 v[24:27], a[8:11], v[152:155], v[24:27]
    ds_read_b128 v[132:135], v14 offset:19072
    v_cvt_pk_bf16_f32 v77, v112, v113
    v_cvt_pk_bf16_f32 v78, v114, v115
    s_waitcnt lgkmcnt(2)
    v_mfma_f32_16x16x32_bf16 v[28:31], a[8:11], v[156:159], v[28:31]
    ds_read_b128 v[136:139], v14 offset:38016
    v_cvt_pk_bf16_f32 v79, v116, v117
    ds_write_b128 v1, v[76:79] offset:384
    s_add_u32 s24, s14, 442368
    buffer_load_dwordx4 a[8:11], v4, s[44:47], s24 offen offset:0
    v_mfma_f32_16x16x32_bf16 v[32:35], a[12:15], v[144:147], v[32:35]
    ds_read_b128 v[140:143], v14 offset:56960
    s_waitcnt vmcnt(7)
    v_lshlrev_b32 v110, 16, v80
    v_mfma_f32_16x16x32_bf16 v[36:39], a[12:15], v[148:151], v[36:39]
    v_and_b32 v111, 0xffff0000, v80
    v_lshlrev_b32 v112, 16, v81
    v_mfma_f32_16x16x32_bf16 v[40:43], a[12:15], v[152:155], v[40:43]
    v_and_b32 v113, 0xffff0000, v81
    v_lshlrev_b32 v114, 16, v82
    v_mfma_f32_16x16x32_bf16 v[44:47], a[12:15], v[156:159], v[44:47]
    v_and_b32 v115, 0xffff0000, v82
    v_lshlrev_b32 v116, 16, v83
    buffer_load_dwordx4 a[12:15], v4, s[44:47], s24 offen offset:1024
    s_waitcnt lgkmcnt(4)
    v_mfma_f32_16x16x32_bf16 v[16:19], a[16:19], v[128:131], v[16:19]
    v_and_b32 v117, 0xffff0000, v83
    s_waitcnt lgkmcnt(3)
    v_mfma_f32_16x16x32_bf16 v[20:23], a[16:19], v[132:135], v[20:23]
    ds_read_b128 v[144:147], v14 offset:192
    v_fma_f32 v110, v110, v126, v127
    v_fma_f32 v111, v111, v126, v127
    s_waitcnt lgkmcnt(3)
    v_mfma_f32_16x16x32_bf16 v[24:27], a[16:19], v[136:139], v[24:27]
    ds_read_b128 v[148:151], v14 offset:19136
    v_fma_f32 v112, v112, v126, v127
    v_fma_f32 v113, v113, v126, v127
    s_waitcnt lgkmcnt(2)
    v_mfma_f32_16x16x32_bf16 v[28:31], a[16:19], v[140:143], v[28:31]
    ds_read_b128 v[152:155], v14 offset:38080
    v_fma_f32 v114, v114, v126, v127
    v_fma_f32 v115, v115, v126, v127
    s_add_u32 s24, s14, 479232
    buffer_load_dwordx4 a[16:19], v4, s[44:47], s24 offen offset:0
    v_mfma_f32_16x16x32_bf16 v[32:35], a[20:23], v[128:131], v[32:35]
    ds_read_b128 v[156:159], v14 offset:57024
    v_fma_f32 v116, v116, v126, v127
    v_mfma_f32_16x16x32_bf16 v[36:39], a[20:23], v[132:135], v[36:39]
    v_fma_f32 v117, v117, v126, v127
    v_cvt_pk_bf16_f32 v80, v110, v111
    v_mfma_f32_16x16x32_bf16 v[40:43], a[20:23], v[136:139], v[40:43]
    v_cvt_pk_bf16_f32 v81, v112, v113
    v_cvt_pk_bf16_f32 v82, v114, v115
    v_mfma_f32_16x16x32_bf16 v[44:47], a[20:23], v[140:143], v[44:47]
    v_cvt_pk_bf16_f32 v83, v116, v117
    ds_write_b128 v1, v[80:83] offset:512
    buffer_load_dwordx4 a[20:23], v4, s[44:47], s24 offen offset:1024
    s_waitcnt lgkmcnt(4)
    v_mfma_f32_16x16x32_bf16 v[16:19], a[24:27], v[144:147], v[16:19]
    s_waitcnt vmcnt(9)
    v_lshlrev_b32 v110, 16, v84
    s_waitcnt lgkmcnt(3)
    v_mfma_f32_16x16x32_bf16 v[20:23], a[24:27], v[148:151], v[20:23]
    ds_read_b128 v[128:131], v14 offset:256
    v_and_b32 v111, 0xffff0000, v84
    v_lshlrev_b32 v112, 16, v85
    s_waitcnt lgkmcnt(3)
    v_mfma_f32_16x16x32_bf16 v[24:27], a[24:27], v[152:155], v[24:27]
    ds_read_b128 v[132:135], v14 offset:19200
    v_and_b32 v113, 0xffff0000, v85
    v_lshlrev_b32 v114, 16, v86
    s_waitcnt lgkmcnt(3)
    v_mfma_f32_16x16x32_bf16 v[28:31], a[24:27], v[156:159], v[28:31]
    ds_read_b128 v[136:139], v14 offset:38144
    v_and_b32 v115, 0xffff0000, v86
    v_lshlrev_b32 v116, 16, v87
    s_add_u32 s24, s14, 516096
    buffer_load_dwordx4 a[24:27], v4, s[44:47], s24 offen offset:0
    v_mfma_f32_16x16x32_bf16 v[32:35], a[28:31], v[144:147], v[32:35]
    ds_read_b128 v[140:143], v14 offset:57088
    v_and_b32 v117, 0xffff0000, v87
    v_mfma_f32_16x16x32_bf16 v[36:39], a[28:31], v[148:151], v[36:39]
    v_fma_f32 v110, v110, v126, v127
    v_fma_f32 v111, v111, v126, v127
    v_mfma_f32_16x16x32_bf16 v[40:43], a[28:31], v[152:155], v[40:43]
    v_fma_f32 v112, v112, v126, v127
    v_fma_f32 v113, v113, v126, v127
    v_mfma_f32_16x16x32_bf16 v[44:47], a[28:31], v[156:159], v[44:47]
    v_fma_f32 v114, v114, v126, v127
    v_fma_f32 v115, v115, v126, v127
    buffer_load_dwordx4 a[28:31], v4, s[44:47], s24 offen offset:1024
    s_waitcnt lgkmcnt(3)
    v_mfma_f32_16x16x32_bf16 v[16:19], a[32:35], v[128:131], v[16:19]
    v_fma_f32 v116, v116, v126, v127
    s_waitcnt lgkmcnt(2)
    v_mfma_f32_16x16x32_bf16 v[20:23], a[32:35], v[132:135], v[20:23]
    ds_read_b128 v[144:147], v14 offset:320
    v_fma_f32 v117, v117, v126, v127
    v_cvt_pk_bf16_f32 v84, v110, v111
    s_waitcnt lgkmcnt(2)
    v_mfma_f32_16x16x32_bf16 v[24:27], a[32:35], v[136:139], v[24:27]
    ds_read_b128 v[148:151], v14 offset:19264
    v_cvt_pk_bf16_f32 v85, v112, v113
    v_cvt_pk_bf16_f32 v86, v114, v115
    s_waitcnt lgkmcnt(2)
    v_mfma_f32_16x16x32_bf16 v[28:31], a[32:35], v[140:143], v[28:31]
    ds_read_b128 v[152:155], v14 offset:38208
    v_cvt_pk_bf16_f32 v87, v116, v117
    ds_write_b128 v1, v[84:87] offset:640
    s_add_u32 s24, s14, 552960
    buffer_load_dwordx4 a[32:35], v4, s[44:47], s24 offen offset:0
    v_mfma_f32_16x16x32_bf16 v[32:35], a[36:39], v[128:131], v[32:35]
    ds_read_b128 v[156:159], v14 offset:57152
    v_mfma_f32_16x16x32_bf16 v[36:39], a[36:39], v[132:135], v[36:39]
    v_mfma_f32_16x16x32_bf16 v[40:43], a[36:39], v[136:139], v[40:43]
    v_mfma_f32_16x16x32_bf16 v[44:47], a[36:39], v[140:143], v[44:47]
    buffer_load_dwordx4 a[36:39], v4, s[44:47], s24 offen offset:1024
    s_waitcnt lgkmcnt(4)
    v_mfma_f32_16x16x32_bf16 v[16:19], a[40:43], v[144:147], v[16:19]
    s_waitcnt lgkmcnt(3)
    v_mfma_f32_16x16x32_bf16 v[20:23], a[40:43], v[148:151], v[20:23]
    s_waitcnt lgkmcnt(2)
    v_mfma_f32_16x16x32_bf16 v[24:27], a[40:43], v[152:155], v[24:27]
    s_waitcnt lgkmcnt(0)
    v_mfma_f32_16x16x32_bf16 v[28:31], a[40:43], v[156:159], v[28:31]
    s_add_u32 s24, s14, 589824
    buffer_load_dwordx4 a[40:43], v4, s[44:47], s24 offen offset:0
    v_mfma_f32_16x16x32_bf16 v[32:35], a[44:47], v[144:147], v[32:35]
    v_mfma_f32_16x16x32_bf16 v[36:39], a[44:47], v[148:151], v[36:39]
    v_mfma_f32_16x16x32_bf16 v[40:43], a[44:47], v[152:155], v[40:43]
    v_mfma_f32_16x16x32_bf16 v[44:47], a[44:47], v[156:159], v[44:47]
    buffer_load_dwordx4 a[44:47], v4, s[44:47], s24 offen offset:1024
    s_waitcnt lgkmcnt(0)
    s_barrier
    ds_read_b128 v[128:131], v14 offset:384
    ds_read_b128 v[132:135], v14 offset:19328
    ds_read_b128 v[136:139], v14 offset:38272
    ds_read_b128 v[140:143], v14 offset:57216
    s_waitcnt lgkmcnt(3)
    v_mfma_f32_16x16x32_bf16 v[16:19], a[48:51], v[128:131], v[16:19]
    s_waitcnt vmcnt(14)
    v_lshlrev_b32 v110, 16, v88
    s_waitcnt lgkmcnt(2)
    v_mfma_f32_16x16x32_bf16 v[20:23], a[48:51], v[132:135], v[20:23]
    ds_read_b128 v[144:147], v14 offset:448
    v_and_b32 v111, 0xffff0000, v88
    v_lshlrev_b32 v112, 16, v89
    s_waitcnt lgkmcnt(2)
    v_mfma_f32_16x16x32_bf16 v[24:27], a[48:51], v[136:139], v[24:27]
    ds_read_b128 v[148:151], v14 offset:19392
    v_and_b32 v113, 0xffff0000, v89
    v_lshlrev_b32 v114, 16, v90
    s_waitcnt lgkmcnt(2)
    v_mfma_f32_16x16x32_bf16 v[28:31], a[48:51], v[140:143], v[28:31]
    ds_read_b128 v[152:155], v14 offset:38336
    v_and_b32 v115, 0xffff0000, v90
    v_lshlrev_b32 v116, 16, v91
    s_add_u32 s24, s14, 626688
    buffer_load_dwordx4 a[48:51], v4, s[44:47], s24 offen offset:0
    v_mfma_f32_16x16x32_bf16 v[32:35], a[52:55], v[128:131], v[32:35]
    ds_read_b128 v[156:159], v14 offset:57280
    v_and_b32 v117, 0xffff0000, v91
    v_mfma_f32_16x16x32_bf16 v[36:39], a[52:55], v[132:135], v[36:39]
    v_fma_f32 v110, v110, v126, v127
    v_fma_f32 v111, v111, v126, v127
    v_mfma_f32_16x16x32_bf16 v[40:43], a[52:55], v[136:139], v[40:43]
    v_fma_f32 v112, v112, v126, v127
    v_fma_f32 v113, v113, v126, v127
    v_mfma_f32_16x16x32_bf16 v[44:47], a[52:55], v[140:143], v[44:47]
    v_fma_f32 v114, v114, v126, v127
    v_fma_f32 v115, v115, v126, v127
    buffer_load_dwordx4 a[52:55], v4, s[44:47], s24 offen offset:1024
    s_waitcnt lgkmcnt(3)
    v_mfma_f32_16x16x32_bf16 v[16:19], a[56:59], v[144:147], v[16:19]
    v_fma_f32 v116, v116, v126, v127
    s_waitcnt lgkmcnt(2)
    v_mfma_f32_16x16x32_bf16 v[20:23], a[56:59], v[148:151], v[20:23]
    ds_read_b128 v[128:131], v14 offset:512
    v_fma_f32 v117, v117, v126, v127
    v_cvt_pk_bf16_f32 v88, v110, v111
    s_waitcnt lgkmcnt(2)
    v_mfma_f32_16x16x32_bf16 v[24:27], a[56:59], v[152:155], v[24:27]
    ds_read_b128 v[132:135], v14 offset:19456
    v_cvt_pk_bf16_f32 v89, v112, v113
    v_cvt_pk_bf16_f32 v90, v114, v115
    s_waitcnt lgkmcnt(2)
    v_mfma_f32_16x16x32_bf16 v[28:31], a[56:59], v[156:159], v[28:31]
    ds_read_b128 v[136:139], v14 offset:38400
    v_cvt_pk_bf16_f32 v91, v116, v117
    ds_write_b128 v1, v[88:91] offset:768
    s_add_u32 s24, s14, 0
    buffer_load_dwordx4 a[56:59], v13, s[44:47], s24 offen offset:0
    v_mfma_f32_16x16x32_bf16 v[32:35], a[60:63], v[144:147], v[32:35]
    ds_read_b128 v[140:143], v14 offset:57344
    s_waitcnt vmcnt(16)
    v_lshlrev_b32 v110, 16, v92
    v_mfma_f32_16x16x32_bf16 v[36:39], a[60:63], v[148:151], v[36:39]
    v_and_b32 v111, 0xffff0000, v92
    v_lshlrev_b32 v112, 16, v93
    v_mfma_f32_16x16x32_bf16 v[40:43], a[60:63], v[152:155], v[40:43]
    v_and_b32 v113, 0xffff0000, v93
    v_lshlrev_b32 v114, 16, v94
    v_mfma_f32_16x16x32_bf16 v[44:47], a[60:63], v[156:159], v[44:47]
    v_and_b32 v115, 0xffff0000, v94
    v_lshlrev_b32 v116, 16, v95
    buffer_load_dwordx4 a[60:63], v13, s[44:47], s24 offen offset:1024
    s_waitcnt lgkmcnt(4)
    v_mfma_f32_16x16x32_bf16 v[16:19], a[64:67], v[128:131], v[16:19]
    v_and_b32 v117, 0xffff0000, v95
    s_waitcnt lgkmcnt(3)
    v_mfma_f32_16x16x32_bf16 v[20:23], a[64:67], v[132:135], v[20:23]
    ds_read_b128 v[144:147], v14 offset:576
    v_fma_f32 v110, v110, v126, v127
    v_fma_f32 v111, v111, v126, v127
    s_waitcnt lgkmcnt(3)
    v_mfma_f32_16x16x32_bf16 v[24:27], a[64:67], v[136:139], v[24:27]
    ds_read_b128 v[148:151], v14 offset:19520
    v_fma_f32 v112, v112, v126, v127
    v_fma_f32 v113, v113, v126, v127
    s_waitcnt lgkmcnt(2)
    v_mfma_f32_16x16x32_bf16 v[28:31], a[64:67], v[140:143], v[28:31]
    ds_read_b128 v[152:155], v14 offset:38464
    v_fma_f32 v114, v114, v126, v127
    v_fma_f32 v115, v115, v126, v127
    s_add_u32 s24, s14, 36864
    buffer_load_dwordx4 a[64:67], v13, s[44:47], s24 offen offset:0
    v_mfma_f32_16x16x32_bf16 v[32:35], a[68:71], v[128:131], v[32:35]
    ds_read_b128 v[156:159], v14 offset:57408
    v_fma_f32 v116, v116, v126, v127
    v_mfma_f32_16x16x32_bf16 v[36:39], a[68:71], v[132:135], v[36:39]
    v_fma_f32 v117, v117, v126, v127
    v_cvt_pk_bf16_f32 v92, v110, v111
    v_mfma_f32_16x16x32_bf16 v[40:43], a[68:71], v[136:139], v[40:43]
    v_cvt_pk_bf16_f32 v93, v112, v113
    v_cvt_pk_bf16_f32 v94, v114, v115
    v_mfma_f32_16x16x32_bf16 v[44:47], a[68:71], v[140:143], v[44:47]
    v_cvt_pk_bf16_f32 v95, v116, v117
    ds_write_b128 v1, v[92:95] offset:896
    buffer_load_dwordx4 a[68:71], v13, s[44:47], s24 offen offset:1024
    s_waitcnt lgkmcnt(4)
    v_mfma_f32_16x16x32_bf16 v[16:19], a[72:75], v[144:147], v[16:19]
    s_waitcnt vmcnt(18)
    v_lshlrev_b32 v110, 16, v96
    s_waitcnt lgkmcnt(3)
    v_mfma_f32_16x16x32_bf16 v[20:23], a[72:75], v[148:151], v[20:23]
    ds_read_b128 v[128:131], v14 offset:640
    v_and_b32 v111, 0xffff0000, v96
    v_lshlrev_b32 v112, 16, v97
    s_waitcnt lgkmcnt(3)
    v_mfma_f32_16x16x32_bf16 v[24:27], a[72:75], v[152:155], v[24:27]
    ds_read_b128 v[132:135], v14 offset:19584
    v_and_b32 v113, 0xffff0000, v97
    v_lshlrev_b32 v114, 16, v98
    s_waitcnt lgkmcnt(3)
    v_mfma_f32_16x16x32_bf16 v[28:31], a[72:75], v[156:159], v[28:31]
    ds_read_b128 v[136:139], v14 offset:38528
    v_and_b32 v115, 0xffff0000, v98
    v_lshlrev_b32 v116, 16, v99
    s_add_u32 s24, s14, 73728
    buffer_load_dwordx4 a[72:75], v13, s[44:47], s24 offen offset:0
    v_mfma_f32_16x16x32_bf16 v[32:35], a[76:79], v[144:147], v[32:35]
    ds_read_b128 v[140:143], v14 offset:57472
    v_and_b32 v117, 0xffff0000, v99
    v_mfma_f32_16x16x32_bf16 v[36:39], a[76:79], v[148:151], v[36:39]
    v_fma_f32 v110, v110, v126, v127
    v_fma_f32 v111, v111, v126, v127
    v_mfma_f32_16x16x32_bf16 v[40:43], a[76:79], v[152:155], v[40:43]
    v_fma_f32 v112, v112, v126, v127
    v_fma_f32 v113, v113, v126, v127
    v_mfma_f32_16x16x32_bf16 v[44:47], a[76:79], v[156:159], v[44:47]
    v_fma_f32 v114, v114, v126, v127
    v_fma_f32 v115, v115, v126, v127
    buffer_load_dwordx4 a[76:79], v13, s[44:47], s24 offen offset:1024
    s_waitcnt lgkmcnt(3)
    v_mfma_f32_16x16x32_bf16 v[16:19], a[80:83], v[128:131], v[16:19]
    v_fma_f32 v116, v116, v126, v127
    s_waitcnt lgkmcnt(2)
    v_mfma_f32_16x16x32_bf16 v[20:23], a[80:83], v[132:135], v[20:23]
    ds_read_b128 v[144:147], v14 offset:704
    v_fma_f32 v117, v117, v126, v127
    v_cvt_pk_bf16_f32 v96, v110, v111
    s_waitcnt lgkmcnt(2)
    v_mfma_f32_16x16x32_bf16 v[24:27], a[80:83], v[136:139], v[24:27]
    ds_read_b128 v[148:151], v14 offset:19648
    v_cvt_pk_bf16_f32 v97, v112, v113
    v_cvt_pk_bf16_f32 v98, v114, v115
    s_waitcnt lgkmcnt(2)
    v_mfma_f32_16x16x32_bf16 v[28:31], a[80:83], v[140:143], v[28:31]
    ds_read_b128 v[152:155], v14 offset:38592
    v_cvt_pk_bf16_f32 v99, v116, v117
    ds_write_b128 v1, v[96:99] offset:1024
    s_add_u32 s24, s14, 110592
    buffer_load_dwordx4 a[80:83], v13, s[44:47], s24 offen offset:0
    v_mfma_f32_16x16x32_bf16 v[32:35], a[84:87], v[128:131], v[32:35]
    ds_read_b128 v[156:159], v14 offset:57536
    v_mfma_f32_16x16x32_bf16 v[36:39], a[84:87], v[132:135], v[36:39]
    v_mfma_f32_16x16x32_bf16 v[40:43], a[84:87], v[136:139], v[40:43]
    v_mfma_f32_16x16x32_bf16 v[44:47], a[84:87], v[140:143], v[44:47]
    buffer_load_dwordx4 a[84:87], v13, s[44:47], s24 offen offset:1024
    s_waitcnt vmcnt(21) lgkmcnt(4)
    v_mfma_f32_16x16x32_bf16 v[16:19], a[0:3], v[144:147], v[16:19]
    s_waitcnt lgkmcnt(3)
    v_mfma_f32_16x16x32_bf16 v[20:23], a[0:3], v[148:151], v[20:23]
    s_waitcnt lgkmcnt(2)
    v_mfma_f32_16x16x32_bf16 v[24:27], a[0:3], v[152:155], v[24:27]
    s_waitcnt lgkmcnt(0)
    v_mfma_f32_16x16x32_bf16 v[28:31], a[0:3], v[156:159], v[28:31]
    s_add_u32 s24, s14, 147456
    buffer_load_dwordx4 a[0:3], v13, s[44:47], s24 offen offset:0
    s_waitcnt vmcnt(21)
    v_mfma_f32_16x16x32_bf16 v[32:35], a[4:7], v[144:147], v[32:35]
    v_mfma_f32_16x16x32_bf16 v[36:39], a[4:7], v[148:151], v[36:39]
    v_mfma_f32_16x16x32_bf16 v[40:43], a[4:7], v[152:155], v[40:43]
    v_mfma_f32_16x16x32_bf16 v[44:47], a[4:7], v[156:159], v[44:47]
    buffer_load_dwordx4 a[4:7], v13, s[44:47], s24 offen offset:1024
    s_waitcnt lgkmcnt(0)
    s_barrier
    ds_read_b128 v[128:131], v14 offset:768
    ds_read_b128 v[132:135], v14 offset:19712
    ds_read_b128 v[136:139], v14 offset:38656
    ds_read_b128 v[140:143], v14 offset:57600
    s_waitcnt vmcnt(21) lgkmcnt(3)
    v_mfma_f32_16x16x32_bf16 v[16:19], a[8:11], v[128:131], v[16:19]
    s_waitcnt lgkmcnt(2)
    v_mfma_f32_16x16x32_bf16 v[20:23], a[8:11], v[132:135], v[20:23]
    ds_read_b128 v[144:147], v14 offset:832
    s_waitcnt lgkmcnt(2)
    v_mfma_f32_16x16x32_bf16 v[24:27], a[8:11], v[136:139], v[24:27]
    ds_read_b128 v[148:151], v14 offset:19776
    s_waitcnt lgkmcnt(2)
    v_mfma_f32_16x16x32_bf16 v[28:31], a[8:11], v[140:143], v[28:31]
    ds_read_b128 v[152:155], v14 offset:38720
    s_add_u32 s24, s14, 184320
    buffer_load_dwordx4 a[8:11], v13, s[44:47], s24 offen offset:0
    s_waitcnt vmcnt(21)
    v_mfma_f32_16x16x32_bf16 v[32:35], a[12:15], v[128:131], v[32:35]
    ds_read_b128 v[156:159], v14 offset:57664
    v_mfma_f32_16x16x32_bf16 v[36:39], a[12:15], v[132:135], v[36:39]
    v_mfma_f32_16x16x32_bf16 v[40:43], a[12:15], v[136:139], v[40:43]
    v_mfma_f32_16x16x32_bf16 v[44:47], a[12:15], v[140:143], v[44:47]
    buffer_load_dwordx4 a[12:15], v13, s[44:47], s24 offen offset:1024
    s_waitcnt vmcnt(21) lgkmcnt(3)
    v_mfma_f32_16x16x32_bf16 v[16:19], a[16:19], v[144:147], v[16:19]
    s_waitcnt lgkmcnt(2)
    v_mfma_f32_16x16x32_bf16 v[20:23], a[16:19], v[148:151], v[20:23]
    ds_read_b128 v[128:131], v14 offset:896
    s_waitcnt lgkmcnt(2)
    v_mfma_f32_16x16x32_bf16 v[24:27], a[16:19], v[152:155], v[24:27]
    ds_read_b128 v[132:135], v14 offset:19840
    s_waitcnt lgkmcnt(2)
    v_mfma_f32_16x16x32_bf16 v[28:31], a[16:19], v[156:159], v[28:31]
    ds_read_b128 v[136:139], v14 offset:38784
    s_add_u32 s24, s14, 221184
    buffer_load_dwordx4 a[16:19], v13, s[44:47], s24 offen offset:0
    s_waitcnt vmcnt(21)
    v_mfma_f32_16x16x32_bf16 v[32:35], a[20:23], v[144:147], v[32:35]
    ds_read_b128 v[140:143], v14 offset:57728
    v_mfma_f32_16x16x32_bf16 v[36:39], a[20:23], v[148:151], v[36:39]
    v_mfma_f32_16x16x32_bf16 v[40:43], a[20:23], v[152:155], v[40:43]
    v_mfma_f32_16x16x32_bf16 v[44:47], a[20:23], v[156:159], v[44:47]
    buffer_load_dwordx4 a[20:23], v13, s[44:47], s24 offen offset:1024
    s_waitcnt vmcnt(21) lgkmcnt(3)
    v_mfma_f32_16x16x32_bf16 v[16:19], a[24:27], v[128:131], v[16:19]
    s_waitcnt lgkmcnt(2)
    v_mfma_f32_16x16x32_bf16 v[20:23], a[24:27], v[132:135], v[20:23]
    ds_read_b128 v[144:147], v14 offset:960
    s_waitcnt lgkmcnt(2)
    v_mfma_f32_16x16x32_bf16 v[24:27], a[24:27], v[136:139], v[24:27]
    ds_read_b128 v[148:151], v14 offset:19904
    s_waitcnt lgkmcnt(2)
    v_mfma_f32_16x16x32_bf16 v[28:31], a[24:27], v[140:143], v[28:31]
    ds_read_b128 v[152:155], v14 offset:38848
    s_add_u32 s24, s14, 258048
    buffer_load_dwordx4 a[24:27], v13, s[44:47], s24 offen offset:0
    s_waitcnt vmcnt(21)
    v_mfma_f32_16x16x32_bf16 v[32:35], a[28:31], v[128:131], v[32:35]
    ds_read_b128 v[156:159], v14 offset:57792
    v_mfma_f32_16x16x32_bf16 v[36:39], a[28:31], v[132:135], v[36:39]
    v_mfma_f32_16x16x32_bf16 v[40:43], a[28:31], v[136:139], v[40:43]
    v_mfma_f32_16x16x32_bf16 v[44:47], a[28:31], v[140:143], v[44:47]
    buffer_load_dwordx4 a[28:31], v13, s[44:47], s24 offen offset:1024
    s_waitcnt vmcnt(21) lgkmcnt(3)
    v_mfma_f32_16x16x32_bf16 v[16:19], a[32:35], v[144:147], v[16:19]
    s_waitcnt lgkmcnt(2)
    v_mfma_f32_16x16x32_bf16 v[20:23], a[32:35], v[148:151], v[20:23]
    ds_read_b128 v[128:131], v14 offset:1024
    s_waitcnt lgkmcnt(2)
    v_mfma_f32_16x16x32_bf16 v[24:27], a[32:35], v[152:155], v[24:27]
    ds_read_b128 v[132:135], v14 offset:19968
    s_waitcnt lgkmcnt(2)
    v_mfma_f32_16x16x32_bf16 v[28:31], a[32:35], v[156:159], v[28:31]
    ds_read_b128 v[136:139], v14 offset:38912
    s_add_u32 s24, s14, 294912
    buffer_load_dwordx4 a[32:35], v13, s[44:47], s24 offen offset:0
    s_waitcnt vmcnt(21)
    v_mfma_f32_16x16x32_bf16 v[32:35], a[36:39], v[144:147], v[32:35]
    ds_read_b128 v[140:143], v14 offset:57856
    v_mfma_f32_16x16x32_bf16 v[36:39], a[36:39], v[148:151], v[36:39]
    v_mfma_f32_16x16x32_bf16 v[40:43], a[36:39], v[152:155], v[40:43]
    v_mfma_f32_16x16x32_bf16 v[44:47], a[36:39], v[156:159], v[44:47]
    buffer_load_dwordx4 a[36:39], v13, s[44:47], s24 offen offset:1024
    s_waitcnt vmcnt(21) lgkmcnt(3)
    v_mfma_f32_16x16x32_bf16 v[16:19], a[40:43], v[128:131], v[16:19]
    s_waitcnt lgkmcnt(2)
    v_mfma_f32_16x16x32_bf16 v[20:23], a[40:43], v[132:135], v[20:23]
    ds_read_b128 v[144:147], v14 offset:1088
    s_waitcnt lgkmcnt(2)
    v_mfma_f32_16x16x32_bf16 v[24:27], a[40:43], v[136:139], v[24:27]
    ds_read_b128 v[148:151], v14 offset:20032
    s_waitcnt lgkmcnt(2)
    v_mfma_f32_16x16x32_bf16 v[28:31], a[40:43], v[140:143], v[28:31]
    ds_read_b128 v[152:155], v14 offset:38976
    s_add_u32 s24, s14, 331776
    buffer_load_dwordx4 a[40:43], v13, s[44:47], s24 offen offset:0
    s_waitcnt vmcnt(21)
    v_mfma_f32_16x16x32_bf16 v[32:35], a[44:47], v[128:131], v[32:35]
    ds_read_b128 v[156:159], v14 offset:57920
    v_mfma_f32_16x16x32_bf16 v[36:39], a[44:47], v[132:135], v[36:39]
    v_mfma_f32_16x16x32_bf16 v[40:43], a[44:47], v[136:139], v[40:43]
    v_mfma_f32_16x16x32_bf16 v[44:47], a[44:47], v[140:143], v[44:47]
    buffer_load_dwordx4 a[44:47], v13, s[44:47], s24 offen offset:1024
    s_waitcnt vmcnt(21) lgkmcnt(3)
    v_mfma_f32_16x16x32_bf16 v[16:19], a[48:51], v[144:147], v[16:19]
    s_waitcnt lgkmcnt(2)
    v_mfma_f32_16x16x32_bf16 v[20:23], a[48:51], v[148:151], v[20:23]
    s_waitcnt lgkmcnt(1)
    v_mfma_f32_16x16x32_bf16 v[24:27], a[48:51], v[152:155], v[24:27]
    s_waitcnt lgkmcnt(0)
    v_mfma_f32_16x16x32_bf16 v[28:31], a[48:51], v[156:159], v[28:31]
    s_add_u32 s24, s14, 368640
    buffer_load_dwordx4 a[48:51], v13, s[44:47], s24 offen offset:0
    s_waitcnt vmcnt(21)
    v_mfma_f32_16x16x32_bf16 v[32:35], a[52:55], v[144:147], v[32:35]
    v_mfma_f32_16x16x32_bf16 v[36:39], a[52:55], v[148:151], v[36:39]
    v_mfma_f32_16x16x32_bf16 v[40:43], a[52:55], v[152:155], v[40:43]
    v_mfma_f32_16x16x32_bf16 v[44:47], a[52:55], v[156:159], v[44:47]
    buffer_load_dwordx4 a[52:55], v13, s[44:47], s24 offen offset:1024
    ds_read_b128 v[128:131], v14 offset:0
    ds_read_b128 v[132:135], v14 offset:18944
    ds_read_b128 v[136:139], v14 offset:37888
    ds_read_b128 v[140:143], v14 offset:56832
    s_waitcnt vmcnt(21) lgkmcnt(3)
    v_mfma_f32_16x16x32_bf16 v[64:67], a[56:59], v[128:131], 0
    v_mul_f32 v160, v16, v16
    v_mul_f32 v161, v17, v17
    s_waitcnt lgkmcnt(2)
    v_mfma_f32_16x16x32_bf16 v[68:71], a[56:59], v[132:135], 0
    ds_read_b128 v[144:147], v14 offset:64
    v_mul_f32 v162, v18, v18
    v_mul_f32 v163, v19, v19
    s_waitcnt lgkmcnt(2)
    v_mfma_f32_16x16x32_bf16 v[72:75], a[56:59], v[136:139], 0
    ds_read_b128 v[148:151], v14 offset:19008
    v_mul_f32 v164, v32, v32
    v_mul_f32 v165, v33, v33
    s_waitcnt lgkmcnt(2)
    v_mfma_f32_16x16x32_bf16 v[76:79], a[56:59], v[140:143], 0
    ds_read_b128 v[152:155], v14 offset:37952
    v_mul_f32 v166, v34, v34
    v_mul_f32 v167, v35, v35
    s_add_u32 s24, s14, 405504
    buffer_load_dwordx4 a[56:59], v13, s[44:47], s24 offen offset:0
    s_waitcnt vmcnt(21)
    v_mfma_f32_16x16x32_bf16 v[80:83], a[60:63], v[128:131], 0
    ds_read_b128 v[156:159], v14 offset:56896
    v_fma_f32 v160, v160, v11, s62
    v_fma_f32 v161, v161, v11, s62
    v_mfma_f32_16x16x32_bf16 v[84:87], a[60:63], v[132:135], 0
    v_fma_f32 v162, v162, v11, s62
    v_fma_f32 v163, v163, v11, s62
    v_mfma_f32_16x16x32_bf16 v[88:91], a[60:63], v[136:139], 0
    v_fma_f32 v164, v164, v11, s62
    v_fma_f32 v165, v165, v11, s62
    v_mfma_f32_16x16x32_bf16 v[92:95], a[60:63], v[140:143], 0
    v_fma_f32 v166, v166, v11, s62
    v_fma_f32 v167, v167, v11, s62
    buffer_load_dwordx4 a[60:63], v13, s[44:47], s24 offen offset:1024
    s_waitcnt vmcnt(21) lgkmcnt(3)
    v_mfma_f32_16x16x32_bf16 v[64:67], a[64:67], v[144:147], v[64:67]
    v_mul_f32 v160, v160, v16
    v_mul_f32 v161, v161, v17
    s_waitcnt lgkmcnt(2)
    v_mfma_f32_16x16x32_bf16 v[68:71], a[64:67], v[148:151], v[68:71]
    ds_read_b128 v[128:131], v14 offset:128
    v_mul_f32 v162, v162, v18
    v_mul_f32 v163, v163, v19
    s_waitcnt lgkmcnt(2)
    v_mfma_f32_16x16x32_bf16 v[72:75], a[64:67], v[152:155], v[72:75]
    ds_read_b128 v[132:135], v14 offset:19072
    v_mul_f32 v164, v164, v32
    v_mul_f32 v165, v165, v33
    s_waitcnt lgkmcnt(2)
    v_mfma_f32_16x16x32_bf16 v[76:79], a[64:67], v[156:159], v[76:79]
    ds_read_b128 v[136:139], v14 offset:38016
    v_mul_f32 v166, v166, v34
    v_mul_f32 v167, v167, v35
    s_add_u32 s24, s14, 442368
    buffer_load_dwordx4 a[64:67], v13, s[44:47], s24 offen offset:0
    s_waitcnt vmcnt(21)
    v_mfma_f32_16x16x32_bf16 v[80:83], a[68:71], v[144:147], v[80:83]
    ds_read_b128 v[140:143], v14 offset:56960
    v_exp_f32 v160, v160
    v_exp_f32 v161, v161
    v_mfma_f32_16x16x32_bf16 v[84:87], a[68:71], v[148:151], v[84:87]
    v_exp_f32 v162, v162
    v_exp_f32 v163, v163
    v_mfma_f32_16x16x32_bf16 v[88:91], a[68:71], v[152:155], v[88:91]
    v_exp_f32 v164, v164
    v_exp_f32 v165, v165
    v_mfma_f32_16x16x32_bf16 v[92:95], a[68:71], v[156:159], v[92:95]
    v_exp_f32 v166, v166
    v_exp_f32 v167, v167
    buffer_load_dwordx4 a[68:71], v13, s[44:47], s24 offen offset:1024
    s_waitcnt vmcnt(21) lgkmcnt(3)
    v_mfma_f32_16x16x32_bf16 v[64:67], a[72:75], v[128:131], v[64:67]
    v_add_f32 v160, 1.0, v160
    v_add_f32 v161, 1.0, v161
    s_waitcnt lgkmcnt(2)
    v_mfma_f32_16x16x32_bf16 v[68:71], a[72:75], v[132:135], v[68:71]
    ds_read_b128 v[144:147], v14 offset:192
    v_add_f32 v162, 1.0, v162
    v_add_f32 v163, 1.0, v163
    s_waitcnt lgkmcnt(2)
    v_mfma_f32_16x16x32_bf16 v[72:75], a[72:75], v[136:139], v[72:75]
    ds_read_b128 v[148:151], v14 offset:19136
    v_add_f32 v164, 1.0, v164
    v_add_f32 v165, 1.0, v165
    s_waitcnt lgkmcnt(2)
    v_mfma_f32_16x16x32_bf16 v[76:79], a[72:75], v[140:143], v[76:79]
    ds_read_b128 v[152:155], v14 offset:38080
    v_add_f32 v166, 1.0, v166
    v_add_f32 v167, 1.0, v167
    s_add_u32 s24, s14, 479232
    buffer_load_dwordx4 a[72:75], v13, s[44:47], s24 offen offset:0
    s_waitcnt vmcnt(21)
    v_mfma_f32_16x16x32_bf16 v[80:83], a[76:79], v[128:131], v[80:83]
    ds_read_b128 v[156:159], v14 offset:57024
    v_rcp_f32 v160, v160
    v_rcp_f32 v161, v161
    v_mfma_f32_16x16x32_bf16 v[84:87], a[76:79], v[132:135], v[84:87]
    v_rcp_f32 v162, v162
    v_rcp_f32 v163, v163
    v_mfma_f32_16x16x32_bf16 v[88:91], a[76:79], v[136:139], v[88:91]
    v_rcp_f32 v164, v164
    v_rcp_f32 v165, v165
    v_mfma_f32_16x16x32_bf16 v[92:95], a[76:79], v[140:143], v[92:95]
    v_rcp_f32 v166, v166
    v_rcp_f32 v167, v167
    buffer_load_dwordx4 a[76:79], v13, s[44:47], s24 offen offset:1024
    s_waitcnt vmcnt(21) lgkmcnt(3)
    v_mfma_f32_16x16x32_bf16 v[64:67], a[80:83], v[144:147], v[64:67]
    v_mul_f32 v160, v160, v16
    v_mul_f32 v161, v161, v17
    s_waitcnt lgkmcnt(2)
    v_mfma_f32_16x16x32_bf16 v[68:71], a[80:83], v[148:151], v[68:71]
    ds_read_b128 v[128:131], v14 offset:256
    v_mul_f32 v162, v162, v18
    v_mul_f32 v163, v163, v19
    s_waitcnt lgkmcnt(2)
    v_mfma_f32_16x16x32_bf16 v[72:75], a[80:83], v[152:155], v[72:75]
    ds_read_b128 v[132:135], v14 offset:19200
    v_mul_f32 v164, v164, v32
    v_mul_f32 v165, v165, v33
    s_waitcnt lgkmcnt(2)
    v_mfma_f32_16x16x32_bf16 v[76:79], a[80:83], v[156:159], v[76:79]
    ds_read_b128 v[136:139], v14 offset:38144
    v_mul_f32 v166, v166, v34
    v_mul_f32 v167, v167, v35
    s_add_u32 s24, s14, 516096
    buffer_load_dwordx4 a[80:83], v13, s[44:47], s24 offen offset:0
    s_waitcnt vmcnt(21)
    v_mfma_f32_16x16x32_bf16 v[80:83], a[84:87], v[144:147], v[80:83]
    ds_read_b128 v[140:143], v14 offset:57088
    v_cvt_pk_bf16_f32 v16, v160, v161
    v_cvt_pk_bf16_f32 v17, v162, v163
    v_mfma_f32_16x16x32_bf16 v[84:87], a[84:87], v[148:151], v[84:87]
    v_cvt_pk_bf16_f32 v18, v164, v165
    v_cvt_pk_bf16_f32 v19, v166, v167
    v_mfma_f32_16x16x32_bf16 v[88:91], a[84:87], v[152:155], v[88:91]
    ds_write_b128 v7, v[16:19] offset:0
    v_mul_f32 v160, v20, v20
    v_mul_f32 v161, v21, v21
    v_mfma_f32_16x16x32_bf16 v[92:95], a[84:87], v[156:159], v[92:95]
    v_mul_f32 v162, v22, v22
    v_mul_f32 v163, v23, v23
    buffer_load_dwordx4 a[84:87], v13, s[44:47], s24 offen offset:1024
    s_waitcnt vmcnt(21) lgkmcnt(4)
    v_mfma_f32_16x16x32_bf16 v[64:67], a[0:3], v[128:131], v[64:67]
    v_mul_f32 v164, v36, v36
    v_mul_f32 v165, v37, v37
    s_waitcnt lgkmcnt(3)
    v_mfma_f32_16x16x32_bf16 v[68:71], a[0:3], v[132:135], v[68:71]
    ds_read_b128 v[144:147], v14 offset:320
    v_mul_f32 v166, v38, v38
    v_mul_f32 v167, v39, v39
    s_waitcnt lgkmcnt(3)
    v_mfma_f32_16x16x32_bf16 v[72:75], a[0:3], v[136:139], v[72:75]
    ds_read_b128 v[148:151], v14 offset:19264
    v_fma_f32 v160, v160, v11, s62
    v_fma_f32 v161, v161, v11, s62
    s_waitcnt lgkmcnt(3)
    v_mfma_f32_16x16x32_bf16 v[76:79], a[0:3], v[140:143], v[76:79]
    ds_read_b128 v[152:155], v14 offset:38208
    v_fma_f32 v162, v162, v11, s62
    v_fma_f32 v163, v163, v11, s62
    s_add_u32 s24, s14, 552960
    buffer_load_dwordx4 a[0:3], v13, s[44:47], s24 offen offset:0
    s_waitcnt vmcnt(21)
    v_mfma_f32_16x16x32_bf16 v[80:83], a[4:7], v[128:131], v[80:83]
    ds_read_b128 v[156:159], v14 offset:57152
    v_fma_f32 v164, v164, v11, s62
    v_fma_f32 v165, v165, v11, s62
    v_mfma_f32_16x16x32_bf16 v[84:87], a[4:7], v[132:135], v[84:87]
    v_fma_f32 v166, v166, v11, s62
    v_fma_f32 v167, v167, v11, s62
    v_mfma_f32_16x16x32_bf16 v[88:91], a[4:7], v[136:139], v[88:91]
    v_mul_f32 v160, v160, v20
    v_mul_f32 v161, v161, v21
    v_mfma_f32_16x16x32_bf16 v[92:95], a[4:7], v[140:143], v[92:95]
    v_mul_f32 v162, v162, v22
    v_mul_f32 v163, v163, v23
    buffer_load_dwordx4 a[4:7], v13, s[44:47], s24 offen offset:1024
    s_waitcnt vmcnt(21) lgkmcnt(3)
    v_mfma_f32_16x16x32_bf16 v[64:67], a[8:11], v[144:147], v[64:67]
    v_mul_f32 v164, v164, v36
    v_mul_f32 v165, v165, v37
    s_waitcnt lgkmcnt(2)
    v_mfma_f32_16x16x32_bf16 v[68:71], a[8:11], v[148:151], v[68:71]
    ds_read_b128 v[128:131], v14 offset:384
    v_mul_f32 v166, v166, v38
    v_mul_f32 v167, v167, v39
    s_waitcnt lgkmcnt(2)
    v_mfma_f32_16x16x32_bf16 v[72:75], a[8:11], v[152:155], v[72:75]
    ds_read_b128 v[132:135], v14 offset:19328
    v_exp_f32 v160, v160
    v_exp_f32 v161, v161
    s_waitcnt lgkmcnt(2)
    v_mfma_f32_16x16x32_bf16 v[76:79], a[8:11], v[156:159], v[76:79]
    ds_read_b128 v[136:139], v14 offset:38272
    v_exp_f32 v162, v162
    v_exp_f32 v163, v163
    s_add_u32 s24, s14, 589824
    buffer_load_dwordx4 a[8:11], v13, s[44:47], s24 offen offset:0
    s_waitcnt vmcnt(21)
    v_mfma_f32_16x16x32_bf16 v[80:83], a[12:15], v[144:147], v[80:83]
    ds_read_b128 v[140:143], v14 offset:57216
    v_exp_f32 v164, v164
    v_exp_f32 v165, v165
    v_mfma_f32_16x16x32_bf16 v[84:87], a[12:15], v[148:151], v[84:87]
    v_exp_f32 v166, v166
    v_exp_f32 v167, v167
    v_mfma_f32_16x16x32_bf16 v[88:91], a[12:15], v[152:155], v[88:91]
    v_add_f32 v160, 1.0, v160
    v_add_f32 v161, 1.0, v161
    v_mfma_f32_16x16x32_bf16 v[92:95], a[12:15], v[156:159], v[92:95]
    v_add_f32 v162, 1.0, v162
    v_add_f32 v163, 1.0, v163
    buffer_load_dwordx4 a[12:15], v13, s[44:47], s24 offen offset:1024
    s_waitcnt vmcnt(21) lgkmcnt(3)
    v_mfma_f32_16x16x32_bf16 v[64:67], a[16:19], v[128:131], v[64:67]
    v_add_f32 v164, 1.0, v164
    v_add_f32 v165, 1.0, v165
    s_waitcnt lgkmcnt(2)
    v_mfma_f32_16x16x32_bf16 v[68:71], a[16:19], v[132:135], v[68:71]
    ds_read_b128 v[144:147], v14 offset:448
    v_add_f32 v166, 1.0, v166
    v_add_f32 v167, 1.0, v167
    s_waitcnt lgkmcnt(2)
    v_mfma_f32_16x16x32_bf16 v[72:75], a[16:19], v[136:139], v[72:75]
    ds_read_b128 v[148:151], v14 offset:19392
    v_rcp_f32 v160, v160
    v_rcp_f32 v161, v161
    s_waitcnt lgkmcnt(2)
    v_mfma_f32_16x16x32_bf16 v[76:79], a[16:19], v[140:143], v[76:79]
    ds_read_b128 v[152:155], v14 offset:38336
    v_rcp_f32 v162, v162
    v_rcp_f32 v163, v163
    s_add_u32 s24, s14, 626688
    buffer_load_dwordx4 a[16:19], v13, s[44:47], s24 offen offset:0
    s_waitcnt vmcnt(21)
    v_mfma_f32_16x16x32_bf16 v[80:83], a[20:23], v[128:131], v[80:83]
    ds_read_b128 v[156:159], v14 offset:57280
    v_rcp_f32 v164, v164
    v_rcp_f32 v165, v165
    v_mfma_f32_16x16x32_bf16 v[84:87], a[20:23], v[132:135], v[84:87]
    v_rcp_f32 v166, v166
    v_rcp_f32 v167, v167
    v_mfma_f32_16x16x32_bf16 v[88:91], a[20:23], v[136:139], v[88:91]
    v_mul_f32 v160, v160, v20
    v_mul_f32 v161, v161, v21
    v_mfma_f32_16x16x32_bf16 v[92:95], a[20:23], v[140:143], v[92:95]
    v_mul_f32 v162, v162, v22
    v_mul_f32 v163, v163, v23
    buffer_load_dwordx4 a[20:23], v13, s[44:47], s24 offen offset:1024
    s_waitcnt vmcnt(21) lgkmcnt(3)
    v_mfma_f32_16x16x32_bf16 v[64:67], a[24:27], v[144:147], v[64:67]
    v_mul_f32 v164, v164, v36
    v_mul_f32 v165, v165, v37
    s_waitcnt lgkmcnt(2)
    v_mfma_f32_16x16x32_bf16 v[68:71], a[24:27], v[148:151], v[68:71]
    ds_read_b128 v[128:131], v14 offset:512
    v_mul_f32 v166, v166, v38
    v_mul_f32 v167, v167, v39
    s_waitcnt lgkmcnt(2)
    v_mfma_f32_16x16x32_bf16 v[72:75], a[24:27], v[152:155], v[72:75]
    ds_read_b128 v[132:135], v14 offset:19456
    v_cvt_pk_bf16_f32 v20, v160, v161
    v_cvt_pk_bf16_f32 v21, v162, v163
    s_waitcnt lgkmcnt(2)
    v_mfma_f32_16x16x32_bf16 v[76:79], a[24:27], v[156:159], v[76:79]
    ds_read_b128 v[136:139], v14 offset:38400
    v_cvt_pk_bf16_f32 v22, v164, v165
    v_cvt_pk_bf16_f32 v23, v166, v167
    s_add_u32 s24, s15, 0
    buffer_load_dwordx4 a[24:27], v2, s[44:47], s24 offen offset:0
    s_waitcnt vmcnt(21)
    v_mfma_f32_16x16x32_bf16 v[80:83], a[28:31], v[144:147], v[80:83]
    ds_read_b128 v[140:143], v14 offset:57344
    ds_write_b128 v7, v[20:23] offset:1024
    v_mul_f32 v160, v24, v24
    v_mul_f32 v161, v25, v25
    v_mfma_f32_16x16x32_bf16 v[84:87], a[28:31], v[148:151], v[84:87]
    v_mul_f32 v162, v26, v26
    v_mul_f32 v163, v27, v27
    v_mfma_f32_16x16x32_bf16 v[88:91], a[28:31], v[152:155], v[88:91]
    v_mul_f32 v164, v40, v40
    v_mul_f32 v165, v41, v41
    v_mfma_f32_16x16x32_bf16 v[92:95], a[28:31], v[156:159], v[92:95]
    v_mul_f32 v166, v42, v42
    v_mul_f32 v167, v43, v43
    buffer_load_dwordx4 a[28:31], v2, s[44:47], s24 offen offset:1024
    s_waitcnt vmcnt(21) lgkmcnt(4)
    v_mfma_f32_16x16x32_bf16 v[64:67], a[32:35], v[128:131], v[64:67]
    v_fma_f32 v160, v160, v11, s62
    v_fma_f32 v161, v161, v11, s62
    s_waitcnt lgkmcnt(3)
    v_mfma_f32_16x16x32_bf16 v[68:71], a[32:35], v[132:135], v[68:71]
    ds_read_b128 v[144:147], v14 offset:576
    v_fma_f32 v162, v162, v11, s62
    v_fma_f32 v163, v163, v11, s62
    s_waitcnt lgkmcnt(3)
    v_mfma_f32_16x16x32_bf16 v[72:75], a[32:35], v[136:139], v[72:75]
    ds_read_b128 v[148:151], v14 offset:19520
    v_fma_f32 v164, v164, v11, s62
    v_fma_f32 v165, v165, v11, s62
    s_waitcnt lgkmcnt(3)
    v_mfma_f32_16x16x32_bf16 v[76:79], a[32:35], v[140:143], v[76:79]
    ds_read_b128 v[152:155], v14 offset:38464
    v_fma_f32 v166, v166, v11, s62
    v_fma_f32 v167, v167, v11, s62
    buffer_load_dwordx4 a[32:35], v2, s[44:47], s24 offen offset:2048
    s_waitcnt vmcnt(21)
    v_mfma_f32_16x16x32_bf16 v[80:83], a[36:39], v[128:131], v[80:83]
    ds_read_b128 v[156:159], v14 offset:57408
    v_mul_f32 v160, v160, v24
    v_mul_f32 v161, v161, v25
    v_mfma_f32_16x16x32_bf16 v[84:87], a[36:39], v[132:135], v[84:87]
    v_mul_f32 v162, v162, v26
    v_mul_f32 v163, v163, v27
    v_mfma_f32_16x16x32_bf16 v[88:91], a[36:39], v[136:139], v[88:91]
    v_mul_f32 v164, v164, v40
    v_mul_f32 v165, v165, v41
    v_mfma_f32_16x16x32_bf16 v[92:95], a[36:39], v[140:143], v[92:95]
    v_mul_f32 v166, v166, v42
    v_mul_f32 v167, v167, v43
    buffer_load_dwordx4 a[36:39], v2, s[44:47], s24 offen offset:3072
    s_waitcnt vmcnt(21) lgkmcnt(3)
    v_mfma_f32_16x16x32_bf16 v[64:67], a[40:43], v[144:147], v[64:67]
    v_exp_f32 v160, v160
    v_exp_f32 v161, v161
    s_waitcnt lgkmcnt(2)
    v_mfma_f32_16x16x32_bf16 v[68:71], a[40:43], v[148:151], v[68:71]
    ds_read_b128 v[128:131], v14 offset:640
    v_exp_f32 v162, v162
    v_exp_f32 v163, v163
    s_waitcnt lgkmcnt(2)
    v_mfma_f32_16x16x32_bf16 v[72:75], a[40:43], v[152:155], v[72:75]
    ds_read_b128 v[132:135], v14 offset:19584
    v_exp_f32 v164, v164
    v_exp_f32 v165, v165
    s_waitcnt lgkmcnt(2)
    v_mfma_f32_16x16x32_bf16 v[76:79], a[40:43], v[156:159], v[76:79]
    ds_read_b128 v[136:139], v14 offset:38528
    v_exp_f32 v166, v166
    v_exp_f32 v167, v167
    s_add_u32 s24, s15, 36864
    buffer_load_dwordx4 a[40:43], v2, s[44:47], s24 offen offset:0
    s_waitcnt vmcnt(21)
    v_mfma_f32_16x16x32_bf16 v[80:83], a[44:47], v[144:147], v[80:83]
    ds_read_b128 v[140:143], v14 offset:57472
    v_add_f32 v160, 1.0, v160
    v_add_f32 v161, 1.0, v161
    v_mfma_f32_16x16x32_bf16 v[84:87], a[44:47], v[148:151], v[84:87]
    v_add_f32 v162, 1.0, v162
    v_add_f32 v163, 1.0, v163
    v_mfma_f32_16x16x32_bf16 v[88:91], a[44:47], v[152:155], v[88:91]
    v_add_f32 v164, 1.0, v164
    v_add_f32 v165, 1.0, v165
    v_mfma_f32_16x16x32_bf16 v[92:95], a[44:47], v[156:159], v[92:95]
    v_add_f32 v166, 1.0, v166
    v_add_f32 v167, 1.0, v167
    buffer_load_dwordx4 a[44:47], v2, s[44:47], s24 offen offset:1024
    s_waitcnt vmcnt(21) lgkmcnt(3)
    v_mfma_f32_16x16x32_bf16 v[64:67], a[48:51], v[128:131], v[64:67]
    v_rcp_f32 v160, v160
    v_rcp_f32 v161, v161
    s_waitcnt lgkmcnt(2)
    v_mfma_f32_16x16x32_bf16 v[68:71], a[48:51], v[132:135], v[68:71]
    ds_read_b128 v[144:147], v14 offset:704
    v_rcp_f32 v162, v162
    v_rcp_f32 v163, v163
    s_waitcnt lgkmcnt(2)
    v_mfma_f32_16x16x32_bf16 v[72:75], a[48:51], v[136:139], v[72:75]
    ds_read_b128 v[148:151], v14 offset:19648
    v_rcp_f32 v164, v164
    v_rcp_f32 v165, v165
    s_waitcnt lgkmcnt(2)
    v_mfma_f32_16x16x32_bf16 v[76:79], a[48:51], v[140:143], v[76:79]
    ds_read_b128 v[152:155], v14 offset:38592
    v_rcp_f32 v166, v166
    v_rcp_f32 v167, v167
    buffer_load_dwordx4 a[48:51], v2, s[44:47], s24 offen offset:2048
    s_waitcnt vmcnt(21)
    v_mfma_f32_16x16x32_bf16 v[80:83], a[52:55], v[128:131], v[80:83]
    ds_read_b128 v[156:159], v14 offset:57536
    v_mul_f32 v160, v160, v24
    v_mul_f32 v161, v161, v25
    v_mfma_f32_16x16x32_bf16 v[84:87], a[52:55], v[132:135], v[84:87]
    v_mul_f32 v162, v162, v26
    v_mul_f32 v163, v163, v27
    v_mfma_f32_16x16x32_bf16 v[88:91], a[52:55], v[136:139], v[88:91]
    v_mul_f32 v164, v164, v40
    v_mul_f32 v165, v165, v41
    v_mfma_f32_16x16x32_bf16 v[92:95], a[52:55], v[140:143], v[92:95]
    v_mul_f32 v166, v166, v42
    v_mul_f32 v167, v167, v43
    buffer_load_dwordx4 a[52:55], v2, s[44:47], s24 offen offset:3072
    s_waitcnt vmcnt(21) lgkmcnt(3)
    v_mfma_f32_16x16x32_bf16 v[64:67], a[56:59], v[144:147], v[64:67]
    v_cvt_pk_bf16_f32 v24, v160, v161
    v_cvt_pk_bf16_f32 v25, v162, v163
    s_waitcnt lgkmcnt(2)
    v_mfma_f32_16x16x32_bf16 v[68:71], a[56:59], v[148:151], v[68:71]
    ds_read_b128 v[128:131], v14 offset:768
    v_cvt_pk_bf16_f32 v26, v164, v165
    v_cvt_pk_bf16_f32 v27, v166, v167
    s_waitcnt lgkmcnt(2)
    v_mfma_f32_16x16x32_bf16 v[72:75], a[56:59], v[152:155], v[72:75]
    ds_read_b128 v[132:135], v14 offset:19712
    ds_write_b128 v7, v[24:27] offset:2048
    v_mul_f32 v160, v28, v28
    v_mul_f32 v161, v29, v29
    s_waitcnt lgkmcnt(3)
    v_mfma_f32_16x16x32_bf16 v[76:79], a[56:59], v[156:159], v[76:79]
    ds_read_b128 v[136:139], v14 offset:38656
    v_mul_f32 v162, v30, v30
    v_mul_f32 v163, v31, v31
    s_add_u32 s24, s15, 73728
    buffer_load_dwordx4 a[56:59], v2, s[44:47], s24 offen offset:0
    s_waitcnt vmcnt(21)
    v_mfma_f32_16x16x32_bf16 v[80:83], a[60:63], v[144:147], v[80:83]
    ds_read_b128 v[140:143], v14 offset:57600
    v_mul_f32 v164, v44, v44
    v_mul_f32 v165, v45, v45
    v_mfma_f32_16x16x32_bf16 v[84:87], a[60:63], v[148:151], v[84:87]
    v_mul_f32 v166, v46, v46
    v_mul_f32 v167, v47, v47
    v_mfma_f32_16x16x32_bf16 v[88:91], a[60:63], v[152:155], v[88:91]
    v_fma_f32 v160, v160, v11, s62
    v_fma_f32 v161, v161, v11, s62
    v_mfma_f32_16x16x32_bf16 v[92:95], a[60:63], v[156:159], v[92:95]
    v_fma_f32 v162, v162, v11, s62
    v_fma_f32 v163, v163, v11, s62
    buffer_load_dwordx4 a[60:63], v2, s[44:47], s24 offen offset:1024
    s_waitcnt vmcnt(21) lgkmcnt(4)
    v_mfma_f32_16x16x32_bf16 v[64:67], a[64:67], v[128:131], v[64:67]
    v_fma_f32 v164, v164, v11, s62
    v_fma_f32 v165, v165, v11, s62
    s_waitcnt lgkmcnt(3)
    v_mfma_f32_16x16x32_bf16 v[68:71], a[64:67], v[132:135], v[68:71]
    ds_read_b128 v[144:147], v14 offset:832
    v_fma_f32 v166, v166, v11, s62
    v_fma_f32 v167, v167, v11, s62
    s_waitcnt lgkmcnt(2)
    v_mfma_f32_16x16x32_bf16 v[72:75], a[64:67], v[136:139], v[72:75]
    ds_read_b128 v[148:151], v14 offset:19776
    v_mul_f32 v160, v160, v28
    v_mul_f32 v161, v161, v29
    s_waitcnt lgkmcnt(2)
    v_mfma_f32_16x16x32_bf16 v[76:79], a[64:67], v[140:143], v[76:79]
    ds_read_b128 v[152:155], v14 offset:38720
    v_mul_f32 v162, v162, v30
    v_mul_f32 v163, v163, v31
    buffer_load_dwordx4 a[64:67], v2, s[44:47], s24 offen offset:2048
    s_waitcnt vmcnt(21)
    v_mfma_f32_16x16x32_bf16 v[80:83], a[68:71], v[128:131], v[80:83]
    ds_read_b128 v[156:159], v14 offset:57664
    v_mul_f32 v164, v164, v44
    v_mul_f32 v165, v165, v45
    v_mfma_f32_16x16x32_bf16 v[84:87], a[68:71], v[132:135], v[84:87]
    v_mul_f32 v166, v166, v46
    v_mul_f32 v167, v167, v47
    v_mfma_f32_16x16x32_bf16 v[88:91], a[68:71], v[136:139], v[88:91]
    v_exp_f32 v160, v160
    v_exp_f32 v161, v161
    v_mfma_f32_16x16x32_bf16 v[92:95], a[68:71], v[140:143], v[92:95]
    v_exp_f32 v162, v162
    v_exp_f32 v163, v163
    buffer_load_dwordx4 a[68:71], v2, s[44:47], s24 offen offset:3072
    s_waitcnt vmcnt(21) lgkmcnt(3)
    v_mfma_f32_16x16x32_bf16 v[64:67], a[72:75], v[144:147], v[64:67]
    v_exp_f32 v164, v164
    v_exp_f32 v165, v165
    s_waitcnt lgkmcnt(2)
    v_mfma_f32_16x16x32_bf16 v[68:71], a[72:75], v[148:151], v[68:71]
    ds_read_b128 v[128:131], v14 offset:896
    v_exp_f32 v166, v166
    v_exp_f32 v167, v167
    s_waitcnt lgkmcnt(2)
    v_mfma_f32_16x16x32_bf16 v[72:75], a[72:75], v[152:155], v[72:75]
    ds_read_b128 v[132:135], v14 offset:19840
    v_add_f32 v160, 1.0, v160
    v_add_f32 v161, 1.0, v161
    s_waitcnt lgkmcnt(2)
    v_mfma_f32_16x16x32_bf16 v[76:79], a[72:75], v[156:159], v[76:79]
    ds_read_b128 v[136:139], v14 offset:38784
    v_add_f32 v162, 1.0, v162
    v_add_f32 v163, 1.0, v163
    s_add_u32 s24, s15, 110592
    buffer_load_dwordx4 a[72:75], v2, s[44:47], s24 offen offset:0
    s_waitcnt vmcnt(21)
    v_mfma_f32_16x16x32_bf16 v[80:83], a[76:79], v[144:147], v[80:83]
    ds_read_b128 v[140:143], v14 offset:57728
    v_add_f32 v164, 1.0, v164
    v_add_f32 v165, 1.0, v165
    v_mfma_f32_16x16x32_bf16 v[84:87], a[76:79], v[148:151], v[84:87]
    v_add_f32 v166, 1.0, v166
    v_add_f32 v167, 1.0, v167
    v_mfma_f32_16x16x32_bf16 v[88:91], a[76:79], v[152:155], v[88:91]
    v_rcp_f32 v160, v160
    v_rcp_f32 v161, v161
    v_mfma_f32_16x16x32_bf16 v[92:95], a[76:79], v[156:159], v[92:95]
    v_rcp_f32 v162, v162
    v_rcp_f32 v163, v163
    buffer_load_dwordx4 a[76:79], v2, s[44:47], s24 offen offset:1024
    s_waitcnt vmcnt(21) lgkmcnt(3)
    v_mfma_f32_16x16x32_bf16 v[64:67], a[80:83], v[128:131], v[64:67]
    v_rcp_f32 v164, v164
    v_rcp_f32 v165, v165
    s_waitcnt lgkmcnt(2)
    v_mfma_f32_16x16x32_bf16 v[68:71], a[80:83], v[132:135], v[68:71]
    ds_read_b128 v[144:147], v14 offset:960
    v_rcp_f32 v166, v166
    v_rcp_f32 v167, v167
    s_waitcnt lgkmcnt(2)
    v_mfma_f32_16x16x32_bf16 v[72:75], a[80:83], v[136:139], v[72:75]
    ds_read_b128 v[148:151], v14 offset:19904
    v_mul_f32 v160, v160, v28
    v_mul_f32 v161, v161, v29
    s_waitcnt lgkmcnt(2)
    v_mfma_f32_16x16x32_bf16 v[76:79], a[80:83], v[140:143], v[76:79]
    ds_read_b128 v[152:155], v14 offset:38848
    v_mul_f32 v162, v162, v30
    v_mul_f32 v163, v163, v31
    buffer_load_dwordx4 a[80:83], v2, s[44:47], s24 offen offset:2048
    s_waitcnt vmcnt(21)
    v_mfma_f32_16x16x32_bf16 v[80:83], a[84:87], v[128:131], v[80:83]
    ds_read_b128 v[156:159], v14 offset:57792
    v_mul_f32 v164, v164, v44
    v_mul_f32 v165, v165, v45
    v_mfma_f32_16x16x32_bf16 v[84:87], a[84:87], v[132:135], v[84:87]
    v_mul_f32 v166, v166, v46
    v_mul_f32 v167, v167, v47
    v_mfma_f32_16x16x32_bf16 v[88:91], a[84:87], v[136:139], v[88:91]
    v_cvt_pk_bf16_f32 v28, v160, v161
    v_cvt_pk_bf16_f32 v29, v162, v163
    v_mfma_f32_16x16x32_bf16 v[92:95], a[84:87], v[140:143], v[92:95]
    v_cvt_pk_bf16_f32 v30, v164, v165
    v_cvt_pk_bf16_f32 v31, v166, v167
    buffer_load_dwordx4 a[84:87], v2, s[44:47], s24 offen offset:3072
    s_waitcnt vmcnt(21) lgkmcnt(3)
    v_mfma_f32_16x16x32_bf16 v[64:67], a[0:3], v[144:147], v[64:67]
    ds_write_b128 v7, v[28:31] offset:3072
    s_waitcnt lgkmcnt(3)
    v_mfma_f32_16x16x32_bf16 v[68:71], a[0:3], v[148:151], v[68:71]
    ds_read_b128 v[128:131], v14 offset:1024
    s_waitcnt lgkmcnt(3)
    v_mfma_f32_16x16x32_bf16 v[72:75], a[0:3], v[152:155], v[72:75]
    ds_read_b128 v[132:135], v14 offset:19968
    s_waitcnt lgkmcnt(3)
    v_mfma_f32_16x16x32_bf16 v[76:79], a[0:3], v[156:159], v[76:79]
    ds_read_b128 v[136:139], v14 offset:38912
    s_add_u32 s24, s15, 147456
    buffer_load_dwordx4 a[0:3], v2, s[44:47], s24 offen offset:0
    s_waitcnt vmcnt(21)
    v_mfma_f32_16x16x32_bf16 v[80:83], a[4:7], v[144:147], v[80:83]
    ds_read_b128 v[140:143], v14 offset:57856
    v_mfma_f32_16x16x32_bf16 v[84:87], a[4:7], v[148:151], v[84:87]
    v_mfma_f32_16x16x32_bf16 v[88:91], a[4:7], v[152:155], v[88:91]
    v_mfma_f32_16x16x32_bf16 v[92:95], a[4:7], v[156:159], v[92:95]
    buffer_load_dwordx4 a[4:7], v2, s[44:47], s24 offen offset:1024
    s_waitcnt vmcnt(21) lgkmcnt(3)
    v_mfma_f32_16x16x32_bf16 v[64:67], a[8:11], v[128:131], v[64:67]
    s_waitcnt lgkmcnt(2)
    v_mfma_f32_16x16x32_bf16 v[68:71], a[8:11], v[132:135], v[68:71]
    ds_read_b128 v[144:147], v14 offset:1088
    s_waitcnt lgkmcnt(2)
    v_mfma_f32_16x16x32_bf16 v[72:75], a[8:11], v[136:139], v[72:75]
    ds_read_b128 v[148:151], v14 offset:20032
    s_waitcnt lgkmcnt(2)
    v_mfma_f32_16x16x32_bf16 v[76:79], a[8:11], v[140:143], v[76:79]
    ds_read_b128 v[152:155], v14 offset:38976
    buffer_load_dwordx4 a[8:11], v2, s[44:47], s24 offen offset:2048
    s_waitcnt vmcnt(21)
    v_mfma_f32_16x16x32_bf16 v[80:83], a[12:15], v[128:131], v[80:83]
    ds_read_b128 v[156:159], v14 offset:57920
    v_mfma_f32_16x16x32_bf16 v[84:87], a[12:15], v[132:135], v[84:87]
    v_mfma_f32_16x16x32_bf16 v[88:91], a[12:15], v[136:139], v[88:91]
    v_mfma_f32_16x16x32_bf16 v[92:95], a[12:15], v[140:143], v[92:95]
    buffer_load_dwordx4 a[12:15], v2, s[44:47], s24 offen offset:3072
    s_waitcnt vmcnt(21) lgkmcnt(3)
    v_mfma_f32_16x16x32_bf16 v[64:67], a[16:19], v[144:147], v[64:67]
    s_waitcnt lgkmcnt(2)
    v_mfma_f32_16x16x32_bf16 v[68:71], a[16:19], v[148:151], v[68:71]
    s_waitcnt lgkmcnt(1)
    v_mfma_f32_16x16x32_bf16 v[72:75], a[16:19], v[152:155], v[72:75]
    s_waitcnt lgkmcnt(0)
    v_mfma_f32_16x16x32_bf16 v[76:79], a[16:19], v[156:159], v[76:79]
    s_add_u32 s24, s15, 184320
    buffer_load_dwordx4 a[16:19], v2, s[44:47], s24 offen offset:0
    s_waitcnt vmcnt(21)
    v_mfma_f32_16x16x32_bf16 v[80:83], a[20:23], v[144:147], v[80:83]
    v_mfma_f32_16x16x32_bf16 v[84:87], a[20:23], v[148:151], v[84:87]
    v_mfma_f32_16x16x32_bf16 v[88:91], a[20:23], v[152:155], v[88:91]
    v_mfma_f32_16x16x32_bf16 v[92:95], a[20:23], v[156:159], v[92:95]
    buffer_load_dwordx4 a[20:23], v2, s[44:47], s24 offen offset:1024
    s_waitcnt lgkmcnt(0)
    s_barrier
    ds_read_b128 v[128:131], v5 offset:0
    ds_read_b128 v[132:135], v5 offset:1024
    ds_read_b128 v[136:139], v5 offset:2048
    ds_read_b128 v[140:143], v5 offset:3072
    s_waitcnt vmcnt(21) lgkmcnt(3)
    v_mfma_f32_16x16x32_bf16 v[16:19], a[24:27], v[128:131], 0
    v_mul_f32 v160, v64, v64
    v_mul_f32 v161, v65, v65
    s_waitcnt lgkmcnt(2)
    v_mfma_f32_16x16x32_bf16 v[20:23], a[24:27], v[132:135], 0
    ds_read_b128 v[144:147], v5 offset:4096
    v_mul_f32 v162, v66, v66
    v_mul_f32 v163, v67, v67
    s_waitcnt lgkmcnt(2)
    v_mfma_f32_16x16x32_bf16 v[24:27], a[24:27], v[136:139], 0
    ds_read_b128 v[148:151], v5 offset:5120
    v_mul_f32 v164, v80, v80
    v_mul_f32 v165, v81, v81
    s_waitcnt lgkmcnt(2)
    v_mfma_f32_16x16x32_bf16 v[28:31], a[24:27], v[140:143], 0
    ds_read_b128 v[152:155], v5 offset:6144
    v_mul_f32 v166, v82, v82
    v_mul_f32 v167, v83, v83
    buffer_load_dwordx4 a[24:27], v2, s[44:47], s24 offen offset:2048
    s_waitcnt vmcnt(21)
    v_mfma_f32_16x16x32_bf16 v[32:35], a[28:31], v[128:131], 0
    ds_read_b128 v[156:159], v5 offset:7168
    v_fma_f32 v160, v160, v11, s62
    v_fma_f32 v161, v161, v11, s62
    v_mfma_f32_16x16x32_bf16 v[36:39], a[28:31], v[132:135], 0
    v_fma_f32 v162, v162, v11, s62
    v_fma_f32 v163, v163, v11, s62
    v_mfma_f32_16x16x32_bf16 v[40:43], a[28:31], v[136:139], 0
    v_fma_f32 v164, v164, v11, s62
    v_fma_f32 v165, v165, v11, s62
    v_mfma_f32_16x16x32_bf16 v[44:47], a[28:31], v[140:143], 0
    v_fma_f32 v166, v166, v11, s62
    v_fma_f32 v167, v167, v11, s62
    buffer_load_dwordx4 a[28:31], v2, s[44:47], s24 offen offset:3072
    s_waitcnt vmcnt(21)
    v_mfma_f32_16x16x32_bf16 v[96:99], a[32:35], v[128:131], 0
    v_mul_f32 v160, v160, v64
    v_mul_f32 v161, v161, v65
    v_mfma_f32_16x16x32_bf16 v[100:103], a[32:35], v[132:135], 0
    v_mul_f32 v162, v162, v66
    v_mul_f32 v163, v163, v67
    v_mfma_f32_16x16x32_bf16 v[104:107], a[32:35], v[136:139], 0
    v_mul_f32 v164, v164, v80
    v_mul_f32 v165, v165, v81
    v_mfma_f32_16x16x32_bf16 v[108:111], a[32:35], v[140:143], 0
    v_mul_f32 v166, v166, v82
    v_mul_f32 v167, v167, v83
    s_add_u32 s24, s15, 221184
    buffer_load_dwordx4 a[32:35], v2, s[44:47], s24 offen offset:0
    s_waitcnt vmcnt(21)
    v_mfma_f32_16x16x32_bf16 v[112:115], a[36:39], v[128:131], 0
    v_exp_f32 v160, v160
    v_exp_f32 v161, v161
    v_mfma_f32_16x16x32_bf16 v[116:119], a[36:39], v[132:135], 0
    v_exp_f32 v162, v162
    v_exp_f32 v163, v163
    v_mfma_f32_16x16x32_bf16 v[120:123], a[36:39], v[136:139], 0
    v_exp_f32 v164, v164
    v_exp_f32 v165, v165
    v_mfma_f32_16x16x32_bf16 v[124:127], a[36:39], v[140:143], 0
    v_exp_f32 v166, v166
    v_exp_f32 v167, v167
    buffer_load_dwordx4 a[36:39], v2, s[44:47], s24 offen offset:1024
    s_waitcnt vmcnt(21) lgkmcnt(3)
    v_mfma_f32_16x16x32_bf16 v[16:19], a[40:43], v[144:147], v[16:19]
    v_add_f32 v160, 1.0, v160
    v_add_f32 v161, 1.0, v161
    s_waitcnt lgkmcnt(2)
    v_mfma_f32_16x16x32_bf16 v[20:23], a[40:43], v[148:151], v[20:23]
    ds_read_b128 v[128:131], v5 offset:8192
    v_add_f32 v162, 1.0, v162
    v_add_f32 v163, 1.0, v163
    s_waitcnt lgkmcnt(2)
    v_mfma_f32_16x16x32_bf16 v[24:27], a[40:43], v[152:155], v[24:27]
    ds_read_b128 v[132:135], v5 offset:9216
    v_add_f32 v164, 1.0, v164
    v_add_f32 v165, 1.0, v165
    s_waitcnt lgkmcnt(2)
    v_mfma_f32_16x16x32_bf16 v[28:31], a[40:43], v[156:159], v[28:31]
    ds_read_b128 v[136:139], v5 offset:10240
    v_add_f32 v166, 1.0, v166
    v_add_f32 v167, 1.0, v167
    buffer_load_dwordx4 a[40:43], v2, s[44:47], s24 offen offset:2048
    s_waitcnt vmcnt(21)
    v_mfma_f32_16x16x32_bf16 v[32:35], a[44:47], v[144:147], v[32:35]
    ds_read_b128 v[140:143], v5 offset:11264
    v_rcp_f32 v160, v160
    v_rcp_f32 v161, v161
    v_mfma_f32_16x16x32_bf16 v[36:39], a[44:47], v[148:151], v[36:39]
    v_rcp_f32 v162, v162
    v_rcp_f32 v163, v163
    v_mfma_f32_16x16x32_bf16 v[40:43], a[44:47], v[152:155], v[40:43]
    v_rcp_f32 v164, v164
    v_rcp_f32 v165, v165
    v_mfma_f32_16x16x32_bf16 v[44:47], a[44:47], v[156:159], v[44:47]
    v_rcp_f32 v166, v166
    v_rcp_f32 v167, v167
    buffer_load_dwordx4 a[44:47], v2, s[44:47], s24 offen offset:3072
    s_waitcnt vmcnt(21)
    v_mfma_f32_16x16x32_bf16 v[96:99], a[48:51], v[144:147], v[96:99]
    v_mul_f32 v160, v160, v64
    v_mul_f32 v161, v161, v65
    v_mfma_f32_16x16x32_bf16 v[100:103], a[48:51], v[148:151], v[100:103]
    v_mul_f32 v162, v162, v66
    v_mul_f32 v163, v163, v67
    v_mfma_f32_16x16x32_bf16 v[104:107], a[48:51], v[152:155], v[104:107]
    v_mul_f32 v164, v164, v80
    v_mul_f32 v165, v165, v81
    v_mfma_f32_16x16x32_bf16 v[108:111], a[48:51], v[156:159], v[108:111]
    v_mul_f32 v166, v166, v82
    v_mul_f32 v167, v167, v83
    s_add_u32 s24, s15, 258048
    buffer_load_dwordx4 a[48:51], v2, s[44:47], s24 offen offset:0
    s_waitcnt vmcnt(21)
    v_mfma_f32_16x16x32_bf16 v[112:115], a[52:55], v[144:147], v[112:115]
    v_cvt_pk_bf16_f32 v64, v160, v161
    v_cvt_pk_bf16_f32 v65, v162, v163
    v_mfma_f32_16x16x32_bf16 v[116:119], a[52:55], v[148:151], v[116:119]
    v_cvt_pk_bf16_f32 v66, v164, v165
    v_cvt_pk_bf16_f32 v67, v166, v167
    v_mfma_f32_16x16x32_bf16 v[120:123], a[52:55], v[152:155], v[120:123]
    ds_write_b128 v10, v[64:67] offset:0
    v_mul_f32 v160, v68, v68
    v_mul_f32 v161, v69, v69
    v_mfma_f32_16x16x32_bf16 v[124:127], a[52:55], v[156:159], v[124:127]
    v_mul_f32 v162, v70, v70
    v_mul_f32 v163, v71, v71
    buffer_load_dwordx4 a[52:55], v2, s[44:47], s24 offen offset:1024
    s_waitcnt vmcnt(21) lgkmcnt(4)
    v_mfma_f32_16x16x32_bf16 v[16:19], a[56:59], v[128:131], v[16:19]
    v_mul_f32 v164, v84, v84
    v_mul_f32 v165, v85, v85
    s_waitcnt lgkmcnt(3)
    v_mfma_f32_16x16x32_bf16 v[20:23], a[56:59], v[132:135], v[20:23]
    ds_read_b128 v[144:147], v5 offset:12288
    v_mul_f32 v166, v86, v86
    v_mul_f32 v167, v87, v87
    s_waitcnt lgkmcnt(3)
    v_mfma_f32_16x16x32_bf16 v[24:27], a[56:59], v[136:139], v[24:27]
    ds_read_b128 v[148:151], v5 offset:13312
    v_fma_f32 v160, v160, v11, s62
    v_fma_f32 v161, v161, v11, s62
    s_waitcnt lgkmcnt(3)
    v_mfma_f32_16x16x32_bf16 v[28:31], a[56:59], v[140:143], v[28:31]
    ds_read_b128 v[152:155], v5 offset:14336
    v_fma_f32 v162, v162, v11, s62
    v_fma_f32 v163, v163, v11, s62
    buffer_load_dwordx4 a[56:59], v2, s[44:47], s24 offen offset:2048
    s_waitcnt vmcnt(21)
    v_mfma_f32_16x16x32_bf16 v[32:35], a[60:63], v[128:131], v[32:35]
    ds_read_b128 v[156:159], v5 offset:15360
    v_fma_f32 v164, v164, v11, s62
    v_fma_f32 v165, v165, v11, s62
    v_mfma_f32_16x16x32_bf16 v[36:39], a[60:63], v[132:135], v[36:39]
    v_fma_f32 v166, v166, v11, s62
    v_fma_f32 v167, v167, v11, s62
    v_mfma_f32_16x16x32_bf16 v[40:43], a[60:63], v[136:139], v[40:43]
    v_mul_f32 v160, v160, v68
    v_mul_f32 v161, v161, v69
    v_mfma_f32_16x16x32_bf16 v[44:47], a[60:63], v[140:143], v[44:47]
    v_mul_f32 v162, v162, v70
    v_mul_f32 v163, v163, v71
    buffer_load_dwordx4 a[60:63], v2, s[44:47], s24 offen offset:3072
    s_waitcnt vmcnt(21)
    v_mfma_f32_16x16x32_bf16 v[96:99], a[64:67], v[128:131], v[96:99]
    v_mul_f32 v164, v164, v84
    v_mul_f32 v165, v165, v85
    v_mfma_f32_16x16x32_bf16 v[100:103], a[64:67], v[132:135], v[100:103]
    v_mul_f32 v166, v166, v86
    v_mul_f32 v167, v167, v87
    v_mfma_f32_16x16x32_bf16 v[104:107], a[64:67], v[136:139], v[104:107]
    v_exp_f32 v160, v160
    v_exp_f32 v161, v161
    v_mfma_f32_16x16x32_bf16 v[108:111], a[64:67], v[140:143], v[108:111]
    v_exp_f32 v162, v162
    v_exp_f32 v163, v163
    s_add_u32 s24, s15, 294912
    buffer_load_dwordx4 a[64:67], v2, s[44:47], s24 offen offset:0
    s_waitcnt vmcnt(21)
    v_mfma_f32_16x16x32_bf16 v[112:115], a[68:71], v[128:131], v[112:115]
    v_exp_f32 v164, v164
    v_exp_f32 v165, v165
    v_mfma_f32_16x16x32_bf16 v[116:119], a[68:71], v[132:135], v[116:119]
    v_exp_f32 v166, v166
    v_exp_f32 v167, v167
    v_mfma_f32_16x16x32_bf16 v[120:123], a[68:71], v[136:139], v[120:123]
    v_add_f32 v160, 1.0, v160
    v_add_f32 v161, 1.0, v161
    v_mfma_f32_16x16x32_bf16 v[124:127], a[68:71], v[140:143], v[124:127]
    v_add_f32 v162, 1.0, v162
    v_add_f32 v163, 1.0, v163
    buffer_load_dwordx4 a[68:71], v2, s[44:47], s24 offen offset:1024
    s_waitcnt vmcnt(21) lgkmcnt(3)
    v_mfma_f32_16x16x32_bf16 v[16:19], a[72:75], v[144:147], v[16:19]
    v_add_f32 v164, 1.0, v164
    v_add_f32 v165, 1.0, v165
    s_waitcnt lgkmcnt(2)
    v_mfma_f32_16x16x32_bf16 v[20:23], a[72:75], v[148:151], v[20:23]
    ds_read_b128 v[128:131], v5 offset:16384
    v_add_f32 v166, 1.0, v166
    v_add_f32 v167, 1.0, v167
    s_waitcnt lgkmcnt(2)
    v_mfma_f32_16x16x32_bf16 v[24:27], a[72:75], v[152:155], v[24:27]
    ds_read_b128 v[132:135], v5 offset:17408
    v_rcp_f32 v160, v160
    v_rcp_f32 v161, v161
    s_waitcnt lgkmcnt(2)
    v_mfma_f32_16x16x32_bf16 v[28:31], a[72:75], v[156:159], v[28:31]
    ds_read_b128 v[136:139], v5 offset:18432
    v_rcp_f32 v162, v162
    v_rcp_f32 v163, v163
    buffer_load_dwordx4 a[72:75], v2, s[44:47], s24 offen offset:2048
    s_waitcnt vmcnt(21)
    v_mfma_f32_16x16x32_bf16 v[32:35], a[76:79], v[144:147], v[32:35]
    ds_read_b128 v[140:143], v5 offset:19456
    v_rcp_f32 v164, v164
    v_rcp_f32 v165, v165
    v_mfma_f32_16x16x32_bf16 v[36:39], a[76:79], v[148:151], v[36:39]
    v_rcp_f32 v166, v166
    v_rcp_f32 v167, v167
    v_mfma_f32_16x16x32_bf16 v[40:43], a[76:79], v[152:155], v[40:43]
    v_mul_f32 v160, v160, v68
    v_mul_f32 v161, v161, v69
    v_mfma_f32_16x16x32_bf16 v[44:47], a[76:79], v[156:159], v[44:47]
    v_mul_f32 v162, v162, v70
    v_mul_f32 v163, v163, v71
    buffer_load_dwordx4 a[76:79], v2, s[44:47], s24 offen offset:3072
    s_waitcnt vmcnt(21)
    v_mfma_f32_16x16x32_bf16 v[96:99], a[80:83], v[144:147], v[96:99]
    v_mul_f32 v164, v164, v84
    v_mul_f32 v165, v165, v85
    v_mfma_f32_16x16x32_bf16 v[100:103], a[80:83], v[148:151], v[100:103]
    v_mul_f32 v166, v166, v86
    v_mul_f32 v167, v167, v87
    v_mfma_f32_16x16x32_bf16 v[104:107], a[80:83], v[152:155], v[104:107]
    v_cvt_pk_bf16_f32 v68, v160, v161
    v_cvt_pk_bf16_f32 v69, v162, v163
    v_mfma_f32_16x16x32_bf16 v[108:111], a[80:83], v[156:159], v[108:111]
    v_cvt_pk_bf16_f32 v70, v164, v165
    v_cvt_pk_bf16_f32 v71, v166, v167
    s_add_u32 s24, s15, 331776
    buffer_load_dwordx4 a[80:83], v2, s[44:47], s24 offen offset:0
    s_waitcnt vmcnt(21)
    v_mfma_f32_16x16x32_bf16 v[112:115], a[84:87], v[144:147], v[112:115]
    ds_write_b128 v10, v[68:71] offset:1024
    v_mul_f32 v160, v72, v72
    v_mul_f32 v161, v73, v73
    v_mfma_f32_16x16x32_bf16 v[116:119], a[84:87], v[148:151], v[116:119]
    v_mul_f32 v162, v74, v74
    v_mul_f32 v163, v75, v75
    v_mfma_f32_16x16x32_bf16 v[120:123], a[84:87], v[152:155], v[120:123]
    v_mul_f32 v164, v88, v88
    v_mul_f32 v165, v89, v89
    v_mfma_f32_16x16x32_bf16 v[124:127], a[84:87], v[156:159], v[124:127]
    v_mul_f32 v166, v90, v90
    v_mul_f32 v167, v91, v91
    buffer_load_dwordx4 a[84:87], v2, s[44:47], s24 offen offset:1024
    s_waitcnt vmcnt(21) lgkmcnt(4)
    v_mfma_f32_16x16x32_bf16 v[16:19], a[0:3], v[128:131], v[16:19]
    v_fma_f32 v160, v160, v11, s62
    v_fma_f32 v161, v161, v11, s62
    s_waitcnt lgkmcnt(3)
    v_mfma_f32_16x16x32_bf16 v[20:23], a[0:3], v[132:135], v[20:23]
    ds_read_b128 v[144:147], v5 offset:20480
    v_fma_f32 v162, v162, v11, s62
    v_fma_f32 v163, v163, v11, s62
    s_waitcnt lgkmcnt(3)
    v_mfma_f32_16x16x32_bf16 v[24:27], a[0:3], v[136:139], v[24:27]
    ds_read_b128 v[148:151], v5 offset:21504
    v_fma_f32 v164, v164, v11, s62
    v_fma_f32 v165, v165, v11, s62
    s_waitcnt lgkmcnt(3)
    v_mfma_f32_16x16x32_bf16 v[28:31], a[0:3], v[140:143], v[28:31]
    ds_read_b128 v[152:155], v5 offset:22528
    v_fma_f32 v166, v166, v11, s62
    v_fma_f32 v167, v167, v11, s62
    buffer_load_dwordx4 a[0:3], v2, s[44:47], s24 offen offset:2048
    s_waitcnt vmcnt(21)
    v_mfma_f32_16x16x32_bf16 v[32:35], a[4:7], v[128:131], v[32:35]
    ds_read_b128 v[156:159], v5 offset:23552
    v_mul_f32 v160, v160, v72
    v_mul_f32 v161, v161, v73
    v_mfma_f32_16x16x32_bf16 v[36:39], a[4:7], v[132:135], v[36:39]
    v_mul_f32 v162, v162, v74
    v_mul_f32 v163, v163, v75
    v_mfma_f32_16x16x32_bf16 v[40:43], a[4:7], v[136:139], v[40:43]
    v_mul_f32 v164, v164, v88
    v_mul_f32 v165, v165, v89
    v_mfma_f32_16x16x32_bf16 v[44:47], a[4:7], v[140:143], v[44:47]
    v_mul_f32 v166, v166, v90
    v_mul_f32 v167, v167, v91
    buffer_load_dwordx4 a[4:7], v2, s[44:47], s24 offen offset:3072
    s_waitcnt vmcnt(21)
    v_mfma_f32_16x16x32_bf16 v[96:99], a[8:11], v[128:131], v[96:99]
    v_exp_f32 v160, v160
    v_exp_f32 v161, v161
    v_mfma_f32_16x16x32_bf16 v[100:103], a[8:11], v[132:135], v[100:103]
    v_exp_f32 v162, v162
    v_exp_f32 v163, v163
    v_mfma_f32_16x16x32_bf16 v[104:107], a[8:11], v[136:139], v[104:107]
    v_exp_f32 v164, v164
    v_exp_f32 v165, v165
    v_mfma_f32_16x16x32_bf16 v[108:111], a[8:11], v[140:143], v[108:111]
    v_exp_f32 v166, v166
    v_exp_f32 v167, v167
    s_add_u32 s24, s15, 368640
    buffer_load_dwordx4 a[8:11], v2, s[44:47], s24 offen offset:0
    s_waitcnt vmcnt(21)
    v_mfma_f32_16x16x32_bf16 v[112:115], a[12:15], v[128:131], v[112:115]
    v_add_f32 v160, 1.0, v160
    v_add_f32 v161, 1.0, v161
    v_mfma_f32_16x16x32_bf16 v[116:119], a[12:15], v[132:135], v[116:119]
    v_add_f32 v162, 1.0, v162
    v_add_f32 v163, 1.0, v163
    v_mfma_f32_16x16x32_bf16 v[120:123], a[12:15], v[136:139], v[120:123]
    v_add_f32 v164, 1.0, v164
    v_add_f32 v165, 1.0, v165
    v_mfma_f32_16x16x32_bf16 v[124:127], a[12:15], v[140:143], v[124:127]
    v_add_f32 v166, 1.0, v166
    v_add_f32 v167, 1.0, v167
    buffer_load_dwordx4 a[12:15], v2, s[44:47], s24 offen offset:1024
    s_waitcnt vmcnt(21) lgkmcnt(3)
    v_mfma_f32_16x16x32_bf16 v[16:19], a[16:19], v[144:147], v[16:19]
    v_rcp_f32 v160, v160
    v_rcp_f32 v161, v161
    s_waitcnt lgkmcnt(2)
    v_mfma_f32_16x16x32_bf16 v[20:23], a[16:19], v[148:151], v[20:23]
    ds_read_b128 v[128:131], v5 offset:24576
    v_rcp_f32 v162, v162
    v_rcp_f32 v163, v163
    s_waitcnt lgkmcnt(2)
    v_mfma_f32_16x16x32_bf16 v[24:27], a[16:19], v[152:155], v[24:27]
    ds_read_b128 v[132:135], v5 offset:25600
    v_rcp_f32 v164, v164
    v_rcp_f32 v165, v165
    s_waitcnt lgkmcnt(2)
    v_mfma_f32_16x16x32_bf16 v[28:31], a[16:19], v[156:159], v[28:31]
    ds_read_b128 v[136:139], v5 offset:26624
    v_rcp_f32 v166, v166
    v_rcp_f32 v167, v167
    s_add_u32 s24, s15, 405504
    buffer_load_dwordx4 a[16:19], v2, s[44:47], s24 offen offset:0
    s_waitcnt vmcnt(21)
    v_mfma_f32_16x16x32_bf16 v[32:35], a[20:23], v[144:147], v[32:35]
    ds_read_b128 v[140:143], v5 offset:27648
    v_mul_f32 v160, v160, v72
    v_mul_f32 v161, v161, v73
    v_mfma_f32_16x16x32_bf16 v[36:39], a[20:23], v[148:151], v[36:39]
    v_mul_f32 v162, v162, v74
    v_mul_f32 v163, v163, v75
    v_mfma_f32_16x16x32_bf16 v[40:43], a[20:23], v[152:155], v[40:43]
    v_mul_f32 v164, v164, v88
    v_mul_f32 v165, v165, v89
    v_mfma_f32_16x16x32_bf16 v[44:47], a[20:23], v[156:159], v[44:47]
    v_mul_f32 v166, v166, v90
    v_mul_f32 v167, v167, v91
    buffer_load_dwordx4 a[20:23], v2, s[44:47], s24 offen offset:1024
    s_waitcnt vmcnt(21)
    v_mfma_f32_16x16x32_bf16 v[96:99], a[24:27], v[144:147], v[96:99]
    v_cvt_pk_bf16_f32 v72, v160, v161
    v_cvt_pk_bf16_f32 v73, v162, v163
    v_mfma_f32_16x16x32_bf16 v[100:103], a[24:27], v[148:151], v[100:103]
    v_cvt_pk_bf16_f32 v74, v164, v165
    v_cvt_pk_bf16_f32 v75, v166, v167
    v_mfma_f32_16x16x32_bf16 v[104:107], a[24:27], v[152:155], v[104:107]
    ds_write_b128 v10, v[72:75] offset:2048
    v_mul_f32 v160, v76, v76
    v_mul_f32 v161, v77, v77
    v_mfma_f32_16x16x32_bf16 v[108:111], a[24:27], v[156:159], v[108:111]
    v_mul_f32 v162, v78, v78
    v_mul_f32 v163, v79, v79
    s_add_u32 s24, s15, 442368
    buffer_load_dwordx4 a[24:27], v2, s[44:47], s24 offen offset:0
    s_waitcnt vmcnt(21)
    v_mfma_f32_16x16x32_bf16 v[112:115], a[28:31], v[144:147], v[112:115]
    v_mul_f32 v164, v92, v92
    v_mul_f32 v165, v93, v93
    v_mfma_f32_16x16x32_bf16 v[116:119], a[28:31], v[148:151], v[116:119]
    v_mul_f32 v166, v94, v94
    v_mul_f32 v167, v95, v95
    v_mfma_f32_16x16x32_bf16 v[120:123], a[28:31], v[152:155], v[120:123]
    v_fma_f32 v160, v160, v11, s62
    v_fma_f32 v161, v161, v11, s62
    v_mfma_f32_16x16x32_bf16 v[124:127], a[28:31], v[156:159], v[124:127]
    v_fma_f32 v162, v162, v11, s62
    v_fma_f32 v163, v163, v11, s62
    buffer_load_dwordx4 a[28:31], v2, s[44:47], s24 offen offset:1024
    s_waitcnt vmcnt(21) lgkmcnt(4)
    v_mfma_f32_16x16x32_bf16 v[16:19], a[32:35], v[128:131], v[16:19]
    v_fma_f32 v164, v164, v11, s62
    v_fma_f32 v165, v165, v11, s62
    s_waitcnt lgkmcnt(3)
    v_mfma_f32_16x16x32_bf16 v[20:23], a[32:35], v[132:135], v[20:23]
    ds_read_b128 v[144:147], v5 offset:28672
    v_fma_f32 v166, v166, v11, s62
    v_fma_f32 v167, v167, v11, s62
    s_waitcnt lgkmcnt(3)
    v_mfma_f32_16x16x32_bf16 v[24:27], a[32:35], v[136:139], v[24:27]
    ds_read_b128 v[148:151], v5 offset:29696
    v_mul_f32 v160, v160, v76
    v_mul_f32 v161, v161, v77
    s_waitcnt lgkmcnt(3)
    v_mfma_f32_16x16x32_bf16 v[28:31], a[32:35], v[140:143], v[28:31]
    ds_read_b128 v[152:155], v5 offset:30720
    v_mul_f32 v162, v162, v78
    v_mul_f32 v163, v163, v79
    s_add_u32 s24, s15, 479232
    buffer_load_dwordx4 a[32:35], v2, s[44:47], s24 offen offset:0
    s_waitcnt vmcnt(21)
    v_mfma_f32_16x16x32_bf16 v[32:35], a[36:39], v[128:131], v[32:35]
    ds_read_b128 v[156:159], v5 offset:31744
    v_mul_f32 v164, v164, v92
    v_mul_f32 v165, v165, v93
    v_mfma_f32_16x16x32_bf16 v[36:39], a[36:39], v[132:135], v[36:39]
    v_mul_f32 v166, v166, v94
    v_mul_f32 v167, v167, v95
    v_mfma_f32_16x16x32_bf16 v[40:43], a[36:39], v[136:139], v[40:43]
    v_exp_f32 v160, v160
    v_exp_f32 v161, v161
    v_mfma_f32_16x16x32_bf16 v[44:47], a[36:39], v[140:143], v[44:47]
    v_exp_f32 v162, v162
    v_exp_f32 v163, v163
    buffer_load_dwordx4 a[36:39], v2, s[44:47], s24 offen offset:1024
    s_waitcnt vmcnt(21)
    v_mfma_f32_16x16x32_bf16 v[96:99], a[40:43], v[128:131], v[96:99]
    v_exp_f32 v164, v164
    v_exp_f32 v165, v165
    v_mfma_f32_16x16x32_bf16 v[100:103], a[40:43], v[132:135], v[100:103]
    v_exp_f32 v166, v166
    v_exp_f32 v167, v167
    v_mfma_f32_16x16x32_bf16 v[104:107], a[40:43], v[136:139], v[104:107]
    v_add_f32 v160, 1.0, v160
    v_add_f32 v161, 1.0, v161
    v_mfma_f32_16x16x32_bf16 v[108:111], a[40:43], v[140:143], v[108:111]
    v_add_f32 v162, 1.0, v162
    v_add_f32 v163, 1.0, v163
    s_add_u32 s24, s15, 516096
    buffer_load_dwordx4 a[40:43], v2, s[44:47], s24 offen offset:0
    s_waitcnt vmcnt(21)
    v_mfma_f32_16x16x32_bf16 v[112:115], a[44:47], v[128:131], v[112:115]
    v_add_f32 v164, 1.0, v164
    v_add_f32 v165, 1.0, v165
    v_mfma_f32_16x16x32_bf16 v[116:119], a[44:47], v[132:135], v[116:119]
    v_add_f32 v166, 1.0, v166
    v_add_f32 v167, 1.0, v167
    v_mfma_f32_16x16x32_bf16 v[120:123], a[44:47], v[136:139], v[120:123]
    v_rcp_f32 v160, v160
    v_rcp_f32 v161, v161
    v_mfma_f32_16x16x32_bf16 v[124:127], a[44:47], v[140:143], v[124:127]
    v_rcp_f32 v162, v162
    v_rcp_f32 v163, v163
    buffer_load_dwordx4 a[44:47], v2, s[44:47], s24 offen offset:1024
    s_waitcnt vmcnt(21) lgkmcnt(3)
    v_mfma_f32_16x16x32_bf16 v[16:19], a[48:51], v[144:147], v[16:19]
    v_rcp_f32 v164, v164
    v_rcp_f32 v165, v165
    s_waitcnt lgkmcnt(2)
    v_mfma_f32_16x16x32_bf16 v[20:23], a[48:51], v[148:151], v[20:23]
    ds_read_b128 v[128:131], v5 offset:32768
    v_rcp_f32 v166, v166
    v_rcp_f32 v167, v167
    s_waitcnt lgkmcnt(2)
    v_mfma_f32_16x16x32_bf16 v[24:27], a[48:51], v[152:155], v[24:27]
    ds_read_b128 v[132:135], v5 offset:33792
    v_mul_f32 v160, v160, v76
    v_mul_f32 v161, v161, v77
    s_waitcnt lgkmcnt(2)
    v_mfma_f32_16x16x32_bf16 v[28:31], a[48:51], v[156:159], v[28:31]
    ds_read_b128 v[136:139], v5 offset:34816
    v_mul_f32 v162, v162, v78
    v_mul_f32 v163, v163, v79
    s_add_u32 s24, s15, 552960
    buffer_load_dwordx4 a[48:51], v2, s[44:47], s24 offen offset:0
    s_waitcnt vmcnt(21)
    v_mfma_f32_16x16x32_bf16 v[32:35], a[52:55], v[144:147], v[32:35]
    ds_read_b128 v[140:143], v5 offset:35840
    v_mul_f32 v164, v164, v92
    v_mul_f32 v165, v165, v93
    v_mfma_f32_16x16x32_bf16 v[36:39], a[52:55], v[148:151], v[36:39]
    v_mul_f32 v166, v166, v94
    v_mul_f32 v167, v167, v95
    v_mfma_f32_16x16x32_bf16 v[40:43], a[52:55], v[152:155], v[40:43]
    v_cvt_pk_bf16_f32 v76, v160, v161
    v_cvt_pk_bf16_f32 v77, v162, v163
    v_mfma_f32_16x16x32_bf16 v[44:47], a[52:55], v[156:159], v[44:47]
    v_cvt_pk_bf16_f32 v78, v164, v165
    v_cvt_pk_bf16_f32 v79, v166, v167
    buffer_load_dwordx4 a[52:55], v2, s[44:47], s24 offen offset:1024
    s_waitcnt vmcnt(21)
    v_mfma_f32_16x16x32_bf16 v[96:99], a[56:59], v[144:147], v[96:99]
    ds_write_b128 v10, v[76:79] offset:3072
    v_mfma_f32_16x16x32_bf16 v[100:103], a[56:59], v[148:151], v[100:103]
    v_mfma_f32_16x16x32_bf16 v[104:107], a[56:59], v[152:155], v[104:107]
    v_mfma_f32_16x16x32_bf16 v[108:111], a[56:59], v[156:159], v[108:111]
    s_add_u32 s24, s15, 589824
    buffer_load_dwordx4 a[56:59], v2, s[44:47], s24 offen offset:0
    s_waitcnt vmcnt(21)
    v_mfma_f32_16x16x32_bf16 v[112:115], a[60:63], v[144:147], v[112:115]
    v_mfma_f32_16x16x32_bf16 v[116:119], a[60:63], v[148:151], v[116:119]
    v_mfma_f32_16x16x32_bf16 v[120:123], a[60:63], v[152:155], v[120:123]
    v_mfma_f32_16x16x32_bf16 v[124:127], a[60:63], v[156:159], v[124:127]
    buffer_load_dwordx4 a[60:63], v2, s[44:47], s24 offen offset:1024
    s_waitcnt vmcnt(21) lgkmcnt(4)
    v_mfma_f32_16x16x32_bf16 v[16:19], a[64:67], v[128:131], v[16:19]
    s_waitcnt lgkmcnt(3)
    v_mfma_f32_16x16x32_bf16 v[20:23], a[64:67], v[132:135], v[20:23]
    ds_read_b128 v[144:147], v6 offset:0
    s_waitcnt lgkmcnt(3)
    v_mfma_f32_16x16x32_bf16 v[24:27], a[64:67], v[136:139], v[24:27]
    ds_read_b128 v[148:151], v6 offset:1024
    s_waitcnt lgkmcnt(3)
    v_mfma_f32_16x16x32_bf16 v[28:31], a[64:67], v[140:143], v[28:31]
    ds_read_b128 v[152:155], v6 offset:2048
    s_add_u32 s24, s15, 626688
    buffer_load_dwordx4 a[64:67], v2, s[44:47], s24 offen offset:0
    s_waitcnt vmcnt(21)
    v_mfma_f32_16x16x32_bf16 v[32:35], a[68:71], v[128:131], v[32:35]
    ds_read_b128 v[156:159], v6 offset:3072
    v_mfma_f32_16x16x32_bf16 v[36:39], a[68:71], v[132:135], v[36:39]
    v_mfma_f32_16x16x32_bf16 v[40:43], a[68:71], v[136:139], v[40:43]
    v_mfma_f32_16x16x32_bf16 v[44:47], a[68:71], v[140:143], v[44:47]
    buffer_load_dwordx4 a[68:71], v2, s[44:47], s24 offen offset:1024
    s_waitcnt vmcnt(21)
    v_mfma_f32_16x16x32_bf16 v[96:99], a[72:75], v[128:131], v[96:99]
    v_mfma_f32_16x16x32_bf16 v[100:103], a[72:75], v[132:135], v[100:103]
    v_mfma_f32_16x16x32_bf16 v[104:107], a[72:75], v[136:139], v[104:107]
    v_mfma_f32_16x16x32_bf16 v[108:111], a[72:75], v[140:143], v[108:111]
    s_add_u32 s24, s15, 368640
    buffer_load_dwordx4 a[72:75], v2, s[44:47], s24 offen offset:2048
    s_waitcnt vmcnt(21)
    v_mfma_f32_16x16x32_bf16 v[112:115], a[76:79], v[128:131], v[112:115]
    v_mfma_f32_16x16x32_bf16 v[116:119], a[76:79], v[132:135], v[116:119]
    v_mfma_f32_16x16x32_bf16 v[120:123], a[76:79], v[136:139], v[120:123]
    v_mfma_f32_16x16x32_bf16 v[124:127], a[76:79], v[140:143], v[124:127]
    buffer_load_dwordx4 a[76:79], v2, s[44:47], s24 offen offset:3072
    s_waitcnt vmcnt(21) lgkmcnt(3)
    v_mfma_f32_16x16x32_bf16 v[16:19], a[80:83], v[144:147], v[16:19]
    s_waitcnt lgkmcnt(2)
    v_mfma_f32_16x16x32_bf16 v[20:23], a[80:83], v[148:151], v[20:23]
    s_waitcnt lgkmcnt(1)
    v_mfma_f32_16x16x32_bf16 v[24:27], a[80:83], v[152:155], v[24:27]
    s_waitcnt lgkmcnt(0)
    v_mfma_f32_16x16x32_bf16 v[28:31], a[80:83], v[156:159], v[28:31]
    s_add_u32 s24, s15, 405504
    buffer_load_dwordx4 a[80:83], v2, s[44:47], s24 offen offset:2048
    s_waitcnt vmcnt(21)
    v_mfma_f32_16x16x32_bf16 v[32:35], a[84:87], v[144:147], v[32:35]
    v_mfma_f32_16x16x32_bf16 v[36:39], a[84:87], v[148:151], v[36:39]
    v_mfma_f32_16x16x32_bf16 v[40:43], a[84:87], v[152:155], v[40:43]
    v_mfma_f32_16x16x32_bf16 v[44:47], a[84:87], v[156:159], v[44:47]
    buffer_load_dwordx4 a[84:87], v2, s[44:47], s24 offen offset:3072
    s_waitcnt vmcnt(21)
    v_mfma_f32_16x16x32_bf16 v[96:99], a[0:3], v[144:147], v[96:99]
    v_mfma_f32_16x16x32_bf16 v[100:103], a[0:3], v[148:151], v[100:103]
    v_mfma_f32_16x16x32_bf16 v[104:107], a[0:3], v[152:155], v[104:107]
    v_mfma_f32_16x16x32_bf16 v[108:111], a[0:3], v[156:159], v[108:111]
    s_add_u32 s24, s15, 442368
    buffer_load_dwordx4 a[0:3], v2, s[44:47], s24 offen offset:2048
    s_waitcnt vmcnt(21)
    v_mfma_f32_16x16x32_bf16 v[112:115], a[4:7], v[144:147], v[112:115]
    v_mfma_f32_16x16x32_bf16 v[116:119], a[4:7], v[148:151], v[116:119]
    v_mfma_f32_16x16x32_bf16 v[120:123], a[4:7], v[152:155], v[120:123]
    v_mfma_f32_16x16x32_bf16 v[124:127], a[4:7], v[156:159], v[124:127]
    buffer_load_dwordx4 a[4:7], v2, s[44:47], s24 offen offset:3072
    s_waitcnt lgkmcnt(0)
    s_barrier
    ds_read_b128 v[128:131], v6 offset:4096
    ds_read_b128 v[132:135], v6 offset:5120
    ds_read_b128 v[136:139], v6 offset:6144
    ds_read_b128 v[140:143], v6 offset:7168
    s_waitcnt vmcnt(21) lgkmcnt(3)
    v_mfma_f32_16x16x32_bf16 v[16:19], a[8:11], v[128:131], v[16:19]
    s_waitcnt lgkmcnt(2)
    v_mfma_f32_16x16x32_bf16 v[20:23], a[8:11], v[132:135], v[20:23]
    ds_read_b128 v[144:147], v6 offset:8192
    s_waitcnt lgkmcnt(2)
    v_mfma_f32_16x16x32_bf16 v[24:27], a[8:11], v[136:139], v[24:27]
    ds_read_b128 v[148:151], v6 offset:9216
    s_waitcnt lgkmcnt(2)
    v_mfma_f32_16x16x32_bf16 v[28:31], a[8:11], v[140:143], v[28:31]
    ds_read_b128 v[152:155], v6 offset:10240
    s_add_u32 s24, s15, 479232
    buffer_load_dwordx4 a[8:11], v2, s[44:47], s24 offen offset:2048
    s_waitcnt vmcnt(21)
    v_mfma_f32_16x16x32_bf16 v[32:35], a[12:15], v[128:131], v[32:35]
    ds_read_b128 v[156:159], v6 offset:11264
    v_mfma_f32_16x16x32_bf16 v[36:39], a[12:15], v[132:135], v[36:39]
    v_mfma_f32_16x16x32_bf16 v[40:43], a[12:15], v[136:139], v[40:43]
    v_mfma_f32_16x16x32_bf16 v[44:47], a[12:15], v[140:143], v[44:47]
    buffer_load_dwordx4 a[12:15], v2, s[44:47], s24 offen offset:3072
    s_waitcnt vmcnt(21) lgkmcnt(3)
    v_mfma_f32_16x16x32_bf16 v[16:19], a[16:19], v[144:147], v[16:19]
    s_waitcnt lgkmcnt(2)
    v_mfma_f32_16x16x32_bf16 v[20:23], a[16:19], v[148:151], v[20:23]
    ds_read_b128 v[128:131], v6 offset:12288
    s_waitcnt lgkmcnt(2)
    v_mfma_f32_16x16x32_bf16 v[24:27], a[16:19], v[152:155], v[24:27]
    ds_read_b128 v[132:135], v6 offset:13312
    s_waitcnt lgkmcnt(2)
    v_mfma_f32_16x16x32_bf16 v[28:31], a[16:19], v[156:159], v[28:31]
    ds_read_b128 v[136:139], v6 offset:14336
    s_add_u32 s24, s15, 516096
    buffer_load_dwordx4 a[16:19], v2, s[44:47], s24 offen offset:2048
    s_waitcnt vmcnt(21)
    v_mfma_f32_16x16x32_bf16 v[32:35], a[20:23], v[144:147], v[32:35]
    ds_read_b128 v[140:143], v6 offset:15360
    v_mfma_f32_16x16x32_bf16 v[36:39], a[20:23], v[148:151], v[36:39]
    v_mfma_f32_16x16x32_bf16 v[40:43], a[20:23], v[152:155], v[40:43]
    v_mfma_f32_16x16x32_bf16 v[44:47], a[20:23], v[156:159], v[44:47]
    buffer_load_dwordx4 a[20:23], v2, s[44:47], s24 offen offset:3072
    s_waitcnt vmcnt(21) lgkmcnt(3)
    v_mfma_f32_16x16x32_bf16 v[16:19], a[24:27], v[128:131], v[16:19]
    s_waitcnt lgkmcnt(2)
    v_mfma_f32_16x16x32_bf16 v[20:23], a[24:27], v[132:135], v[20:23]
    ds_read_b128 v[144:147], v6 offset:16384
    s_waitcnt lgkmcnt(2)
    v_mfma_f32_16x16x32_bf16 v[24:27], a[24:27], v[136:139], v[24:27]
    ds_read_b128 v[148:151], v6 offset:17408
    s_waitcnt lgkmcnt(2)
    v_mfma_f32_16x16x32_bf16 v[28:31], a[24:27], v[140:143], v[28:31]
    ds_read_b128 v[152:155], v6 offset:18432
    s_add_u32 s24, s15, 552960
    buffer_load_dwordx4 a[24:27], v2, s[44:47], s24 offen offset:2048
    s_waitcnt vmcnt(21)
    v_mfma_f32_16x16x32_bf16 v[32:35], a[28:31], v[128:131], v[32:35]
    ds_read_b128 v[156:159], v6 offset:19456
    v_mfma_f32_16x16x32_bf16 v[36:39], a[28:31], v[132:135], v[36:39]
    v_mfma_f32_16x16x32_bf16 v[40:43], a[28:31], v[136:139], v[40:43]
    v_mfma_f32_16x16x32_bf16 v[44:47], a[28:31], v[140:143], v[44:47]
    buffer_load_dwordx4 a[28:31], v2, s[44:47], s24 offen offset:3072
    s_waitcnt vmcnt(21) lgkmcnt(3)
    v_mfma_f32_16x16x32_bf16 v[16:19], a[32:35], v[144:147], v[16:19]
    s_waitcnt lgkmcnt(2)
    v_mfma_f32_16x16x32_bf16 v[20:23], a[32:35], v[148:151], v[20:23]
    ds_read_b128 v[128:131], v6 offset:20480
    s_waitcnt lgkmcnt(2)
    v_mfma_f32_16x16x32_bf16 v[24:27], a[32:35], v[152:155], v[24:27]
    ds_read_b128 v[132:135], v6 offset:21504
    s_waitcnt lgkmcnt(2)
    v_mfma_f32_16x16x32_bf16 v[28:31], a[32:35], v[156:159], v[28:31]
    ds_read_b128 v[136:139], v6 offset:22528
    s_add_u32 s24, s15, 589824
    buffer_load_dwordx4 a[32:35], v2, s[44:47], s24 offen offset:2048
    s_waitcnt vmcnt(21)
    v_mfma_f32_16x16x32_bf16 v[32:35], a[36:39], v[144:147], v[32:35]
    ds_read_b128 v[140:143], v6 offset:23552
    v_mfma_f32_16x16x32_bf16 v[36:39], a[36:39], v[148:151], v[36:39]
    v_mfma_f32_16x16x32_bf16 v[40:43], a[36:39], v[152:155], v[40:43]
    v_mfma_f32_16x16x32_bf16 v[44:47], a[36:39], v[156:159], v[44:47]
    buffer_load_dwordx4 a[36:39], v2, s[44:47], s24 offen offset:3072
    s_waitcnt vmcnt(21) lgkmcnt(3)
    v_mfma_f32_16x16x32_bf16 v[16:19], a[40:43], v[128:131], v[16:19]
    s_waitcnt lgkmcnt(2)
    v_mfma_f32_16x16x32_bf16 v[20:23], a[40:43], v[132:135], v[20:23]
    ds_read_b128 v[144:147], v6 offset:24576
    s_waitcnt lgkmcnt(2)
    v_mfma_f32_16x16x32_bf16 v[24:27], a[40:43], v[136:139], v[24:27]
    ds_read_b128 v[148:151], v6 offset:25600
    s_waitcnt lgkmcnt(2)
    v_mfma_f32_16x16x32_bf16 v[28:31], a[40:43], v[140:143], v[28:31]
    ds_read_b128 v[152:155], v6 offset:26624
    s_add_u32 s24, s15, 626688
    buffer_load_dwordx4 a[40:43], v2, s[44:47], s24 offen offset:2048
    s_waitcnt vmcnt(21)
    v_mfma_f32_16x16x32_bf16 v[32:35], a[44:47], v[128:131], v[32:35]
    ds_read_b128 v[156:159], v6 offset:27648
    v_mfma_f32_16x16x32_bf16 v[36:39], a[44:47], v[132:135], v[36:39]
    v_mfma_f32_16x16x32_bf16 v[40:43], a[44:47], v[136:139], v[40:43]
    v_mfma_f32_16x16x32_bf16 v[44:47], a[44:47], v[140:143], v[44:47]
    buffer_load_dwordx4 a[44:47], v2, s[44:47], s24 offen offset:3072
    s_waitcnt vmcnt(21) lgkmcnt(3)
    v_mfma_f32_16x16x32_bf16 v[16:19], a[48:51], v[144:147], v[16:19]
    s_waitcnt lgkmcnt(2)
    v_mfma_f32_16x16x32_bf16 v[20:23], a[48:51], v[148:151], v[20:23]
    ds_read_b128 v[128:131], v6 offset:28672
    s_waitcnt lgkmcnt(2)
    v_mfma_f32_16x16x32_bf16 v[24:27], a[48:51], v[152:155], v[24:27]
    ds_read_b128 v[132:135], v6 offset:29696
    s_waitcnt lgkmcnt(2)
    v_mfma_f32_16x16x32_bf16 v[28:31], a[48:51], v[156:159], v[28:31]
    ds_read_b128 v[136:139], v6 offset:30720
    s_waitcnt vmcnt(20)
    v_mfma_f32_16x16x32_bf16 v[32:35], a[52:55], v[144:147], v[32:35]
    ds_read_b128 v[140:143], v6 offset:31744
    v_mfma_f32_16x16x32_bf16 v[36:39], a[52:55], v[148:151], v[36:39]
    v_mfma_f32_16x16x32_bf16 v[40:43], a[52:55], v[152:155], v[40:43]
    v_mfma_f32_16x16x32_bf16 v[44:47], a[52:55], v[156:159], v[44:47]
    s_waitcnt vmcnt(19) lgkmcnt(3)
    v_mfma_f32_16x16x32_bf16 v[16:19], a[56:59], v[128:131], v[16:19]
    s_waitcnt lgkmcnt(2)
    v_mfma_f32_16x16x32_bf16 v[20:23], a[56:59], v[132:135], v[20:23]
    ds_read_b128 v[144:147], v6 offset:32768
    s_waitcnt lgkmcnt(2)
    v_mfma_f32_16x16x32_bf16 v[24:27], a[56:59], v[136:139], v[24:27]
    ds_read_b128 v[148:151], v6 offset:33792
    s_waitcnt lgkmcnt(2)
    v_mfma_f32_16x16x32_bf16 v[28:31], a[56:59], v[140:143], v[28:31]
    ds_read_b128 v[152:155], v6 offset:34816
    s_waitcnt vmcnt(18)
    v_mfma_f32_16x16x32_bf16 v[32:35], a[60:63], v[128:131], v[32:35]
    ds_read_b128 v[156:159], v6 offset:35840
    v_mfma_f32_16x16x32_bf16 v[36:39], a[60:63], v[132:135], v[36:39]
    v_mfma_f32_16x16x32_bf16 v[40:43], a[60:63], v[136:139], v[40:43]
    v_mfma_f32_16x16x32_bf16 v[44:47], a[60:63], v[140:143], v[44:47]
    s_waitcnt vmcnt(17) lgkmcnt(3)
    v_mfma_f32_16x16x32_bf16 v[16:19], a[64:67], v[144:147], v[16:19]
    s_waitcnt lgkmcnt(2)
    v_mfma_f32_16x16x32_bf16 v[20:23], a[64:67], v[148:151], v[20:23]
    s_waitcnt lgkmcnt(1)
    v_mfma_f32_16x16x32_bf16 v[24:27], a[64:67], v[152:155], v[24:27]
    s_waitcnt lgkmcnt(0)
    v_mfma_f32_16x16x32_bf16 v[28:31], a[64:67], v[156:159], v[28:31]
    s_waitcnt vmcnt(16)
    v_mfma_f32_16x16x32_bf16 v[32:35], a[68:71], v[144:147], v[32:35]
    v_mfma_f32_16x16x32_bf16 v[36:39], a[68:71], v[148:151], v[36:39]
    v_mfma_f32_16x16x32_bf16 v[40:43], a[68:71], v[152:155], v[40:43]
    v_mfma_f32_16x16x32_bf16 v[44:47], a[68:71], v[156:159], v[44:47]
    s_barrier
    ds_read_b128 v[128:131], v6 offset:4096
    ds_read_b128 v[132:135], v6 offset:5120
    ds_read_b128 v[136:139], v6 offset:6144
    ds_read_b128 v[140:143], v6 offset:7168
    s_waitcnt vmcnt(15) lgkmcnt(3)
    v_mfma_f32_16x16x32_bf16 v[96:99], a[72:75], v[128:131], v[96:99]
    s_waitcnt lgkmcnt(2)
    v_mfma_f32_16x16x32_bf16 v[100:103], a[72:75], v[132:135], v[100:103]
    ds_read_b128 v[144:147], v6 offset:8192
    v_cvt_pk_bf16_f32 v160, v16, v17
    s_waitcnt lgkmcnt(2)
    v_mfma_f32_16x16x32_bf16 v[104:107], a[72:75], v[136:139], v[104:107]
    ds_read_b128 v[148:151], v6 offset:9216
    s_waitcnt lgkmcnt(2)
    v_mfma_f32_16x16x32_bf16 v[108:111], a[72:75], v[140:143], v[108:111]
    ds_read_b128 v[152:155], v6 offset:10240
    v_cvt_pk_bf16_f32 v161, v18, v19
    s_waitcnt vmcnt(14)
    v_mfma_f32_16x16x32_bf16 v[112:115], a[76:79], v[128:131], v[112:115]
    ds_read_b128 v[156:159], v6 offset:11264
    v_mfma_f32_16x16x32_bf16 v[116:119], a[76:79], v[132:135], v[116:119]
    v_cvt_pk_bf16_f32 v162, v32, v33
    v_mfma_f32_16x16x32_bf16 v[120:123], a[76:79], v[136:139], v[120:123]
    v_mfma_f32_16x16x32_bf16 v[124:127], a[76:79], v[140:143], v[124:127]
    v_cvt_pk_bf16_f32 v163, v34, v35
    s_waitcnt vmcnt(13) lgkmcnt(3)
    v_mfma_f32_16x16x32_bf16 v[96:99], a[80:83], v[144:147], v[96:99]
    s_waitcnt lgkmcnt(2)
    v_mfma_f32_16x16x32_bf16 v[100:103], a[80:83], v[148:151], v[100:103]
    ds_read_b128 v[128:131], v6 offset:12288
    s_add_u32 s30, s28, 0
    s_waitcnt lgkmcnt(2)
    v_mfma_f32_16x16x32_bf16 v[104:107], a[80:83], v[152:155], v[104:107]
    ds_read_b128 v[132:135], v6 offset:13312
    s_waitcnt lgkmcnt(2)
    v_mfma_f32_16x16x32_bf16 v[108:111], a[80:83], v[156:159], v[108:111]
    ds_read_b128 v[136:139], v6 offset:14336
    buffer_store_dwordx4 v[160:163], v3, s[44:47], s30 offen offset:0 sc1
    s_waitcnt vmcnt(13)
    v_mfma_f32_16x16x32_bf16 v[112:115], a[84:87], v[144:147], v[112:115]
    ds_read_b128 v[140:143], v6 offset:15360
    v_mfma_f32_16x16x32_bf16 v[116:119], a[84:87], v[148:151], v[116:119]
    v_cvt_pk_bf16_f32 v164, v20, v21
    v_mfma_f32_16x16x32_bf16 v[120:123], a[84:87], v[152:155], v[120:123]
    v_mfma_f32_16x16x32_bf16 v[124:127], a[84:87], v[156:159], v[124:127]
    v_cvt_pk_bf16_f32 v165, v22, v23
    s_waitcnt vmcnt(12) lgkmcnt(3)
    v_mfma_f32_16x16x32_bf16 v[96:99], a[0:3], v[128:131], v[96:99]
    s_waitcnt lgkmcnt(2)
    v_mfma_f32_16x16x32_bf16 v[100:103], a[0:3], v[132:135], v[100:103]
    ds_read_b128 v[144:147], v6 offset:16384
    v_cvt_pk_bf16_f32 v166, v36, v37
    s_waitcnt lgkmcnt(2)
    v_mfma_f32_16x16x32_bf16 v[104:107], a[0:3], v[136:139], v[104:107]
    ds_read_b128 v[148:151], v6 offset:17408
    s_waitcnt lgkmcnt(2)
    v_mfma_f32_16x16x32_bf16 v[108:111], a[0:3], v[140:143], v[108:111]
    ds_read_b128 v[152:155], v6 offset:18432
    v_cvt_pk_bf16_f32 v167, v38, v39
    s_waitcnt vmcnt(11)
    v_mfma_f32_16x16x32_bf16 v[112:115], a[4:7], v[128:131], v[112:115]
    ds_read_b128 v[156:159], v6 offset:19456
    v_mfma_f32_16x16x32_bf16 v[116:119], a[4:7], v[132:135], v[116:119]
    s_add_u32 s30, s28, 18432
    v_mfma_f32_16x16x32_bf16 v[120:123], a[4:7], v[136:139], v[120:123]
    v_mfma_f32_16x16x32_bf16 v[124:127], a[4:7], v[140:143], v[124:127]
    buffer_store_dwordx4 v[164:167], v3, s[44:47], s30 offen offset:0 sc1
    s_waitcnt vmcnt(11) lgkmcnt(3)
    v_mfma_f32_16x16x32_bf16 v[96:99], a[8:11], v[144:147], v[96:99]
    s_waitcnt lgkmcnt(2)
    v_mfma_f32_16x16x32_bf16 v[100:103], a[8:11], v[148:151], v[100:103]
    ds_read_b128 v[128:131], v6 offset:20480
    v_cvt_pk_bf16_f32 v160, v24, v25
    s_waitcnt lgkmcnt(2)
    v_mfma_f32_16x16x32_bf16 v[104:107], a[8:11], v[152:155], v[104:107]
    ds_read_b128 v[132:135], v6 offset:21504
    s_waitcnt lgkmcnt(2)
    v_mfma_f32_16x16x32_bf16 v[108:111], a[8:11], v[156:159], v[108:111]
    ds_read_b128 v[136:139], v6 offset:22528
    v_cvt_pk_bf16_f32 v161, v26, v27
    s_waitcnt vmcnt(10)
    v_mfma_f32_16x16x32_bf16 v[112:115], a[12:15], v[144:147], v[112:115]
    ds_read_b128 v[140:143], v6 offset:23552
    v_mfma_f32_16x16x32_bf16 v[116:119], a[12:15], v[148:151], v[116:119]
    v_cvt_pk_bf16_f32 v162, v40, v41
    v_mfma_f32_16x16x32_bf16 v[120:123], a[12:15], v[152:155], v[120:123]
    v_mfma_f32_16x16x32_bf16 v[124:127], a[12:15], v[156:159], v[124:127]
    v_cvt_pk_bf16_f32 v163, v42, v43
    s_waitcnt vmcnt(9) lgkmcnt(3)
    v_mfma_f32_16x16x32_bf16 v[96:99], a[16:19], v[128:131], v[96:99]
    s_waitcnt lgkmcnt(2)
    v_mfma_f32_16x16x32_bf16 v[100:103], a[16:19], v[132:135], v[100:103]
    ds_read_b128 v[144:147], v6 offset:24576
    s_add_u32 s30, s28, 36864
    s_waitcnt lgkmcnt(2)
    v_mfma_f32_16x16x32_bf16 v[104:107], a[16:19], v[136:139], v[104:107]
    ds_read_b128 v[148:151], v6 offset:25600
    s_waitcnt lgkmcnt(2)
    v_mfma_f32_16x16x32_bf16 v[108:111], a[16:19], v[140:143], v[108:111]
    ds_read_b128 v[152:155], v6 offset:26624
    buffer_store_dwordx4 v[160:163], v3, s[44:47], s30 offen offset:0 sc1
    s_waitcnt vmcnt(9)
    v_mfma_f32_16x16x32_bf16 v[112:115], a[20:23], v[128:131], v[112:115]
    ds_read_b128 v[156:159], v6 offset:27648
    v_mfma_f32_16x16x32_bf16 v[116:119], a[20:23], v[132:135], v[116:119]
    v_cvt_pk_bf16_f32 v164, v28, v29
    v_mfma_f32_16x16x32_bf16 v[120:123], a[20:23], v[136:139], v[120:123]
    v_mfma_f32_16x16x32_bf16 v[124:127], a[20:23], v[140:143], v[124:127]
    v_cvt_pk_bf16_f32 v165, v30, v31
    s_waitcnt vmcnt(8) lgkmcnt(3)
    v_mfma_f32_16x16x32_bf16 v[96:99], a[24:27], v[144:147], v[96:99]
    s_waitcnt lgkmcnt(2)
    v_mfma_f32_16x16x32_bf16 v[100:103], a[24:27], v[148:151], v[100:103]
    ds_read_b128 v[128:131], v6 offset:28672
    v_cvt_pk_bf16_f32 v166, v44, v45
    s_waitcnt lgkmcnt(2)
    v_mfma_f32_16x16x32_bf16 v[104:107], a[24:27], v[152:155], v[104:107]
    ds_read_b128 v[132:135], v6 offset:29696
    s_waitcnt lgkmcnt(2)
    v_mfma_f32_16x16x32_bf16 v[108:111], a[24:27], v[156:159], v[108:111]
    ds_read_b128 v[136:139], v6 offset:30720
    v_cvt_pk_bf16_f32 v167, v46, v47
    s_waitcnt vmcnt(7)
    v_mfma_f32_16x16x32_bf16 v[112:115], a[28:31], v[144:147], v[112:115]
    ds_read_b128 v[140:143], v6 offset:31744
    v_mfma_f32_16x16x32_bf16 v[116:119], a[28:31], v[148:151], v[116:119]
    s_add_u32 s30, s28, 55296
    v_mfma_f32_16x16x32_bf16 v[120:123], a[28:31], v[152:155], v[120:123]
    v_mfma_f32_16x16x32_bf16 v[124:127], a[28:31], v[156:159], v[124:127]
    buffer_store_dwordx4 v[164:167], v3, s[44:47], s30 offen offset:0 sc1
    s_waitcnt vmcnt(7) lgkmcnt(3)
    v_mfma_f32_16x16x32_bf16 v[96:99], a[32:35], v[128:131], v[96:99]
    s_waitcnt lgkmcnt(2)
    v_mfma_f32_16x16x32_bf16 v[100:103], a[32:35], v[132:135], v[100:103]
    ds_read_b128 v[144:147], v6 offset:32768
    s_waitcnt lgkmcnt(2)
    v_mfma_f32_16x16x32_bf16 v[104:107], a[32:35], v[136:139], v[104:107]
    ds_read_b128 v[148:151], v6 offset:33792
    s_waitcnt lgkmcnt(2)
    v_mfma_f32_16x16x32_bf16 v[108:111], a[32:35], v[140:143], v[108:111]
    ds_read_b128 v[152:155], v6 offset:34816
    s_waitcnt vmcnt(6)
    v_mfma_f32_16x16x32_bf16 v[112:115], a[36:39], v[128:131], v[112:115]
    ds_read_b128 v[156:159], v6 offset:35840
    v_mfma_f32_16x16x32_bf16 v[116:119], a[36:39], v[132:135], v[116:119]
    v_mfma_f32_16x16x32_bf16 v[120:123], a[36:39], v[136:139], v[120:123]
    v_mfma_f32_16x16x32_bf16 v[124:127], a[36:39], v[140:143], v[124:127]
    s_waitcnt vmcnt(5) lgkmcnt(3)
    v_mfma_f32_16x16x32_bf16 v[96:99], a[40:43], v[144:147], v[96:99]
    s_waitcnt lgkmcnt(2)
    v_mfma_f32_16x16x32_bf16 v[100:103], a[40:43], v[148:151], v[100:103]
    s_waitcnt lgkmcnt(1)
    v_mfma_f32_16x16x32_bf16 v[104:107], a[40:43], v[152:155], v[104:107]
    s_waitcnt lgkmcnt(0)
    v_mfma_f32_16x16x32_bf16 v[108:111], a[40:43], v[156:159], v[108:111]
    s_waitcnt vmcnt(4)
    v_mfma_f32_16x16x32_bf16 v[112:115], a[44:47], v[144:147], v[112:115]
    v_mfma_f32_16x16x32_bf16 v[116:119], a[44:47], v[148:151], v[116:119]
    v_mfma_f32_16x16x32_bf16 v[120:123], a[44:47], v[152:155], v[120:123]
    v_mfma_f32_16x16x32_bf16 v[124:127], a[44:47], v[156:159], v[124:127]
    v_cvt_pk_bf16_f32 v160, v96, v97
    v_cvt_pk_bf16_f32 v161, v98, v99
    s_nop 2
    v_cvt_pk_bf16_f32 v162, v112, v113
    v_cvt_pk_bf16_f32 v163, v114, v115
    s_add_u32 s30, s28, 0
    buffer_store_dwordx4 v[160:163], v3, s[44:47], s30 offen offset:1024 sc1
    v_cvt_pk_bf16_f32 v164, v100, v101
    v_cvt_pk_bf16_f32 v165, v102, v103
    v_cvt_pk_bf16_f32 v166, v116, v117
    v_cvt_pk_bf16_f32 v167, v118, v119
    s_add_u32 s30, s28, 18432
    buffer_store_dwordx4 v[164:167], v3, s[44:47], s30 offen offset:1024 sc1
    v_cvt_pk_bf16_f32 v160, v104, v105
    v_cvt_pk_bf16_f32 v161, v106, v107
    v_cvt_pk_bf16_f32 v162, v120, v121
    v_cvt_pk_bf16_f32 v163, v122, v123
    s_add_u32 s30, s28, 36864
    buffer_store_dwordx4 v[160:163], v3, s[44:47], s30 offen offset:1024 sc1
    v_cvt_pk_bf16_f32 v164, v108, v109
    v_cvt_pk_bf16_f32 v165, v110, v111
    v_cvt_pk_bf16_f32 v166, v124, v125
    v_cvt_pk_bf16_f32 v167, v126, v127
    s_add_u32 s30, s28, 55296
    buffer_store_dwordx4 v[164:167], v3, s[44:47], s30 offen offset:1024 sc1
    s_waitcnt vmcnt(0) lgkmcnt(0)
    s_barrier
    s_cmp_lg_u32 s3, 4
    s_cbranch_scc1 Lsig18
    s_mov_b64 exec, 1
    v_mov_b32 v1, 1
    v_mov_b32 v10, 0
    buffer_atomic_add v1, v10, s[44:47], s36 offen sc1
    s_mov_b64 exec, -1
Lsig18:
sequential_preLN__ssm_conv_h3__mixer_s_mlp__prompt_kernel_d:
    s_nop 4
    s_mul_i32 s6, s4, 72
    s_mul_i32 s7, s5, 9
    s_add_u32 s6, s6, s7
    s_add_u32 s6, s6, s3
    v_lshrrev_b32 v5, 1, v12
    v_lshl_add_u32 v5, v5, 4, v15
    v_lshlrev_b32 v5, 4, v5
    v_and_b32 v6, 1, v12
    v_lshl_add_u32 v5, v6, 3, v5
    v_lshrrev_b32 v9, 1, v12
    v_lshlrev_b32 v9, 4, v9
    v_lshl_add_u32 v9, v6, 5, v9
    s_mul_hi_u32 s7, s6, 0x0e38e38f
    s_mul_i32 s8, s7, 18
    s_sub_u32 s8, s6, s8
    s_lshl_b32 s9, s7, 4
    v_add_u32 v4, s9, v15
    v_mul_u32_u24 v4, 1152, v4
    v_add_u32 v4, v9, v4
    s_lshl_b32 s9, s8, 6
    v_add_u32 v4, s9, v4
    s_lshl_b32 s12, s6, 10
    s_add_u32 s9, s12, 19021824
    s_add_u32 s10, s12, 16662528
    buffer_load_dwordx2 v[48:49], v5, s[44:47], s9 offen offset:0 sc1
    buffer_load_dwordx2 v[52:53], v5, s[44:47], s10 offen offset:0 sc1
    buffer_load_dwordx2 v[50:51], v5, s[44:47], s9 offen offset:512 sc1
    buffer_load_dwordx2 v[54:55], v5, s[44:47], s10 offen offset:512 sc1
    s_add_u32 s12, s12, 21446656
    s_cmp_lg_u32 s3, 0
    s_cbranch_scc1 sequential_preLN__ssm_conv_h3__mixer_s_mlp__prompt_kernel_d1
    s_add_u32 s11, s6, 8
    s_mul_hi_u32 s7, s11, 0x0e38e38f
    s_mul_i32 s8, s7, 18
    s_sub_u32 s8, s11, s8
    s_lshl_b32 s9, s7, 4
    v_add_u32 v8, s9, v15
    v_mul_u32_u24 v8, 1152, v8
    v_add_u32 v8, v9, v8
    s_lshl_b32 s9, s8, 6
    v_add_u32 v8, s9, v8
    s_lshl_b32 s13, s11, 10
    s_add_u32 s9, s13, 19021824
    s_add_u32 s10, s13, 16662528
    buffer_load_dwordx2 v[104:105], v5, s[44:47], s9 offen offset:0 sc1
    buffer_load_dwordx2 v[108:109], v5, s[44:47], s10 offen offset:0 sc1
    buffer_load_dwordx2 v[106:107], v5, s[44:47], s9 offen offset:512 sc1
    buffer_load_dwordx2 v[110:111], v5, s[44:47], s10 offen offset:512 sc1
    s_add_u32 s13, s13, 21446656
    s_cmp_lg_u32 s3, 4
    s_cbranch_scc1 Lw19_done
    v_mov_b32 v10, 0
    s_mov_b32 s35, 0
Lw19_0:
    buffer_load_dword v1, v10, s[44:47], s36 offen sc1
    s_add_u32 s35, s35, 1
    s_waitcnt vmcnt(0)
    v_readfirstlane_b32 s34, v1
    s_cmp_gt_u32 s35, 0x80000
    s_cbranch_scc1 Lw19_done
    s_cmp_lg_u32 s34, 8
    s_cbranch_scc1 Lw19_0
Lw19_done:
    s_barrier
    buffer_load_dwordx4 v[16:19], v3, s[44:47], s12 offen sc1
    s_add_u32 s12, s12, 2359296
    buffer_load_dwordx4 v[20:23], v3, s[44:47], s12 offen sc1
    s_add_u32 s12, s12, 2359296
    buffer_load_dwordx4 v[24:27], v3, s[44:47], s12 offen sc1
    s_add_u32 s12, s12, 2359296
    buffer_load_dwordx4 v[28:31], v3, s[44:47], s12 offen sc1
    s_add_u32 s12, s12, 2359296
    buffer_load_dwordx4 v[32:35], v3, s[44:47], s12 offen sc1
    s_add_u32 s12, s12, 2359296
    buffer_load_dwordx4 v[36:39], v3, s[44:47], s12 offen sc1
    s_add_u32 s12, s12, 2359296
    buffer_load_dwordx4 v[40:43], v3, s[44:47], s12 offen sc1
    s_add_u32 s12, s12, 2359296
    buffer_load_dwordx4 v[44:47], v3, s[44:47], s12 offen sc1
    buffer_load_dwordx4 v[72:75], v3, s[44:47], s13 offen sc1
    s_add_u32 s13, s13, 2359296
    buffer_load_dwordx4 v[76:79], v3, s[44:47], s13 offen sc1
    s_add_u32 s13, s13, 2359296
    buffer_load_dwordx4 v[80:83], v3, s[44:47], s13 offen sc1
    s_add_u32 s13, s13, 2359296
    buffer_load_dwordx4 v[84:87], v3, s[44:47], s13 offen sc1
    s_add_u32 s13, s13, 2359296
    buffer_load_dwordx4 v[88:91], v3, s[44:47], s13 offen sc1
    s_add_u32 s13, s13, 2359296
    buffer_load_dwordx4 v[92:95], v3, s[44:47], s13 offen sc1
    s_add_u32 s13, s13, 2359296
    buffer_load_dwordx4 v[96:99], v3, s[44:47], s13 offen sc1
    s_add_u32 s13, s13, 2359296
    buffer_load_dwordx4 v[100:103], v3, s[44:47], s13 offen sc1
    s_waitcnt vmcnt(23)
    v_lshlrev_b32 v56, 16, v48
    v_and_b32 v57, 0xffff0000, v48
    v_lshlrev_b32 v58, 16, v49
    v_and_b32 v59, 0xffff0000, v49
    s_waitcnt vmcnt(21)
    v_lshlrev_b32 v60, 16, v50
    v_and_b32 v61, 0xffff0000, v50
    v_lshlrev_b32 v62, 16, v51
    v_and_b32 v63, 0xffff0000, v51
    v_lshlrev_b32 v6, 16, v52
    v_and_b32 v7, 0xffff0000, v52
    v_add_f32 v56, v56, v6
    v_add_f32 v57, v57, v7
    v_lshlrev_b32 v6, 16, v53
    v_and_b32 v7, 0xffff0000, v53
    v_add_f32 v58, v58, v6
    v_add_f32 v59, v59, v7
    s_waitcnt vmcnt(20)
    v_lshlrev_b32 v6, 16, v54
    v_and_b32 v7, 0xffff0000, v54
    v_add_f32 v60, v60, v6
    v_add_f32 v61, v61, v7
    v_lshlrev_b32 v6, 16, v55
    v_and_b32 v7, 0xffff0000, v55
    v_add_f32 v62, v62, v6
    v_add_f32 v63, v63, v7
    s_waitcnt vmcnt(15)
    v_lshlrev_b32 v6, 16, v16
    v_and_b32 v7, 0xffff0000, v16
    v_add_f32 v56, v56, v6
    v_add_f32 v57, v57, v7
    v_lshlrev_b32 v6, 16, v17
    v_and_b32 v7, 0xffff0000, v17
    v_add_f32 v58, v58, v6
    v_add_f32 v59, v59, v7
    v_lshlrev_b32 v6, 16, v18
    v_and_b32 v7, 0xffff0000, v18
    v_add_f32 v60, v60, v6
    v_add_f32 v61, v61, v7
    v_lshlrev_b32 v6, 16, v19
    v_and_b32 v7, 0xffff0000, v19
    v_add_f32 v62, v62, v6
    v_add_f32 v63, v63, v7
    s_waitcnt vmcnt(14)
    v_lshlrev_b32 v6, 16, v20
    v_and_b32 v7, 0xffff0000, v20
    v_add_f32 v56, v56, v6
    v_add_f32 v57, v57, v7
    v_lshlrev_b32 v6, 16, v21
    v_and_b32 v7, 0xffff0000, v21
    v_add_f32 v58, v58, v6
    v_add_f32 v59, v59, v7
    v_lshlrev_b32 v6, 16, v22
    v_and_b32 v7, 0xffff0000, v22
    v_add_f32 v60, v60, v6
    v_add_f32 v61, v61, v7
    v_lshlrev_b32 v6, 16, v23
    v_and_b32 v7, 0xffff0000, v23
    v_add_f32 v62, v62, v6
    v_add_f32 v63, v63, v7
    s_waitcnt vmcnt(13)
    v_lshlrev_b32 v6, 16, v24
    v_and_b32 v7, 0xffff0000, v24
    v_add_f32 v56, v56, v6
    v_add_f32 v57, v57, v7
    v_lshlrev_b32 v6, 16, v25
    v_and_b32 v7, 0xffff0000, v25
    v_add_f32 v58, v58, v6
    v_add_f32 v59, v59, v7
    v_lshlrev_b32 v6, 16, v26
    v_and_b32 v7, 0xffff0000, v26
    v_add_f32 v60, v60, v6
    v_add_f32 v61, v61, v7
    v_lshlrev_b32 v6, 16, v27
    v_and_b32 v7, 0xffff0000, v27
    v_add_f32 v62, v62, v6
    v_add_f32 v63, v63, v7
    s_waitcnt vmcnt(12)
    v_lshlrev_b32 v6, 16, v28
    v_and_b32 v7, 0xffff0000, v28
    v_add_f32 v56, v56, v6
    v_add_f32 v57, v57, v7
    v_lshlrev_b32 v6, 16, v29
    v_and_b32 v7, 0xffff0000, v29
    v_add_f32 v58, v58, v6
    v_add_f32 v59, v59, v7
    v_lshlrev_b32 v6, 16, v30
    v_and_b32 v7, 0xffff0000, v30
    v_add_f32 v60, v60, v6
    v_add_f32 v61, v61, v7
    v_lshlrev_b32 v6, 16, v31
    v_and_b32 v7, 0xffff0000, v31
    v_add_f32 v62, v62, v6
    v_add_f32 v63, v63, v7
    s_waitcnt vmcnt(11)
    v_lshlrev_b32 v6, 16, v32
    v_and_b32 v7, 0xffff0000, v32
    v_add_f32 v56, v56, v6
    v_add_f32 v57, v57, v7
    v_lshlrev_b32 v6, 16, v33
    v_and_b32 v7, 0xffff0000, v33
    v_add_f32 v58, v58, v6
    v_add_f32 v59, v59, v7
    v_lshlrev_b32 v6, 16, v34
    v_and_b32 v7, 0xffff0000, v34
    v_add_f32 v60, v60, v6
    v_add_f32 v61, v61, v7
    v_lshlrev_b32 v6, 16, v35
    v_and_b32 v7, 0xffff0000, v35
    v_add_f32 v62, v62, v6
    v_add_f32 v63, v63, v7
    s_waitcnt vmcnt(10)
    v_lshlrev_b32 v6, 16, v36
    v_and_b32 v7, 0xffff0000, v36
    v_add_f32 v56, v56, v6
    v_add_f32 v57, v57, v7
    v_lshlrev_b32 v6, 16, v37
    v_and_b32 v7, 0xffff0000, v37
    v_add_f32 v58, v58, v6
    v_add_f32 v59, v59, v7
    v_lshlrev_b32 v6, 16, v38
    v_and_b32 v7, 0xffff0000, v38
    v_add_f32 v60, v60, v6
    v_add_f32 v61, v61, v7
    v_lshlrev_b32 v6, 16, v39
    v_and_b32 v7, 0xffff0000, v39
    v_add_f32 v62, v62, v6
    v_add_f32 v63, v63, v7
    s_waitcnt vmcnt(9)
    v_lshlrev_b32 v6, 16, v40
    v_and_b32 v7, 0xffff0000, v40
    v_add_f32 v56, v56, v6
    v_add_f32 v57, v57, v7
    v_lshlrev_b32 v6, 16, v41
    v_and_b32 v7, 0xffff0000, v41
    v_add_f32 v58, v58, v6
    v_add_f32 v59, v59, v7
    v_lshlrev_b32 v6, 16, v42
    v_and_b32 v7, 0xffff0000, v42
    v_add_f32 v60, v60, v6
    v_add_f32 v61, v61, v7
    v_lshlrev_b32 v6, 16, v43
    v_and_b32 v7, 0xffff0000, v43
    v_add_f32 v62, v62, v6
    v_add_f32 v63, v63, v7
    s_waitcnt vmcnt(8)
    v_lshlrev_b32 v6, 16, v44
    v_and_b32 v7, 0xffff0000, v44
    v_add_f32 v56, v56, v6
    v_add_f32 v57, v57, v7
    v_lshlrev_b32 v6, 16, v45
    v_and_b32 v7, 0xffff0000, v45
    v_add_f32 v58, v58, v6
    v_add_f32 v59, v59, v7
    v_lshlrev_b32 v6, 16, v46
    v_and_b32 v7, 0xffff0000, v46
    v_add_f32 v60, v60, v6
    v_add_f32 v61, v61, v7
    v_lshlrev_b32 v6, 16, v47
    v_and_b32 v7, 0xffff0000, v47
    v_add_f32 v62, v62, v6
    v_add_f32 v63, v63, v7
    v_cvt_pk_bf16_f32 v64, v56, v57
    v_cvt_pk_bf16_f32 v65, v58, v59
    v_cvt_pk_bf16_f32 v66, v60, v61
    v_cvt_pk_bf16_f32 v67, v62, v63
    s_nop 0
    v_permlane16_swap_b32 v64, v66
    v_permlane16_swap_b32 v65, v67
    buffer_store_dwordx4 v[64:67], v4, s[68:71], 0 offen
    v_lshlrev_b32 v112, 16, v104
    v_and_b32 v113, 0xffff0000, v104
    v_lshlrev_b32 v114, 16, v105
    v_and_b32 v115, 0xffff0000, v105
    v_lshlrev_b32 v116, 16, v106
    v_and_b32 v117, 0xffff0000, v106
    v_lshlrev_b32 v118, 16, v107
    v_and_b32 v119, 0xffff0000, v107
    v_lshlrev_b32 v6, 16, v108
    v_and_b32 v7, 0xffff0000, v108
    v_add_f32 v112, v112, v6
    v_add_f32 v113, v113, v7
    v_lshlrev_b32 v6, 16, v109
    v_and_b32 v7, 0xffff0000, v109
    v_add_f32 v114, v114, v6
    v_add_f32 v115, v115, v7
    v_lshlrev_b32 v6, 16, v110
    v_and_b32 v7, 0xffff0000, v110
    v_add_f32 v116, v116, v6
    v_add_f32 v117, v117, v7
    v_lshlrev_b32 v6, 16, v111
    v_and_b32 v7, 0xffff0000, v111
    v_add_f32 v118, v118, v6
    v_add_f32 v119, v119, v7
    s_waitcnt vmcnt(8)
    v_lshlrev_b32 v6, 16, v72
    v_and_b32 v7, 0xffff0000, v72
    v_add_f32 v112, v112, v6
    v_add_f32 v113, v113, v7
    v_lshlrev_b32 v6, 16, v73
    v_and_b32 v7, 0xffff0000, v73
    v_add_f32 v114, v114, v6
    v_add_f32 v115, v115, v7
    v_lshlrev_b32 v6, 16, v74
    v_and_b32 v7, 0xffff0000, v74
    v_add_f32 v116, v116, v6
    v_add_f32 v117, v117, v7
    v_lshlrev_b32 v6, 16, v75
    v_and_b32 v7, 0xffff0000, v75
    v_add_f32 v118, v118, v6
    v_add_f32 v119, v119, v7
    s_waitcnt vmcnt(7)
    v_lshlrev_b32 v6, 16, v76
    v_and_b32 v7, 0xffff0000, v76
    v_add_f32 v112, v112, v6
    v_add_f32 v113, v113, v7
    v_lshlrev_b32 v6, 16, v77
    v_and_b32 v7, 0xffff0000, v77
    v_add_f32 v114, v114, v6
    v_add_f32 v115, v115, v7
    v_lshlrev_b32 v6, 16, v78
    v_and_b32 v7, 0xffff0000, v78
    v_add_f32 v116, v116, v6
    v_add_f32 v117, v117, v7
    v_lshlrev_b32 v6, 16, v79
    v_and_b32 v7, 0xffff0000, v79
    v_add_f32 v118, v118, v6
    v_add_f32 v119, v119, v7
    s_waitcnt vmcnt(6)
    v_lshlrev_b32 v6, 16, v80
    v_and_b32 v7, 0xffff0000, v80
    v_add_f32 v112, v112, v6
    v_add_f32 v113, v113, v7
    v_lshlrev_b32 v6, 16, v81
    v_and_b32 v7, 0xffff0000, v81
    v_add_f32 v114, v114, v6
    v_add_f32 v115, v115, v7
    v_lshlrev_b32 v6, 16, v82
    v_and_b32 v7, 0xffff0000, v82
    v_add_f32 v116, v116, v6
    v_add_f32 v117, v117, v7
    v_lshlrev_b32 v6, 16, v83
    v_and_b32 v7, 0xffff0000, v83
    v_add_f32 v118, v118, v6
    v_add_f32 v119, v119, v7
    s_waitcnt vmcnt(5)
    v_lshlrev_b32 v6, 16, v84
    v_and_b32 v7, 0xffff0000, v84
    v_add_f32 v112, v112, v6
    v_add_f32 v113, v113, v7
    v_lshlrev_b32 v6, 16, v85
    v_and_b32 v7, 0xffff0000, v85
    v_add_f32 v114, v114, v6
    v_add_f32 v115, v115, v7
    v_lshlrev_b32 v6, 16, v86
    v_and_b32 v7, 0xffff0000, v86
    v_add_f32 v116, v116, v6
    v_add_f32 v117, v117, v7
    v_lshlrev_b32 v6, 16, v87
    v_and_b32 v7, 0xffff0000, v87
    v_add_f32 v118, v118, v6
    v_add_f32 v119, v119, v7
    s_waitcnt vmcnt(4)
    v_lshlrev_b32 v6, 16, v88
    v_and_b32 v7, 0xffff0000, v88
    v_add_f32 v112, v112, v6
    v_add_f32 v113, v113, v7
    v_lshlrev_b32 v6, 16, v89
    v_and_b32 v7, 0xffff0000, v89
    v_add_f32 v114, v114, v6
    v_add_f32 v115, v115, v7
    v_lshlrev_b32 v6, 16, v90
    v_and_b32 v7, 0xffff0000, v90
    v_add_f32 v116, v116, v6
    v_add_f32 v117, v117, v7
    v_lshlrev_b32 v6, 16, v91
    v_and_b32 v7, 0xffff0000, v91
    v_add_f32 v118, v118, v6
    v_add_f32 v119, v119, v7
    s_waitcnt vmcnt(3)
    v_lshlrev_b32 v6, 16, v92
    v_and_b32 v7, 0xffff0000, v92
    v_add_f32 v112, v112, v6
    v_add_f32 v113, v113, v7
    v_lshlrev_b32 v6, 16, v93
    v_and_b32 v7, 0xffff0000, v93
    v_add_f32 v114, v114, v6
    v_add_f32 v115, v115, v7
    v_lshlrev_b32 v6, 16, v94
    v_and_b32 v7, 0xffff0000, v94
    v_add_f32 v116, v116, v6
    v_add_f32 v117, v117, v7
    v_lshlrev_b32 v6, 16, v95
    v_and_b32 v7, 0xffff0000, v95
    v_add_f32 v118, v118, v6
    v_add_f32 v119, v119, v7
    s_waitcnt vmcnt(2)
    v_lshlrev_b32 v6, 16, v96
    v_and_b32 v7, 0xffff0000, v96
    v_add_f32 v112, v112, v6
    v_add_f32 v113, v113, v7
    v_lshlrev_b32 v6, 16, v97
    v_and_b32 v7, 0xffff0000, v97
    v_add_f32 v114, v114, v6
    v_add_f32 v115, v115, v7
    v_lshlrev_b32 v6, 16, v98
    v_and_b32 v7, 0xffff0000, v98
    v_add_f32 v116, v116, v6
    v_add_f32 v117, v117, v7
    v_lshlrev_b32 v6, 16, v99
    v_and_b32 v7, 0xffff0000, v99
    v_add_f32 v118, v118, v6
    v_add_f32 v119, v119, v7
    s_waitcnt vmcnt(1)
    v_lshlrev_b32 v6, 16, v100
    v_and_b32 v7, 0xffff0000, v100
    v_add_f32 v112, v112, v6
    v_add_f32 v113, v113, v7
    v_lshlrev_b32 v6, 16, v101
    v_and_b32 v7, 0xffff0000, v101
    v_add_f32 v114, v114, v6
    v_add_f32 v115, v115, v7
    v_lshlrev_b32 v6, 16, v102
    v_and_b32 v7, 0xffff0000, v102
    v_add_f32 v116, v116, v6
    v_add_f32 v117, v117, v7
    v_lshlrev_b32 v6, 16, v103
    v_and_b32 v7, 0xffff0000, v103
    v_add_f32 v118, v118, v6
    v_add_f32 v119, v119, v7
    v_cvt_pk_bf16_f32 v120, v112, v113
    v_cvt_pk_bf16_f32 v121, v114, v115
    v_cvt_pk_bf16_f32 v122, v116, v117
    v_cvt_pk_bf16_f32 v123, v118, v119
    s_nop 0
    v_permlane16_swap_b32 v120, v122
    v_permlane16_swap_b32 v121, v123
    buffer_store_dwordx4 v[120:123], v8, s[68:71], 0 offen
    s_branch sequential_preLN__ssm_conv_h3__mixer_s_mlp__prompt_kernel_ddone
sequential_preLN__ssm_conv_h3__mixer_s_mlp__prompt_kernel_d1:
    s_cmp_lg_u32 s3, 4
    s_cbranch_scc1 Lw20_done
    v_mov_b32 v10, 0
    s_mov_b32 s35, 0
Lw20_0:
    buffer_load_dword v1, v10, s[44:47], s36 offen sc1
    s_add_u32 s35, s35, 1
    s_waitcnt vmcnt(0)
    v_readfirstlane_b32 s34, v1
    s_cmp_gt_u32 s35, 0x80000
    s_cbranch_scc1 Lw20_done
    s_cmp_lg_u32 s34, 8
    s_cbranch_scc1 Lw20_0
Lw20_done:
    s_barrier
    buffer_load_dwordx4 v[16:19], v3, s[44:47], s12 offen sc1
    s_add_u32 s12, s12, 2359296
    buffer_load_dwordx4 v[20:23], v3, s[44:47], s12 offen sc1
    s_add_u32 s12, s12, 2359296
    buffer_load_dwordx4 v[24:27], v3, s[44:47], s12 offen sc1
    s_add_u32 s12, s12, 2359296
    buffer_load_dwordx4 v[28:31], v3, s[44:47], s12 offen sc1
    s_add_u32 s12, s12, 2359296
    buffer_load_dwordx4 v[32:35], v3, s[44:47], s12 offen sc1
    s_add_u32 s12, s12, 2359296
    buffer_load_dwordx4 v[36:39], v3, s[44:47], s12 offen sc1
    s_add_u32 s12, s12, 2359296
    buffer_load_dwordx4 v[40:43], v3, s[44:47], s12 offen sc1
    s_add_u32 s12, s12, 2359296
    buffer_load_dwordx4 v[44:47], v3, s[44:47], s12 offen sc1
    s_waitcnt vmcnt(11)
    v_lshlrev_b32 v56, 16, v48
    v_and_b32 v57, 0xffff0000, v48
    v_lshlrev_b32 v58, 16, v49
    v_and_b32 v59, 0xffff0000, v49
    s_waitcnt vmcnt(9)
    v_lshlrev_b32 v60, 16, v50
    v_and_b32 v61, 0xffff0000, v50
    v_lshlrev_b32 v62, 16, v51
    v_and_b32 v63, 0xffff0000, v51
    v_lshlrev_b32 v6, 16, v52
    v_and_b32 v7, 0xffff0000, v52
    v_add_f32 v56, v56, v6
    v_add_f32 v57, v57, v7
    v_lshlrev_b32 v6, 16, v53
    v_and_b32 v7, 0xffff0000, v53
    v_add_f32 v58, v58, v6
    v_add_f32 v59, v59, v7
    s_waitcnt vmcnt(8)
    v_lshlrev_b32 v6, 16, v54
    v_and_b32 v7, 0xffff0000, v54
    v_add_f32 v60, v60, v6
    v_add_f32 v61, v61, v7
    v_lshlrev_b32 v6, 16, v55
    v_and_b32 v7, 0xffff0000, v55
    v_add_f32 v62, v62, v6
    v_add_f32 v63, v63, v7
    s_waitcnt vmcnt(7)
    v_lshlrev_b32 v6, 16, v16
    v_and_b32 v7, 0xffff0000, v16
    v_add_f32 v56, v56, v6
    v_add_f32 v57, v57, v7
    v_lshlrev_b32 v6, 16, v17
    v_and_b32 v7, 0xffff0000, v17
    v_add_f32 v58, v58, v6
    v_add_f32 v59, v59, v7
    v_lshlrev_b32 v6, 16, v18
    v_and_b32 v7, 0xffff0000, v18
    v_add_f32 v60, v60, v6
    v_add_f32 v61, v61, v7
    v_lshlrev_b32 v6, 16, v19
    v_and_b32 v7, 0xffff0000, v19
    v_add_f32 v62, v62, v6
    v_add_f32 v63, v63, v7
    s_waitcnt vmcnt(6)
    v_lshlrev_b32 v6, 16, v20
    v_and_b32 v7, 0xffff0000, v20
    v_add_f32 v56, v56, v6
    v_add_f32 v57, v57, v7
    v_lshlrev_b32 v6, 16, v21
    v_and_b32 v7, 0xffff0000, v21
    v_add_f32 v58, v58, v6
    v_add_f32 v59, v59, v7
    v_lshlrev_b32 v6, 16, v22
    v_and_b32 v7, 0xffff0000, v22
    v_add_f32 v60, v60, v6
    v_add_f32 v61, v61, v7
    v_lshlrev_b32 v6, 16, v23
    v_and_b32 v7, 0xffff0000, v23
    v_add_f32 v62, v62, v6
    v_add_f32 v63, v63, v7
    s_waitcnt vmcnt(5)
    v_lshlrev_b32 v6, 16, v24
    v_and_b32 v7, 0xffff0000, v24
    v_add_f32 v56, v56, v6
    v_add_f32 v57, v57, v7
    v_lshlrev_b32 v6, 16, v25
    v_and_b32 v7, 0xffff0000, v25
    v_add_f32 v58, v58, v6
    v_add_f32 v59, v59, v7
    v_lshlrev_b32 v6, 16, v26
    v_and_b32 v7, 0xffff0000, v26
    v_add_f32 v60, v60, v6
    v_add_f32 v61, v61, v7
    v_lshlrev_b32 v6, 16, v27
    v_and_b32 v7, 0xffff0000, v27
    v_add_f32 v62, v62, v6
    v_add_f32 v63, v63, v7
    s_waitcnt vmcnt(4)
    v_lshlrev_b32 v6, 16, v28
    v_and_b32 v7, 0xffff0000, v28
    v_add_f32 v56, v56, v6
    v_add_f32 v57, v57, v7
    v_lshlrev_b32 v6, 16, v29
    v_and_b32 v7, 0xffff0000, v29
    v_add_f32 v58, v58, v6
    v_add_f32 v59, v59, v7
    v_lshlrev_b32 v6, 16, v30
    v_and_b32 v7, 0xffff0000, v30
    v_add_f32 v60, v60, v6
    v_add_f32 v61, v61, v7
    v_lshlrev_b32 v6, 16, v31
    v_and_b32 v7, 0xffff0000, v31
    v_add_f32 v62, v62, v6
    v_add_f32 v63, v63, v7
    s_waitcnt vmcnt(3)
    v_lshlrev_b32 v6, 16, v32
    v_and_b32 v7, 0xffff0000, v32
    v_add_f32 v56, v56, v6
    v_add_f32 v57, v57, v7
    v_lshlrev_b32 v6, 16, v33
    v_and_b32 v7, 0xffff0000, v33
    v_add_f32 v58, v58, v6
    v_add_f32 v59, v59, v7
    v_lshlrev_b32 v6, 16, v34
    v_and_b32 v7, 0xffff0000, v34
    v_add_f32 v60, v60, v6
    v_add_f32 v61, v61, v7
    v_lshlrev_b32 v6, 16, v35
    v_and_b32 v7, 0xffff0000, v35
    v_add_f32 v62, v62, v6
    v_add_f32 v63, v63, v7
    s_waitcnt vmcnt(2)
    v_lshlrev_b32 v6, 16, v36
    v_and_b32 v7, 0xffff0000, v36
    v_add_f32 v56, v56, v6
    v_add_f32 v57, v57, v7
    v_lshlrev_b32 v6, 16, v37
    v_and_b32 v7, 0xffff0000, v37
    v_add_f32 v58, v58, v6
    v_add_f32 v59, v59, v7
    v_lshlrev_b32 v6, 16, v38
    v_and_b32 v7, 0xffff0000, v38
    v_add_f32 v60, v60, v6
    v_add_f32 v61, v61, v7
    v_lshlrev_b32 v6, 16, v39
    v_and_b32 v7, 0xffff0000, v39
    v_add_f32 v62, v62, v6
    v_add_f32 v63, v63, v7
    s_waitcnt vmcnt(1)
    v_lshlrev_b32 v6, 16, v40
    v_and_b32 v7, 0xffff0000, v40
    v_add_f32 v56, v56, v6
    v_add_f32 v57, v57, v7
    v_lshlrev_b32 v6, 16, v41
    v_and_b32 v7, 0xffff0000, v41
    v_add_f32 v58, v58, v6
    v_add_f32 v59, v59, v7
    v_lshlrev_b32 v6, 16, v42
    v_and_b32 v7, 0xffff0000, v42
    v_add_f32 v60, v60, v6
    v_add_f32 v61, v61, v7
    v_lshlrev_b32 v6, 16, v43
    v_and_b32 v7, 0xffff0000, v43
    v_add_f32 v62, v62, v6
    v_add_f32 v63, v63, v7
    s_waitcnt vmcnt(0)
    v_lshlrev_b32 v6, 16, v44
    v_and_b32 v7, 0xffff0000, v44
    v_add_f32 v56, v56, v6
    v_add_f32 v57, v57, v7
    v_lshlrev_b32 v6, 16, v45
    v_and_b32 v7, 0xffff0000, v45
    v_add_f32 v58, v58, v6
    v_add_f32 v59, v59, v7
    v_lshlrev_b32 v6, 16, v46
    v_and_b32 v7, 0xffff0000, v46
    v_add_f32 v60, v60, v6
    v_add_f32 v61, v61, v7
    v_lshlrev_b32 v6, 16, v47
    v_and_b32 v7, 0xffff0000, v47
    v_add_f32 v62, v62, v6
    v_add_f32 v63, v63, v7
    v_cvt_pk_bf16_f32 v64, v56, v57
    v_cvt_pk_bf16_f32 v65, v58, v59
    v_cvt_pk_bf16_f32 v66, v60, v61
    v_cvt_pk_bf16_f32 v67, v62, v63
    s_nop 0
    v_permlane16_swap_b32 v64, v66
    v_permlane16_swap_b32 v65, v67
    buffer_store_dwordx4 v[64:67], v4, s[68:71], 0 offen
sequential_preLN__ssm_conv_h3__mixer_s_mlp__prompt_kernel_ddone:
sequential_preLN__ssm_conv_h3__mixer_s_mlp__prompt_kernel_end:
    s_endpgm
text_end:
    s_endpgm
.section .rodata,"a"
.p2align 6
.amdhsa_kernel sequential_preLN__ssm_conv_h3__mixer_s_mlp__prompt_kernel
  .amdhsa_next_free_vgpr 256
  .amdhsa_next_free_sgpr 96
  .amdhsa_accum_offset 168
  .amdhsa_group_segment_fixed_size 0
  .amdhsa_kernarg_size 112
  .amdhsa_user_sgpr_count 2
  .amdhsa_user_sgpr_kernarg_segment_ptr 1
  .amdhsa_system_sgpr_workgroup_id_x 1
.end_amdhsa_kernel
```
